```python
import torch

def _softmax(x, axis=-1):
    return torch.softmax(x, dim=axis)

def _gelu(x):
    return torch.nn.functional.gelu(x, approximate='tanh')

def _silu(x):
    return torch.nn.functional.silu(x)

def _sigmoid(x):
    return torch.sigmoid(x)

def _layernorm(x, axis=-1, eps=1e-05):
    m = x.mean(dim=axis, keepdim=True)
    v = x.var(dim=axis, keepdim=True, unbiased=False)
    return (x - m) / torch.sqrt(v + eps)

def _scatter_add(tgt, idx, src, axis=0):
    return tgt.clone().index_add_(axis, idx, src)

def _segment_sum(src, seg, n):
    out = torch.zeros((n,) + src.shape[1:], dtype=src.dtype)
    return out.index_add_(0, seg, src)

def _pad(x, pw):
    flat = tuple((v for pair in reversed(pw) for v in pair))
    return torch.nn.functional.pad(x, flat)
kernel_name = 'adaLN_cond__ssm_conv_h3__mixer_gmlp__prompt'

def setup_inputs():

    _w = lambda a: (lambda t: t.to(torch.bfloat16) if t.is_floating_point() else t)(torch.as_tensor(a))

    def _A_setup():
        B, S, D = (1, 2048, 448)
        ks = 4
        return {'q': _w((lambda *s: torch.randn(*s, dtype=torch.bfloat16) * 0.05)(B, S, D)), 'k': _w((lambda *s: torch.randn(*s, dtype=torch.bfloat16) * 1.6)(B, S, D)), 'v': _w((lambda *s: torch.randn(*s, dtype=torch.bfloat16) * 1.6)(B, S, D)), 'shift_k': _w((lambda *s: torch.randn(*s, dtype=torch.bfloat16) * 1.6)(D, ks) * 0.5), 'ssm_k': _w((lambda *s: torch.randn(*s, dtype=torch.bfloat16) * 1.6)(D, S) * (1.0 / S ** 0.5)), 'ssm_D': _w((lambda *s: torch.randn(*s, dtype=torch.bfloat16) * 1.6)(D))}
    _A_in = _A_setup()

    def _B_setup():
        B, S, D, F = (1, 2048, 448, 1792)
        Fh = F // 2
        return {'x': _w((lambda *s: torch.randn(*s, dtype=torch.bfloat16) * 0.05)(B, S, D)), 'w_in': _w((lambda *s: torch.randn(*s, dtype=torch.bfloat16) * 0.8)(D, 2 * Fh)), 'w_sp': _w(0.01 * (lambda *s: torch.randn(*s, dtype=torch.bfloat16) * 0.8)(S, S)), 'b_sp': _w(1.0 + 0.01 * (lambda *s: torch.randn(*s, dtype=torch.bfloat16) * 0.1)(S)), 'w_out': _w((lambda *s: torch.randn(*s, dtype=torch.bfloat16) * 0.1)(Fh, D))}
    _B_in = _B_setup()
    return {'A_q': _A_in['q'], 'A_k': _A_in['k'], 'A_v': _A_in['v'], 'A_shift_k': _A_in['shift_k'], 'A_ssm_k': _A_in['ssm_k'], 'A_ssm_D': _A_in['ssm_D'], 'B_x': _B_in['x'], 'B_w_in': _B_in['w_in'], 'B_w_sp': _B_in['w_sp'], 'B_b_sp': _B_in['b_sp'], 'B_w_out': _B_in['w_out'], 'c': _w((lambda *s: torch.randn(*s, dtype=torch.bfloat16) * 0.1)(1, 448) * 8.0), 'w_mod': _w((lambda *s: torch.randn(*s, dtype=torch.bfloat16) * 0.1)(448, 6 * 448) * 448 ** (-0.5) * 8.0)}

def reference(A_q, A_k, A_v, A_shift_k, A_ssm_k, A_ssm_D, B_x, B_w_in, B_w_sp, B_b_sp, B_w_out, c, w_mod):

    def _A_ref(q, k, v, shift_k, ssm_k, ssm_D):
        B, S, D = q.shape
        ks = shift_k.shape[-1]
        k_pad = _pad(k, ((0, 0), (ks - 1, 0), (0, 0)))
        k_shift = torch.zeros_like(k)
        for t in range(ks):
            k_shift = k_shift + k_pad[:, t:t + S, :] * shift_k[:, ks - 1 - t][None, None, :]
        kv = k_shift * v
        L = 2 * S
        kv_pad = _pad(kv, ((0, 0), (0, S), (0, 0)))
        kf_pad = _pad(ssm_k, ((0, 0), (0, S)))
        kv_f = (lambda x, axes=(-2, -1): torch.fft.rfft2(x.float(), dim=axes))(kv_pad[:, None, :, :], axes=(1, 2))
        kf_f = (lambda x, axes=(-2, -1): torch.fft.rfft2(x.float(), dim=axes))(kf_pad[:, None, :], axes=(1, 2))
        kf_f = (lambda x, *d: x.permute(*d))(kf_f, 1, 2, 0)
        y_f = kv_f * kf_f[None, :, :, :]
        y = (lambda x, s, axes=(-2, -1): torch.fft.irfft2(x, s=s, dim=axes).to(torch.bfloat16))(y_f, (1, L), axes=(1, 2))[:, 0, :S, :]
        y = y + kv * ssm_D[None, None, :]
        return q * y

    def _B_ref(x, w_in, w_sp, b_sp, w_out):
        B, S, D = x.shape
        F = w_in.shape[-1]
        Fh = F // 2
        z = _gelu(torch.einsum('bsd,df->bsf', x, w_in))
        z1 = z[..., :Fh].clone()
        z2 = _layernorm(z[..., Fh:], axis=-1)
        g = torch.einsum('ts,bsf->btf', w_sp, z2) + b_sp[None, :, None]
        return torch.einsum('bsf,fd->bsd', z1 * g, w_out)
    x = A_q
    mod = (_silu(c) @ w_mod).reshape(c.shape[0], 6, 1, -1)
    sa, ca, ga, sb, cb, gb = (mod[:, 0].clone(), mod[:, 1].clone(), mod[:, 2].clone(), mod[:, 3].clone(), mod[:, 4].clone(), mod[:, 5].clone())
    h = _layernorm(x, axis=-1) * (1 + ca) + sa
    x = x + ga * _A_ref(h, A_k, A_v, A_shift_k, A_ssm_k, A_ssm_D)
    h = _layernorm(x, axis=-1) * (1 + cb) + sb
    x = x + gb * _B_ref(h, B_w_in, B_w_sp, B_b_sp, B_w_out)
    return x
```

```asm
; @launch kernel=prep_kernel grid=(676,1,1) block=(256,1,1) lds=2048
; @launch kernel=conv_kernel grid=(448,1,1) block=(256,1,1) lds=37760
; @launch kernel=mid_kernel grid=(256,1,1) block=(256,1,1) lds=30016
; @launch kernel=spat_kernel grid=(224,1,1) block=(256,1,1) lds=73728
; @launch kernel=outp_kernel grid=(224,1,1) block=(256,1,1) lds=49152
.amdgcn_target "amdgcn-amd-amdhsa--gfx950"
.text
.globl prep_kernel
.p2align 8
.type prep_kernel,@function
prep_kernel:
    s_load_dwordx2 s[4:5], s[0:1], 8
    s_load_dwordx2 s[6:7], s[0:1], 16
    s_load_dwordx2 s[8:9], s[0:1], 24
    s_load_dwordx2 s[10:11], s[0:1], 120
    s_load_dwordx2 s[12:13], s[0:1], 88
    s_load_dwordx2 s[14:15], s[0:1], 96
    s_load_dwordx2 s[16:17], s[0:1], 56
    s_load_dwordx2 s[18:19], s[0:1], 80
    s_mov_b32 s36, 0x05040100
    s_mov_b32 s37, 0x07060302
    s_waitcnt lgkmcnt(0)
    s_cmp_ge_u32 s2, 676
    s_cbranch_scc1 K0_end_4
    s_cmp_ge_u32 s2, 564
    s_cbranch_scc1 K0_wout_3
    s_cmp_ge_u32 s2, 340
    s_cbranch_scc1 K0_win_2
    s_cmp_ge_u32 s2, 256
    s_cbranch_scc1 K0_mod_1
    s_mov_b32 s20, s4
    s_mov_b32 s21, s5
    s_mov_b32 s22, 1835008
    s_mov_b32 s23, 0x00020000
    s_mov_b32 s24, s6
    s_mov_b32 s25, s7
    s_mov_b32 s26, 1835008
    s_mov_b32 s27, 0x00020000
    s_mov_b32 s28, s8
    s_mov_b32 s29, s9
    s_mov_b32 s30, 3584
    s_mov_b32 s31, 0x00020000
    s_add_u32 s32, s10, 65536
    s_addc_u32 s33, s11, 0
    s_mov_b32 s34, 1835008
    s_mov_b32 s35, 0x00020000
    v_cmp_gt_u32 vcc, 224, v0
    s_and_saveexec_b64 s[40:41], vcc
    s_cbranch_execz K0_end_4
    v_lshlrev_b32 v1, 2, v0
    s_mul_i32 s38, s2, 7168
    s_sub_u32 s38, s38, 2688
    v_add_u32 v2, s38, v1
    buffer_load_dword v10, v2, s[20:23], 0 offen
    s_add_u32 s38, s38, 896
    v_add_u32 v2, s38, v1
    buffer_load_dword v11, v2, s[20:23], 0 offen
    s_add_u32 s38, s38, 896
    v_add_u32 v2, s38, v1
    buffer_load_dword v12, v2, s[20:23], 0 offen
    s_add_u32 s38, s38, 896
    v_add_u32 v2, s38, v1
    buffer_load_dword v13, v2, s[20:23], 0 offen
    buffer_load_dword v21, v2, s[24:27], 0 offen
    s_add_u32 s38, s38, 896
    v_add_u32 v2, s38, v1
    buffer_load_dword v14, v2, s[20:23], 0 offen
    buffer_load_dword v22, v2, s[24:27], 0 offen
    s_add_u32 s38, s38, 896
    v_add_u32 v2, s38, v1
    buffer_load_dword v15, v2, s[20:23], 0 offen
    buffer_load_dword v23, v2, s[24:27], 0 offen
    s_add_u32 s38, s38, 896
    v_add_u32 v2, s38, v1
    buffer_load_dword v16, v2, s[20:23], 0 offen
    buffer_load_dword v24, v2, s[24:27], 0 offen
    s_add_u32 s38, s38, 896
    v_add_u32 v2, s38, v1
    buffer_load_dword v17, v2, s[20:23], 0 offen
    buffer_load_dword v25, v2, s[24:27], 0 offen
    s_add_u32 s38, s38, 896
    v_add_u32 v2, s38, v1
    buffer_load_dword v18, v2, s[20:23], 0 offen
    buffer_load_dword v26, v2, s[24:27], 0 offen
    s_add_u32 s38, s38, 896
    v_add_u32 v2, s38, v1
    buffer_load_dword v19, v2, s[20:23], 0 offen
    buffer_load_dword v27, v2, s[24:27], 0 offen
    s_add_u32 s38, s38, 896
    v_add_u32 v2, s38, v1
    buffer_load_dword v20, v2, s[20:23], 0 offen
    buffer_load_dword v28, v2, s[24:27], 0 offen
    s_add_u32 s38, s38, 896
    v_lshlrev_b32 v2, 4, v0
    buffer_load_dwordx4 v[30:33], v2, s[28:31], 0 offen
    s_waitcnt vmcnt(0)
    v_lshlrev_b32 v34, 16, v30
    v_and_b32 v35, 0xffff0000, v30
    v_lshlrev_b32 v36, 16, v31
    v_and_b32 v37, 0xffff0000, v31
    v_lshlrev_b32 v38, 16, v32
    v_and_b32 v39, 0xffff0000, v32
    v_lshlrev_b32 v40, 16, v33
    v_and_b32 v41, 0xffff0000, v33
    v_lshlrev_b32 v50, 16, v10
    v_and_b32 v61, 0xffff0000, v10
    v_lshlrev_b32 v51, 16, v11
    v_and_b32 v62, 0xffff0000, v11
    v_lshlrev_b32 v52, 16, v12
    v_and_b32 v63, 0xffff0000, v12
    v_lshlrev_b32 v53, 16, v13
    v_and_b32 v64, 0xffff0000, v13
    v_lshlrev_b32 v54, 16, v14
    v_and_b32 v65, 0xffff0000, v14
    v_lshlrev_b32 v55, 16, v15
    v_and_b32 v66, 0xffff0000, v15
    v_lshlrev_b32 v56, 16, v16
    v_and_b32 v67, 0xffff0000, v16
    v_lshlrev_b32 v57, 16, v17
    v_and_b32 v68, 0xffff0000, v17
    v_lshlrev_b32 v58, 16, v18
    v_and_b32 v69, 0xffff0000, v18
    v_lshlrev_b32 v59, 16, v19
    v_and_b32 v70, 0xffff0000, v19
    v_lshlrev_b32 v60, 16, v20
    v_and_b32 v71, 0xffff0000, v20
    v_lshlrev_b32 v72, 16, v21
    v_and_b32 v80, 0xffff0000, v21
    v_lshlrev_b32 v73, 16, v22
    v_and_b32 v81, 0xffff0000, v22
    v_lshlrev_b32 v74, 16, v23
    v_and_b32 v82, 0xffff0000, v23
    v_lshlrev_b32 v75, 16, v24
    v_and_b32 v83, 0xffff0000, v24
    v_lshlrev_b32 v76, 16, v25
    v_and_b32 v84, 0xffff0000, v25
    v_lshlrev_b32 v77, 16, v26
    v_and_b32 v85, 0xffff0000, v26
    v_lshlrev_b32 v78, 16, v27
    v_and_b32 v86, 0xffff0000, v27
    v_lshlrev_b32 v79, 16, v28
    v_and_b32 v87, 0xffff0000, v28
    v_mul_f32 v2, v50, v37
    v_mul_f32 v3, v61, v41
    v_cvt_pk_bf16_f32 v4, v2, v3
    v_lshlrev_b32 v5, 16, v4
    v_and_b32 v6, 0xffff0000, v4
    v_mul_f32 v2, v51, v36
    v_mul_f32 v3, v62, v40
    v_cvt_pk_bf16_f32 v4, v2, v3
    v_lshlrev_b32 v7, 16, v4
    v_and_b32 v8, 0xffff0000, v4
    v_add_f32 v5, v5, v7
    v_add_f32 v6, v6, v8
    v_cvt_pk_bf16_f32 v4, v5, v6
    v_lshlrev_b32 v5, 16, v4
    v_and_b32 v6, 0xffff0000, v4
    v_mul_f32 v2, v52, v35
    v_mul_f32 v3, v63, v39
    v_cvt_pk_bf16_f32 v4, v2, v3
    v_lshlrev_b32 v7, 16, v4
    v_and_b32 v8, 0xffff0000, v4
    v_add_f32 v5, v5, v7
    v_add_f32 v6, v6, v8
    v_cvt_pk_bf16_f32 v4, v5, v6
    v_lshlrev_b32 v5, 16, v4
    v_and_b32 v6, 0xffff0000, v4
    v_mul_f32 v2, v53, v34
    v_mul_f32 v3, v64, v38
    v_cvt_pk_bf16_f32 v4, v2, v3
    v_lshlrev_b32 v7, 16, v4
    v_and_b32 v8, 0xffff0000, v4
    v_add_f32 v5, v5, v7
    v_add_f32 v6, v6, v8
    v_cvt_pk_bf16_f32 v4, v5, v6
    v_lshlrev_b32 v5, 16, v4
    v_and_b32 v6, 0xffff0000, v4
    v_mul_f32 v2, v5, v72
    v_mul_f32 v3, v6, v80
    v_cvt_pk_bf16_f32 v90, v2, v3
    v_mul_f32 v2, v51, v37
    v_mul_f32 v3, v62, v41
    v_cvt_pk_bf16_f32 v4, v2, v3
    v_lshlrev_b32 v5, 16, v4
    v_and_b32 v6, 0xffff0000, v4
    v_mul_f32 v2, v52, v36
    v_mul_f32 v3, v63, v40
    v_cvt_pk_bf16_f32 v4, v2, v3
    v_lshlrev_b32 v7, 16, v4
    v_and_b32 v8, 0xffff0000, v4
    v_add_f32 v5, v5, v7
    v_add_f32 v6, v6, v8
    v_cvt_pk_bf16_f32 v4, v5, v6
    v_lshlrev_b32 v5, 16, v4
    v_and_b32 v6, 0xffff0000, v4
    v_mul_f32 v2, v53, v35
    v_mul_f32 v3, v64, v39
    v_cvt_pk_bf16_f32 v4, v2, v3
    v_lshlrev_b32 v7, 16, v4
    v_and_b32 v8, 0xffff0000, v4
    v_add_f32 v5, v5, v7
    v_add_f32 v6, v6, v8
    v_cvt_pk_bf16_f32 v4, v5, v6
    v_lshlrev_b32 v5, 16, v4
    v_and_b32 v6, 0xffff0000, v4
    v_mul_f32 v2, v54, v34
    v_mul_f32 v3, v65, v38
    v_cvt_pk_bf16_f32 v4, v2, v3
    v_lshlrev_b32 v7, 16, v4
    v_and_b32 v8, 0xffff0000, v4
    v_add_f32 v5, v5, v7
    v_add_f32 v6, v6, v8
    v_cvt_pk_bf16_f32 v4, v5, v6
    v_lshlrev_b32 v5, 16, v4
    v_and_b32 v6, 0xffff0000, v4
    v_mul_f32 v2, v5, v73
    v_mul_f32 v3, v6, v81
    v_cvt_pk_bf16_f32 v91, v2, v3
    v_mul_f32 v2, v52, v37
    v_mul_f32 v3, v63, v41
    v_cvt_pk_bf16_f32 v4, v2, v3
    v_lshlrev_b32 v5, 16, v4
    v_and_b32 v6, 0xffff0000, v4
    v_mul_f32 v2, v53, v36
    v_mul_f32 v3, v64, v40
    v_cvt_pk_bf16_f32 v4, v2, v3
    v_lshlrev_b32 v7, 16, v4
    v_and_b32 v8, 0xffff0000, v4
    v_add_f32 v5, v5, v7
    v_add_f32 v6, v6, v8
    v_cvt_pk_bf16_f32 v4, v5, v6
    v_lshlrev_b32 v5, 16, v4
    v_and_b32 v6, 0xffff0000, v4
    v_mul_f32 v2, v54, v35
    v_mul_f32 v3, v65, v39
    v_cvt_pk_bf16_f32 v4, v2, v3
    v_lshlrev_b32 v7, 16, v4
    v_and_b32 v8, 0xffff0000, v4
    v_add_f32 v5, v5, v7
    v_add_f32 v6, v6, v8
    v_cvt_pk_bf16_f32 v4, v5, v6
    v_lshlrev_b32 v5, 16, v4
    v_and_b32 v6, 0xffff0000, v4
    v_mul_f32 v2, v55, v34
    v_mul_f32 v3, v66, v38
    v_cvt_pk_bf16_f32 v4, v2, v3
    v_lshlrev_b32 v7, 16, v4
    v_and_b32 v8, 0xffff0000, v4
    v_add_f32 v5, v5, v7
    v_add_f32 v6, v6, v8
    v_cvt_pk_bf16_f32 v4, v5, v6
    v_lshlrev_b32 v5, 16, v4
    v_and_b32 v6, 0xffff0000, v4
    v_mul_f32 v2, v5, v74
    v_mul_f32 v3, v6, v82
    v_cvt_pk_bf16_f32 v92, v2, v3
    v_mul_f32 v2, v53, v37
    v_mul_f32 v3, v64, v41
    v_cvt_pk_bf16_f32 v4, v2, v3
    v_lshlrev_b32 v5, 16, v4
    v_and_b32 v6, 0xffff0000, v4
    v_mul_f32 v2, v54, v36
    v_mul_f32 v3, v65, v40
    v_cvt_pk_bf16_f32 v4, v2, v3
    v_lshlrev_b32 v7, 16, v4
    v_and_b32 v8, 0xffff0000, v4
    v_add_f32 v5, v5, v7
    v_add_f32 v6, v6, v8
    v_cvt_pk_bf16_f32 v4, v5, v6
    v_lshlrev_b32 v5, 16, v4
    v_and_b32 v6, 0xffff0000, v4
    v_mul_f32 v2, v55, v35
    v_mul_f32 v3, v66, v39
    v_cvt_pk_bf16_f32 v4, v2, v3
    v_lshlrev_b32 v7, 16, v4
    v_and_b32 v8, 0xffff0000, v4
    v_add_f32 v5, v5, v7
    v_add_f32 v6, v6, v8
    v_cvt_pk_bf16_f32 v4, v5, v6
    v_lshlrev_b32 v5, 16, v4
    v_and_b32 v6, 0xffff0000, v4
    v_mul_f32 v2, v56, v34
    v_mul_f32 v3, v67, v38
    v_cvt_pk_bf16_f32 v4, v2, v3
    v_lshlrev_b32 v7, 16, v4
    v_and_b32 v8, 0xffff0000, v4
    v_add_f32 v5, v5, v7
    v_add_f32 v6, v6, v8
    v_cvt_pk_bf16_f32 v4, v5, v6
    v_lshlrev_b32 v5, 16, v4
    v_and_b32 v6, 0xffff0000, v4
    v_mul_f32 v2, v5, v75
    v_mul_f32 v3, v6, v83
    v_cvt_pk_bf16_f32 v93, v2, v3
    v_mul_f32 v2, v54, v37
    v_mul_f32 v3, v65, v41
    v_cvt_pk_bf16_f32 v4, v2, v3
    v_lshlrev_b32 v5, 16, v4
    v_and_b32 v6, 0xffff0000, v4
    v_mul_f32 v2, v55, v36
    v_mul_f32 v3, v66, v40
    v_cvt_pk_bf16_f32 v4, v2, v3
    v_lshlrev_b32 v7, 16, v4
    v_and_b32 v8, 0xffff0000, v4
    v_add_f32 v5, v5, v7
    v_add_f32 v6, v6, v8
    v_cvt_pk_bf16_f32 v4, v5, v6
    v_lshlrev_b32 v5, 16, v4
    v_and_b32 v6, 0xffff0000, v4
    v_mul_f32 v2, v56, v35
    v_mul_f32 v3, v67, v39
    v_cvt_pk_bf16_f32 v4, v2, v3
    v_lshlrev_b32 v7, 16, v4
    v_and_b32 v8, 0xffff0000, v4
    v_add_f32 v5, v5, v7
    v_add_f32 v6, v6, v8
    v_cvt_pk_bf16_f32 v4, v5, v6
    v_lshlrev_b32 v5, 16, v4
    v_and_b32 v6, 0xffff0000, v4
    v_mul_f32 v2, v57, v34
    v_mul_f32 v3, v68, v38
    v_cvt_pk_bf16_f32 v4, v2, v3
    v_lshlrev_b32 v7, 16, v4
    v_and_b32 v8, 0xffff0000, v4
    v_add_f32 v5, v5, v7
    v_add_f32 v6, v6, v8
    v_cvt_pk_bf16_f32 v4, v5, v6
    v_lshlrev_b32 v5, 16, v4
    v_and_b32 v6, 0xffff0000, v4
    v_mul_f32 v2, v5, v76
    v_mul_f32 v3, v6, v84
    v_cvt_pk_bf16_f32 v94, v2, v3
    v_mul_f32 v2, v55, v37
    v_mul_f32 v3, v66, v41
    v_cvt_pk_bf16_f32 v4, v2, v3
    v_lshlrev_b32 v5, 16, v4
    v_and_b32 v6, 0xffff0000, v4
    v_mul_f32 v2, v56, v36
    v_mul_f32 v3, v67, v40
    v_cvt_pk_bf16_f32 v4, v2, v3
    v_lshlrev_b32 v7, 16, v4
    v_and_b32 v8, 0xffff0000, v4
    v_add_f32 v5, v5, v7
    v_add_f32 v6, v6, v8
    v_cvt_pk_bf16_f32 v4, v5, v6
    v_lshlrev_b32 v5, 16, v4
    v_and_b32 v6, 0xffff0000, v4
    v_mul_f32 v2, v57, v35
    v_mul_f32 v3, v68, v39
    v_cvt_pk_bf16_f32 v4, v2, v3
    v_lshlrev_b32 v7, 16, v4
    v_and_b32 v8, 0xffff0000, v4
    v_add_f32 v5, v5, v7
    v_add_f32 v6, v6, v8
    v_cvt_pk_bf16_f32 v4, v5, v6
    v_lshlrev_b32 v5, 16, v4
    v_and_b32 v6, 0xffff0000, v4
    v_mul_f32 v2, v58, v34
    v_mul_f32 v3, v69, v38
    v_cvt_pk_bf16_f32 v4, v2, v3
    v_lshlrev_b32 v7, 16, v4
    v_and_b32 v8, 0xffff0000, v4
    v_add_f32 v5, v5, v7
    v_add_f32 v6, v6, v8
    v_cvt_pk_bf16_f32 v4, v5, v6
    v_lshlrev_b32 v5, 16, v4
    v_and_b32 v6, 0xffff0000, v4
    v_mul_f32 v2, v5, v77
    v_mul_f32 v3, v6, v85
    v_cvt_pk_bf16_f32 v95, v2, v3
    v_mul_f32 v2, v56, v37
    v_mul_f32 v3, v67, v41
    v_cvt_pk_bf16_f32 v4, v2, v3
    v_lshlrev_b32 v5, 16, v4
    v_and_b32 v6, 0xffff0000, v4
    v_mul_f32 v2, v57, v36
    v_mul_f32 v3, v68, v40
    v_cvt_pk_bf16_f32 v4, v2, v3
    v_lshlrev_b32 v7, 16, v4
    v_and_b32 v8, 0xffff0000, v4
    v_add_f32 v5, v5, v7
    v_add_f32 v6, v6, v8
    v_cvt_pk_bf16_f32 v4, v5, v6
    v_lshlrev_b32 v5, 16, v4
    v_and_b32 v6, 0xffff0000, v4
    v_mul_f32 v2, v58, v35
    v_mul_f32 v3, v69, v39
    v_cvt_pk_bf16_f32 v4, v2, v3
    v_lshlrev_b32 v7, 16, v4
    v_and_b32 v8, 0xffff0000, v4
    v_add_f32 v5, v5, v7
    v_add_f32 v6, v6, v8
    v_cvt_pk_bf16_f32 v4, v5, v6
    v_lshlrev_b32 v5, 16, v4
    v_and_b32 v6, 0xffff0000, v4
    v_mul_f32 v2, v59, v34
    v_mul_f32 v3, v70, v38
    v_cvt_pk_bf16_f32 v4, v2, v3
    v_lshlrev_b32 v7, 16, v4
    v_and_b32 v8, 0xffff0000, v4
    v_add_f32 v5, v5, v7
    v_add_f32 v6, v6, v8
    v_cvt_pk_bf16_f32 v4, v5, v6
    v_lshlrev_b32 v5, 16, v4
    v_and_b32 v6, 0xffff0000, v4
    v_mul_f32 v2, v5, v78
    v_mul_f32 v3, v6, v86
    v_cvt_pk_bf16_f32 v96, v2, v3
    v_mul_f32 v2, v57, v37
    v_mul_f32 v3, v68, v41
    v_cvt_pk_bf16_f32 v4, v2, v3
    v_lshlrev_b32 v5, 16, v4
    v_and_b32 v6, 0xffff0000, v4
    v_mul_f32 v2, v58, v36
    v_mul_f32 v3, v69, v40
    v_cvt_pk_bf16_f32 v4, v2, v3
    v_lshlrev_b32 v7, 16, v4
    v_and_b32 v8, 0xffff0000, v4
    v_add_f32 v5, v5, v7
    v_add_f32 v6, v6, v8
    v_cvt_pk_bf16_f32 v4, v5, v6
    v_lshlrev_b32 v5, 16, v4
    v_and_b32 v6, 0xffff0000, v4
    v_mul_f32 v2, v59, v35
    v_mul_f32 v3, v70, v39
    v_cvt_pk_bf16_f32 v4, v2, v3
    v_lshlrev_b32 v7, 16, v4
    v_and_b32 v8, 0xffff0000, v4
    v_add_f32 v5, v5, v7
    v_add_f32 v6, v6, v8
    v_cvt_pk_bf16_f32 v4, v5, v6
    v_lshlrev_b32 v5, 16, v4
    v_and_b32 v6, 0xffff0000, v4
    v_mul_f32 v2, v60, v34
    v_mul_f32 v3, v71, v38
    v_cvt_pk_bf16_f32 v4, v2, v3
    v_lshlrev_b32 v7, 16, v4
    v_and_b32 v8, 0xffff0000, v4
    v_add_f32 v5, v5, v7
    v_add_f32 v6, v6, v8
    v_cvt_pk_bf16_f32 v4, v5, v6
    v_lshlrev_b32 v5, 16, v4
    v_and_b32 v6, 0xffff0000, v4
    v_mul_f32 v2, v5, v79
    v_mul_f32 v3, v6, v87
    v_cvt_pk_bf16_f32 v97, v2, v3
    v_perm_b32 v100, v91, v90, s36
    v_perm_b32 v104, v91, v90, s37
    v_perm_b32 v101, v93, v92, s36
    v_perm_b32 v105, v93, v92, s37
    v_perm_b32 v102, v95, v94, s36
    v_perm_b32 v106, v95, v94, s37
    v_perm_b32 v103, v97, v96, s36
    v_perm_b32 v107, v97, v96, s37
    v_lshlrev_b32 v2, 13, v0
    s_lshl_b32 s39, s2, 4
    v_add_u32 v2, s39, v2
    buffer_store_dwordx4 v[100:103], v2, s[32:35], 0 offen
    v_add_u32 v3, 4096, v2
    buffer_store_dwordx4 v[104:107], v3, s[32:35], 0 offen
    s_branch K0_end_4
K0_mod_1:
    s_mov_b32 s20, s12
    s_mov_b32 s21, s13
    s_mov_b32 s22, 896
    s_mov_b32 s23, 0x00020000
    s_mov_b32 s24, s14
    s_mov_b32 s25, s15
    s_mov_b32 s26, 2408448
    s_mov_b32 s27, 0x00020000
    s_mov_b32 s32, s10
    s_mov_b32 s33, s11
    s_mov_b32 s34, 10752
    s_mov_b32 s35, 0x00020000
    s_sub_u32 s38, s2, 256
    s_lshl_b32 s38, s38, 6
    v_lshrrev_b32 v1, 4, v0
    v_and_b32 v2, 15, v0
    v_mul_u32_u24 v3, 56, v1
    buffer_load_dword v10, v3, s[20:23], 0 offen offset:0
    buffer_load_dword v11, v3, s[20:23], 0 offen offset:4
    buffer_load_dword v12, v3, s[20:23], 0 offen offset:8
    buffer_load_dword v13, v3, s[20:23], 0 offen offset:12
    buffer_load_dword v14, v3, s[20:23], 0 offen offset:16
    buffer_load_dword v15, v3, s[20:23], 0 offen offset:20
    buffer_load_dword v16, v3, s[20:23], 0 offen offset:24
    buffer_load_dword v17, v3, s[20:23], 0 offen offset:28
    buffer_load_dword v18, v3, s[20:23], 0 offen offset:32
    buffer_load_dword v19, v3, s[20:23], 0 offen offset:36
    buffer_load_dword v20, v3, s[20:23], 0 offen offset:40
    buffer_load_dword v21, v3, s[20:23], 0 offen offset:44
    buffer_load_dword v22, v3, s[20:23], 0 offen offset:48
    buffer_load_dword v23, v3, s[20:23], 0 offen offset:52
    s_mov_b32 s39, 150528
    v_mul_lo_u32 v4, v1, s39
    v_lshlrev_b32 v5, 2, v2
    v_add_u32 v4, v4, v5
    v_add_u32 v4, s38, v4
    buffer_load_dword v30, v4, s[24:27], 0 offen
    v_add_u32 v4, 5376, v4
    buffer_load_dword v31, v4, s[24:27], 0 offen
    v_add_u32 v4, 5376, v4
    buffer_load_dword v32, v4, s[24:27], 0 offen
    v_add_u32 v4, 5376, v4
    buffer_load_dword v33, v4, s[24:27], 0 offen
    v_add_u32 v4, 5376, v4
    buffer_load_dword v34, v4, s[24:27], 0 offen
    v_add_u32 v4, 5376, v4
    buffer_load_dword v35, v4, s[24:27], 0 offen
    v_add_u32 v4, 5376, v4
    buffer_load_dword v36, v4, s[24:27], 0 offen
    v_add_u32 v4, 5376, v4
    buffer_load_dword v37, v4, s[24:27], 0 offen
    v_add_u32 v4, 5376, v4
    buffer_load_dword v38, v4, s[24:27], 0 offen
    v_add_u32 v4, 5376, v4
    buffer_load_dword v39, v4, s[24:27], 0 offen
    v_add_u32 v4, 5376, v4
    buffer_load_dword v40, v4, s[24:27], 0 offen
    v_add_u32 v4, 5376, v4
    buffer_load_dword v41, v4, s[24:27], 0 offen
    v_add_u32 v4, 5376, v4
    buffer_load_dword v42, v4, s[24:27], 0 offen
    v_add_u32 v4, 5376, v4
    buffer_load_dword v43, v4, s[24:27], 0 offen
    v_add_u32 v4, 5376, v4
    buffer_load_dword v44, v4, s[24:27], 0 offen
    v_add_u32 v4, 5376, v4
    buffer_load_dword v45, v4, s[24:27], 0 offen
    v_add_u32 v4, 5376, v4
    buffer_load_dword v46, v4, s[24:27], 0 offen
    v_add_u32 v4, 5376, v4
    buffer_load_dword v47, v4, s[24:27], 0 offen
    v_add_u32 v4, 5376, v4
    buffer_load_dword v48, v4, s[24:27], 0 offen
    v_add_u32 v4, 5376, v4
    buffer_load_dword v49, v4, s[24:27], 0 offen
    v_add_u32 v4, 5376, v4
    buffer_load_dword v50, v4, s[24:27], 0 offen
    v_add_u32 v4, 5376, v4
    buffer_load_dword v51, v4, s[24:27], 0 offen
    v_add_u32 v4, 5376, v4
    buffer_load_dword v52, v4, s[24:27], 0 offen
    v_add_u32 v4, 5376, v4
    buffer_load_dword v53, v4, s[24:27], 0 offen
    v_add_u32 v4, 5376, v4
    buffer_load_dword v54, v4, s[24:27], 0 offen
    v_add_u32 v4, 5376, v4
    buffer_load_dword v55, v4, s[24:27], 0 offen
    v_add_u32 v4, 5376, v4
    buffer_load_dword v56, v4, s[24:27], 0 offen
    v_add_u32 v4, 5376, v4
    buffer_load_dword v57, v4, s[24:27], 0 offen
    s_waitcnt vmcnt(28)
    v_lshlrev_b32 v60, 16, v10
    v_mul_f32 v5, 0xbfb8aa3b, v60
    v_exp_f32 v5, v5
    s_nop 0
    v_add_f32 v5, 1.0, v5
    v_rcp_f32 v6, v5
    s_nop 0
    v_mul_f32 v7, v60, v6
    v_fma_f32 v8, -v7, v5, v60
    v_fma_f32 v7, v8, v6, v7
    v_cvt_pk_bf16_f32 v7, v7, v7
    v_lshlrev_b32 v60, 16, v7
    v_and_b32 v61, 0xffff0000, v10
    v_mul_f32 v5, 0xbfb8aa3b, v61
    v_exp_f32 v5, v5
    s_nop 0
    v_add_f32 v5, 1.0, v5
    v_rcp_f32 v6, v5
    s_nop 0
    v_mul_f32 v7, v61, v6
    v_fma_f32 v8, -v7, v5, v61
    v_fma_f32 v7, v8, v6, v7
    v_cvt_pk_bf16_f32 v7, v7, v7
    v_lshlrev_b32 v61, 16, v7
    v_lshlrev_b32 v62, 16, v11
    v_mul_f32 v5, 0xbfb8aa3b, v62
    v_exp_f32 v5, v5
    s_nop 0
    v_add_f32 v5, 1.0, v5
    v_rcp_f32 v6, v5
    s_nop 0
    v_mul_f32 v7, v62, v6
    v_fma_f32 v8, -v7, v5, v62
    v_fma_f32 v7, v8, v6, v7
    v_cvt_pk_bf16_f32 v7, v7, v7
    v_lshlrev_b32 v62, 16, v7
    v_and_b32 v63, 0xffff0000, v11
    v_mul_f32 v5, 0xbfb8aa3b, v63
    v_exp_f32 v5, v5
    s_nop 0
    v_add_f32 v5, 1.0, v5
    v_rcp_f32 v6, v5
    s_nop 0
    v_mul_f32 v7, v63, v6
    v_fma_f32 v8, -v7, v5, v63
    v_fma_f32 v7, v8, v6, v7
    v_cvt_pk_bf16_f32 v7, v7, v7
    v_lshlrev_b32 v63, 16, v7
    v_lshlrev_b32 v64, 16, v12
    v_mul_f32 v5, 0xbfb8aa3b, v64
    v_exp_f32 v5, v5
    s_nop 0
    v_add_f32 v5, 1.0, v5
    v_rcp_f32 v6, v5
    s_nop 0
    v_mul_f32 v7, v64, v6
    v_fma_f32 v8, -v7, v5, v64
    v_fma_f32 v7, v8, v6, v7
    v_cvt_pk_bf16_f32 v7, v7, v7
    v_lshlrev_b32 v64, 16, v7
    v_and_b32 v65, 0xffff0000, v12
    v_mul_f32 v5, 0xbfb8aa3b, v65
    v_exp_f32 v5, v5
    s_nop 0
    v_add_f32 v5, 1.0, v5
    v_rcp_f32 v6, v5
    s_nop 0
    v_mul_f32 v7, v65, v6
    v_fma_f32 v8, -v7, v5, v65
    v_fma_f32 v7, v8, v6, v7
    v_cvt_pk_bf16_f32 v7, v7, v7
    v_lshlrev_b32 v65, 16, v7
    v_lshlrev_b32 v66, 16, v13
    v_mul_f32 v5, 0xbfb8aa3b, v66
    v_exp_f32 v5, v5
    s_nop 0
    v_add_f32 v5, 1.0, v5
    v_rcp_f32 v6, v5
    s_nop 0
    v_mul_f32 v7, v66, v6
    v_fma_f32 v8, -v7, v5, v66
    v_fma_f32 v7, v8, v6, v7
    v_cvt_pk_bf16_f32 v7, v7, v7
    v_lshlrev_b32 v66, 16, v7
    v_and_b32 v67, 0xffff0000, v13
    v_mul_f32 v5, 0xbfb8aa3b, v67
    v_exp_f32 v5, v5
    s_nop 0
    v_add_f32 v5, 1.0, v5
    v_rcp_f32 v6, v5
    s_nop 0
    v_mul_f32 v7, v67, v6
    v_fma_f32 v8, -v7, v5, v67
    v_fma_f32 v7, v8, v6, v7
    v_cvt_pk_bf16_f32 v7, v7, v7
    v_lshlrev_b32 v67, 16, v7
    v_lshlrev_b32 v68, 16, v14
    v_mul_f32 v5, 0xbfb8aa3b, v68
    v_exp_f32 v5, v5
    s_nop 0
    v_add_f32 v5, 1.0, v5
    v_rcp_f32 v6, v5
    s_nop 0
    v_mul_f32 v7, v68, v6
    v_fma_f32 v8, -v7, v5, v68
    v_fma_f32 v7, v8, v6, v7
    v_cvt_pk_bf16_f32 v7, v7, v7
    v_lshlrev_b32 v68, 16, v7
    v_and_b32 v69, 0xffff0000, v14
    v_mul_f32 v5, 0xbfb8aa3b, v69
    v_exp_f32 v5, v5
    s_nop 0
    v_add_f32 v5, 1.0, v5
    v_rcp_f32 v6, v5
    s_nop 0
    v_mul_f32 v7, v69, v6
    v_fma_f32 v8, -v7, v5, v69
    v_fma_f32 v7, v8, v6, v7
    v_cvt_pk_bf16_f32 v7, v7, v7
    v_lshlrev_b32 v69, 16, v7
    v_lshlrev_b32 v70, 16, v15
    v_mul_f32 v5, 0xbfb8aa3b, v70
    v_exp_f32 v5, v5
    s_nop 0
    v_add_f32 v5, 1.0, v5
    v_rcp_f32 v6, v5
    s_nop 0
    v_mul_f32 v7, v70, v6
    v_fma_f32 v8, -v7, v5, v70
    v_fma_f32 v7, v8, v6, v7
    v_cvt_pk_bf16_f32 v7, v7, v7
    v_lshlrev_b32 v70, 16, v7
    v_and_b32 v71, 0xffff0000, v15
    v_mul_f32 v5, 0xbfb8aa3b, v71
    v_exp_f32 v5, v5
    s_nop 0
    v_add_f32 v5, 1.0, v5
    v_rcp_f32 v6, v5
    s_nop 0
    v_mul_f32 v7, v71, v6
    v_fma_f32 v8, -v7, v5, v71
    v_fma_f32 v7, v8, v6, v7
    v_cvt_pk_bf16_f32 v7, v7, v7
    v_lshlrev_b32 v71, 16, v7
    v_lshlrev_b32 v72, 16, v16
    v_mul_f32 v5, 0xbfb8aa3b, v72
    v_exp_f32 v5, v5
    s_nop 0
    v_add_f32 v5, 1.0, v5
    v_rcp_f32 v6, v5
    s_nop 0
    v_mul_f32 v7, v72, v6
    v_fma_f32 v8, -v7, v5, v72
    v_fma_f32 v7, v8, v6, v7
    v_cvt_pk_bf16_f32 v7, v7, v7
    v_lshlrev_b32 v72, 16, v7
    v_and_b32 v73, 0xffff0000, v16
    v_mul_f32 v5, 0xbfb8aa3b, v73
    v_exp_f32 v5, v5
    s_nop 0
    v_add_f32 v5, 1.0, v5
    v_rcp_f32 v6, v5
    s_nop 0
    v_mul_f32 v7, v73, v6
    v_fma_f32 v8, -v7, v5, v73
    v_fma_f32 v7, v8, v6, v7
    v_cvt_pk_bf16_f32 v7, v7, v7
    v_lshlrev_b32 v73, 16, v7
    v_lshlrev_b32 v74, 16, v17
    v_mul_f32 v5, 0xbfb8aa3b, v74
    v_exp_f32 v5, v5
    s_nop 0
    v_add_f32 v5, 1.0, v5
    v_rcp_f32 v6, v5
    s_nop 0
    v_mul_f32 v7, v74, v6
    v_fma_f32 v8, -v7, v5, v74
    v_fma_f32 v7, v8, v6, v7
    v_cvt_pk_bf16_f32 v7, v7, v7
    v_lshlrev_b32 v74, 16, v7
    v_and_b32 v75, 0xffff0000, v17
    v_mul_f32 v5, 0xbfb8aa3b, v75
    v_exp_f32 v5, v5
    s_nop 0
    v_add_f32 v5, 1.0, v5
    v_rcp_f32 v6, v5
    s_nop 0
    v_mul_f32 v7, v75, v6
    v_fma_f32 v8, -v7, v5, v75
    v_fma_f32 v7, v8, v6, v7
    v_cvt_pk_bf16_f32 v7, v7, v7
    v_lshlrev_b32 v75, 16, v7
    v_lshlrev_b32 v76, 16, v18
    v_mul_f32 v5, 0xbfb8aa3b, v76
    v_exp_f32 v5, v5
    s_nop 0
    v_add_f32 v5, 1.0, v5
    v_rcp_f32 v6, v5
    s_nop 0
    v_mul_f32 v7, v76, v6
    v_fma_f32 v8, -v7, v5, v76
    v_fma_f32 v7, v8, v6, v7
    v_cvt_pk_bf16_f32 v7, v7, v7
    v_lshlrev_b32 v76, 16, v7
    v_and_b32 v77, 0xffff0000, v18
    v_mul_f32 v5, 0xbfb8aa3b, v77
    v_exp_f32 v5, v5
    s_nop 0
    v_add_f32 v5, 1.0, v5
    v_rcp_f32 v6, v5
    s_nop 0
    v_mul_f32 v7, v77, v6
    v_fma_f32 v8, -v7, v5, v77
    v_fma_f32 v7, v8, v6, v7
    v_cvt_pk_bf16_f32 v7, v7, v7
    v_lshlrev_b32 v77, 16, v7
    v_lshlrev_b32 v78, 16, v19
    v_mul_f32 v5, 0xbfb8aa3b, v78
    v_exp_f32 v5, v5
    s_nop 0
    v_add_f32 v5, 1.0, v5
    v_rcp_f32 v6, v5
    s_nop 0
    v_mul_f32 v7, v78, v6
    v_fma_f32 v8, -v7, v5, v78
    v_fma_f32 v7, v8, v6, v7
    v_cvt_pk_bf16_f32 v7, v7, v7
    v_lshlrev_b32 v78, 16, v7
    v_and_b32 v79, 0xffff0000, v19
    v_mul_f32 v5, 0xbfb8aa3b, v79
    v_exp_f32 v5, v5
    s_nop 0
    v_add_f32 v5, 1.0, v5
    v_rcp_f32 v6, v5
    s_nop 0
    v_mul_f32 v7, v79, v6
    v_fma_f32 v8, -v7, v5, v79
    v_fma_f32 v7, v8, v6, v7
    v_cvt_pk_bf16_f32 v7, v7, v7
    v_lshlrev_b32 v79, 16, v7
    v_lshlrev_b32 v80, 16, v20
    v_mul_f32 v5, 0xbfb8aa3b, v80
    v_exp_f32 v5, v5
    s_nop 0
    v_add_f32 v5, 1.0, v5
    v_rcp_f32 v6, v5
    s_nop 0
    v_mul_f32 v7, v80, v6
    v_fma_f32 v8, -v7, v5, v80
    v_fma_f32 v7, v8, v6, v7
    v_cvt_pk_bf16_f32 v7, v7, v7
    v_lshlrev_b32 v80, 16, v7
    v_and_b32 v81, 0xffff0000, v20
    v_mul_f32 v5, 0xbfb8aa3b, v81
    v_exp_f32 v5, v5
    s_nop 0
    v_add_f32 v5, 1.0, v5
    v_rcp_f32 v6, v5
    s_nop 0
    v_mul_f32 v7, v81, v6
    v_fma_f32 v8, -v7, v5, v81
    v_fma_f32 v7, v8, v6, v7
    v_cvt_pk_bf16_f32 v7, v7, v7
    v_lshlrev_b32 v81, 16, v7
    v_lshlrev_b32 v82, 16, v21
    v_mul_f32 v5, 0xbfb8aa3b, v82
    v_exp_f32 v5, v5
    s_nop 0
    v_add_f32 v5, 1.0, v5
    v_rcp_f32 v6, v5
    s_nop 0
    v_mul_f32 v7, v82, v6
    v_fma_f32 v8, -v7, v5, v82
    v_fma_f32 v7, v8, v6, v7
    v_cvt_pk_bf16_f32 v7, v7, v7
    v_lshlrev_b32 v82, 16, v7
    v_and_b32 v83, 0xffff0000, v21
    v_mul_f32 v5, 0xbfb8aa3b, v83
    v_exp_f32 v5, v5
    s_nop 0
    v_add_f32 v5, 1.0, v5
    v_rcp_f32 v6, v5
    s_nop 0
    v_mul_f32 v7, v83, v6
    v_fma_f32 v8, -v7, v5, v83
    v_fma_f32 v7, v8, v6, v7
    v_cvt_pk_bf16_f32 v7, v7, v7
    v_lshlrev_b32 v83, 16, v7
    v_lshlrev_b32 v84, 16, v22
    v_mul_f32 v5, 0xbfb8aa3b, v84
    v_exp_f32 v5, v5
    s_nop 0
    v_add_f32 v5, 1.0, v5
    v_rcp_f32 v6, v5
    s_nop 0
    v_mul_f32 v7, v84, v6
    v_fma_f32 v8, -v7, v5, v84
    v_fma_f32 v7, v8, v6, v7
    v_cvt_pk_bf16_f32 v7, v7, v7
    v_lshlrev_b32 v84, 16, v7
    v_and_b32 v85, 0xffff0000, v22
    v_mul_f32 v5, 0xbfb8aa3b, v85
    v_exp_f32 v5, v5
    s_nop 0
    v_add_f32 v5, 1.0, v5
    v_rcp_f32 v6, v5
    s_nop 0
    v_mul_f32 v7, v85, v6
    v_fma_f32 v8, -v7, v5, v85
    v_fma_f32 v7, v8, v6, v7
    v_cvt_pk_bf16_f32 v7, v7, v7
    v_lshlrev_b32 v85, 16, v7
    v_lshlrev_b32 v86, 16, v23
    v_mul_f32 v5, 0xbfb8aa3b, v86
    v_exp_f32 v5, v5
    s_nop 0
    v_add_f32 v5, 1.0, v5
    v_rcp_f32 v6, v5
    s_nop 0
    v_mul_f32 v7, v86, v6
    v_fma_f32 v8, -v7, v5, v86
    v_fma_f32 v7, v8, v6, v7
    v_cvt_pk_bf16_f32 v7, v7, v7
    v_lshlrev_b32 v86, 16, v7
    v_and_b32 v87, 0xffff0000, v23
    v_mul_f32 v5, 0xbfb8aa3b, v87
    v_exp_f32 v5, v5
    s_nop 0
    v_add_f32 v5, 1.0, v5
    v_rcp_f32 v6, v5
    s_nop 0
    v_mul_f32 v7, v87, v6
    v_fma_f32 v8, -v7, v5, v87
    v_fma_f32 v7, v8, v6, v7
    v_cvt_pk_bf16_f32 v7, v7, v7
    v_lshlrev_b32 v87, 16, v7
    s_waitcnt vmcnt(0)
    v_mov_b32 v88, 0
    v_mov_b32 v89, 0
    v_lshlrev_b32 v7, 16, v30
    v_and_b32 v8, 0xffff0000, v30
    v_fmac_f32 v88, v60, v7
    v_fmac_f32 v89, v60, v8
    v_lshlrev_b32 v7, 16, v31
    v_and_b32 v8, 0xffff0000, v31
    v_fmac_f32 v88, v61, v7
    v_fmac_f32 v89, v61, v8
    v_lshlrev_b32 v7, 16, v32
    v_and_b32 v8, 0xffff0000, v32
    v_fmac_f32 v88, v62, v7
    v_fmac_f32 v89, v62, v8
    v_lshlrev_b32 v7, 16, v33
    v_and_b32 v8, 0xffff0000, v33
    v_fmac_f32 v88, v63, v7
    v_fmac_f32 v89, v63, v8
    v_lshlrev_b32 v7, 16, v34
    v_and_b32 v8, 0xffff0000, v34
    v_fmac_f32 v88, v64, v7
    v_fmac_f32 v89, v64, v8
    v_lshlrev_b32 v7, 16, v35
    v_and_b32 v8, 0xffff0000, v35
    v_fmac_f32 v88, v65, v7
    v_fmac_f32 v89, v65, v8
    v_lshlrev_b32 v7, 16, v36
    v_and_b32 v8, 0xffff0000, v36
    v_fmac_f32 v88, v66, v7
    v_fmac_f32 v89, v66, v8
    v_lshlrev_b32 v7, 16, v37
    v_and_b32 v8, 0xffff0000, v37
    v_fmac_f32 v88, v67, v7
    v_fmac_f32 v89, v67, v8
    v_lshlrev_b32 v7, 16, v38
    v_and_b32 v8, 0xffff0000, v38
    v_fmac_f32 v88, v68, v7
    v_fmac_f32 v89, v68, v8
    v_lshlrev_b32 v7, 16, v39
    v_and_b32 v8, 0xffff0000, v39
    v_fmac_f32 v88, v69, v7
    v_fmac_f32 v89, v69, v8
    v_lshlrev_b32 v7, 16, v40
    v_and_b32 v8, 0xffff0000, v40
    v_fmac_f32 v88, v70, v7
    v_fmac_f32 v89, v70, v8
    v_lshlrev_b32 v7, 16, v41
    v_and_b32 v8, 0xffff0000, v41
    v_fmac_f32 v88, v71, v7
    v_fmac_f32 v89, v71, v8
    v_lshlrev_b32 v7, 16, v42
    v_and_b32 v8, 0xffff0000, v42
    v_fmac_f32 v88, v72, v7
    v_fmac_f32 v89, v72, v8
    v_lshlrev_b32 v7, 16, v43
    v_and_b32 v8, 0xffff0000, v43
    v_fmac_f32 v88, v73, v7
    v_fmac_f32 v89, v73, v8
    v_lshlrev_b32 v7, 16, v44
    v_and_b32 v8, 0xffff0000, v44
    v_fmac_f32 v88, v74, v7
    v_fmac_f32 v89, v74, v8
    v_lshlrev_b32 v7, 16, v45
    v_and_b32 v8, 0xffff0000, v45
    v_fmac_f32 v88, v75, v7
    v_fmac_f32 v89, v75, v8
    v_lshlrev_b32 v7, 16, v46
    v_and_b32 v8, 0xffff0000, v46
    v_fmac_f32 v88, v76, v7
    v_fmac_f32 v89, v76, v8
    v_lshlrev_b32 v7, 16, v47
    v_and_b32 v8, 0xffff0000, v47
    v_fmac_f32 v88, v77, v7
    v_fmac_f32 v89, v77, v8
    v_lshlrev_b32 v7, 16, v48
    v_and_b32 v8, 0xffff0000, v48
    v_fmac_f32 v88, v78, v7
    v_fmac_f32 v89, v78, v8
    v_lshlrev_b32 v7, 16, v49
    v_and_b32 v8, 0xffff0000, v49
    v_fmac_f32 v88, v79, v7
    v_fmac_f32 v89, v79, v8
    v_lshlrev_b32 v7, 16, v50
    v_and_b32 v8, 0xffff0000, v50
    v_fmac_f32 v88, v80, v7
    v_fmac_f32 v89, v80, v8
    v_lshlrev_b32 v7, 16, v51
    v_and_b32 v8, 0xffff0000, v51
    v_fmac_f32 v88, v81, v7
    v_fmac_f32 v89, v81, v8
    v_lshlrev_b32 v7, 16, v52
    v_and_b32 v8, 0xffff0000, v52
    v_fmac_f32 v88, v82, v7
    v_fmac_f32 v89, v82, v8
    v_lshlrev_b32 v7, 16, v53
    v_and_b32 v8, 0xffff0000, v53
    v_fmac_f32 v88, v83, v7
    v_fmac_f32 v89, v83, v8
    v_lshlrev_b32 v7, 16, v54
    v_and_b32 v8, 0xffff0000, v54
    v_fmac_f32 v88, v84, v7
    v_fmac_f32 v89, v84, v8
    v_lshlrev_b32 v7, 16, v55
    v_and_b32 v8, 0xffff0000, v55
    v_fmac_f32 v88, v85, v7
    v_fmac_f32 v89, v85, v8
    v_lshlrev_b32 v7, 16, v56
    v_and_b32 v8, 0xffff0000, v56
    v_fmac_f32 v88, v86, v7
    v_fmac_f32 v89, v86, v8
    v_lshlrev_b32 v7, 16, v57
    v_and_b32 v8, 0xffff0000, v57
    v_fmac_f32 v88, v87, v7
    v_fmac_f32 v89, v87, v8
    v_lshlrev_b32 v7, 7, v1
    v_lshlrev_b32 v8, 3, v2
    v_add_u32 v7, v7, v8
    ds_write_b64 v7, v[88:89]
    s_waitcnt lgkmcnt(0)
    s_barrier
    v_cmp_gt_u32 vcc, 32, v0
    s_and_saveexec_b64 s[40:41], vcc
    s_cbranch_execz K0_end_4
    v_lshlrev_b32 v7, 2, v0
    ds_read_b32 v10, v7 offset:0
    ds_read_b32 v11, v7 offset:128
    ds_read_b32 v12, v7 offset:256
    ds_read_b32 v13, v7 offset:384
    ds_read_b32 v14, v7 offset:512
    ds_read_b32 v15, v7 offset:640
    ds_read_b32 v16, v7 offset:768
    ds_read_b32 v17, v7 offset:896
    ds_read_b32 v18, v7 offset:1024
    ds_read_b32 v19, v7 offset:1152
    ds_read_b32 v20, v7 offset:1280
    ds_read_b32 v21, v7 offset:1408
    ds_read_b32 v22, v7 offset:1536
    ds_read_b32 v23, v7 offset:1664
    ds_read_b32 v24, v7 offset:1792
    ds_read_b32 v25, v7 offset:1920
    s_waitcnt lgkmcnt(0)
    v_add_f32 v10, v10, v11
    v_add_f32 v10, v10, v12
    v_add_f32 v10, v10, v13
    v_add_f32 v10, v10, v14
    v_add_f32 v10, v10, v15
    v_add_f32 v10, v10, v16
    v_add_f32 v10, v10, v17
    v_add_f32 v10, v10, v18
    v_add_f32 v10, v10, v19
    v_add_f32 v10, v10, v20
    v_add_f32 v10, v10, v21
    v_add_f32 v10, v10, v22
    v_add_f32 v10, v10, v23
    v_add_f32 v10, v10, v24
    v_add_f32 v10, v10, v25
    v_cvt_pk_bf16_f32 v10, v10, v10
    v_lshlrev_b32 v10, 16, v10
    s_lshl_b32 s38, s38, 1
    v_add_u32 v7, s38, v7
    buffer_store_dword v10, v7, s[32:35], 0 offen
    s_branch K0_end_4
K0_win_2:
    s_mov_b32 s20, s16
    s_mov_b32 s21, s17
    s_mov_b32 s22, 1605632
    s_mov_b32 s23, 0x00020000
    s_add_u32 s32, s10, 6356992
    s_addc_u32 s33, s11, 0
    s_mov_b32 s34, 1605632
    s_mov_b32 s35, 0x00020000
    v_cmp_gt_u32 vcc, 224, v0
    s_and_saveexec_b64 s[40:41], vcc
    s_cbranch_execz K0_end_4
    s_sub_u32 s38, s2, 340
    s_lshr_b32 s39, s38, 2
    s_and_b32 s38, s38, 3
    s_mul_i32 s42, s39, 28672
    s_mul_i32 s43, s38, 896
    s_add_u32 s42, s42, s43
    v_lshlrev_b32 v1, 2, v0
    v_add_u32 v1, s42, v1
    buffer_load_dword v10, v1, s[20:23], 0 offen
    v_add_u32 v1, 3584, v1
    buffer_load_dword v11, v1, s[20:23], 0 offen
    v_add_u32 v1, 3584, v1
    buffer_load_dword v12, v1, s[20:23], 0 offen
    v_add_u32 v1, 3584, v1
    buffer_load_dword v13, v1, s[20:23], 0 offen
    v_add_u32 v1, 3584, v1
    buffer_load_dword v14, v1, s[20:23], 0 offen
    v_add_u32 v1, 3584, v1
    buffer_load_dword v15, v1, s[20:23], 0 offen
    v_add_u32 v1, 3584, v1
    buffer_load_dword v16, v1, s[20:23], 0 offen
    v_add_u32 v1, 3584, v1
    buffer_load_dword v17, v1, s[20:23], 0 offen
    s_waitcnt vmcnt(0)
    v_perm_b32 v20, v11, v10, s36
    v_perm_b32 v24, v11, v10, s37
    v_perm_b32 v21, v13, v12, s36
    v_perm_b32 v25, v13, v12, s37
    v_perm_b32 v22, v15, v14, s36
    v_perm_b32 v26, v15, v14, s37
    v_perm_b32 v23, v17, v16, s36
    v_perm_b32 v27, v17, v16, s37
    s_mul_i32 s43, s38, 224
    v_add_u32 v1, s43, v0
    v_lshlrev_b32 v1, 1, v1
    v_lshrrev_b32 v2, 4, v1
    v_mul_u32_u24 v2, 14336, v2
    v_and_b32 v1, 15, v1
    v_lshlrev_b32 v1, 4, v1
    v_add_u32 v1, v1, v2
    s_lshr_b32 s43, s39, 2
    s_lshl_b32 s43, s43, 10
    s_and_b32 s39, s39, 3
    s_lshl_b32 s39, s39, 8
    s_add_u32 s43, s43, s39
    buffer_store_dwordx4 v[20:23], v1, s[32:35], s43 offen
    buffer_store_dwordx4 v[24:27], v1, s[32:35], s43 offen offset:16
    s_branch K0_end_4
K0_wout_3:
    s_mov_b32 s20, s18
    s_mov_b32 s21, s19
    s_mov_b32 s22, 802816
    s_mov_b32 s23, 0x00020000
    s_add_u32 s32, s10, 8454144
    s_addc_u32 s33, s11, 0
    s_mov_b32 s34, 802816
    s_mov_b32 s35, 0x00020000
    v_cmp_gt_u32 vcc, 224, v0
    s_and_saveexec_b64 s[40:41], vcc
    s_cbranch_execz K0_end_4
    s_sub_u32 s38, s2, 564
    s_mov_b32 s39, s38
    s_mov_b32 s38, 0
    s_mul_i32 s42, s39, 7168
    s_mul_i32 s43, s38, 896
    s_add_u32 s42, s42, s43
    v_lshlrev_b32 v1, 2, v0
    v_add_u32 v1, s42, v1
    buffer_load_dword v10, v1, s[20:23], 0 offen
    v_add_u32 v1, 896, v1
    buffer_load_dword v11, v1, s[20:23], 0 offen
    v_add_u32 v1, 896, v1
    buffer_load_dword v12, v1, s[20:23], 0 offen
    v_add_u32 v1, 896, v1
    buffer_load_dword v13, v1, s[20:23], 0 offen
    v_add_u32 v1, 896, v1
    buffer_load_dword v14, v1, s[20:23], 0 offen
    v_add_u32 v1, 896, v1
    buffer_load_dword v15, v1, s[20:23], 0 offen
    v_add_u32 v1, 896, v1
    buffer_load_dword v16, v1, s[20:23], 0 offen
    v_add_u32 v1, 896, v1
    buffer_load_dword v17, v1, s[20:23], 0 offen
    s_waitcnt vmcnt(0)
    v_perm_b32 v20, v11, v10, s36
    v_perm_b32 v24, v11, v10, s37
    v_perm_b32 v21, v13, v12, s36
    v_perm_b32 v25, v13, v12, s37
    v_perm_b32 v22, v15, v14, s36
    v_perm_b32 v26, v15, v14, s37
    v_perm_b32 v23, v17, v16, s36
    v_perm_b32 v27, v17, v16, s37
    s_mul_i32 s43, s38, 224
    v_add_u32 v1, s43, v0
    s_mov_b32 s43, 3584
    v_mul_lo_u32 v1, v1, s43
    s_lshl_b32 s39, s39, 4
    v_add_u32 v1, s39, v1
    buffer_store_dwordx4 v[20:23], v1, s[32:35], 0 offen
    buffer_store_dwordx4 v[24:27], v1, s[32:35], 0 offen offset:1792
    s_branch K0_end_4
K0_end_4:
    s_endpgm
.globl conv_kernel
.p2align 8
.type conv_kernel,@function
conv_kernel:
    s_cmp_ge_u32 s2, 448
    s_cbranch_scc1 K1_end_5
    s_load_dwordx2 s[4:5], s[0:1], 32
    s_load_dwordx2 s[6:7], s[0:1], 40
    s_load_dwordx2 s[8:9], s[0:1], 120
    s_waitcnt lgkmcnt(0)
    s_mov_b32 s20, s4
    s_mov_b32 s21, s5
    s_mov_b32 s22, 1835008
    s_mov_b32 s23, 0x00020000
    s_mov_b32 s24, s6
    s_mov_b32 s25, s7
    s_mov_b32 s26, 896
    s_mov_b32 s27, 0x00020000
    s_add_u32 s28, s8, 65536
    s_addc_u32 s29, s9, 0
    s_mov_b32 s30, 1835008
    s_mov_b32 s31, 0x00020000
    s_add_u32 s32, s8, 2162688
    s_addc_u32 s33, s9, 0
    s_mov_b32 s34, 1835008
    s_mov_b32 s35, 0x00020000
    s_lshl_b32 s3, s2, 12
    v_lshlrev_b32 v1, 4, v0
    v_add_u32 v2, s3, v1
    buffer_load_dwordx4 v[4:7], v2, s[20:23], 0 offen
    buffer_load_dwordx4 v[8:11], v2, s[28:31], 0 offen
    s_lshl_b32 s12, s2, 1
    v_mov_b32 v3, s12
    buffer_load_ushort v12, v3, s[24:27], 0 offen
    v_mov_b32 v13, 0
    v_lshlrev_b32 v14, 1, v0
    v_cmp_gt_u32 vcc, 240, v0
    s_and_saveexec_b64 s[40:41], vcc
    ds_write_b16 v14, v13
    s_or_b64 exec, exec, s[40:41]
    v_mul_u32_u24 v15, 0xaab, v0
    v_lshrrev_b32 v15, 16, v15
    v_mul_u32_u24 v16, 24, v15
    v_sub_u32 v16, v0, v16
    v_mul_u32_u24 v15, 4144, v15
    v_lshlrev_b32 v16, 1, v16
    v_add_u32 v15, v15, v16
    v_cmp_gt_u32 vcc, 192, v0
    s_and_saveexec_b64 s[40:41], vcc
    ds_write_b16 v15, v13 offset:8688
    s_or_b64 exec, exec, s[40:41]
    s_waitcnt lgkmcnt(0)
    s_barrier
    s_waitcnt vmcnt(0)
    ds_write_b128 v1, v[8:11] offset:480
    v_sub_u32 v15, 4080, v1
    v_and_b32 v16, 0xffff, v4
    ds_write_b16 v15, v16 offset:4622
    ds_write_b16 v15, v16 offset:8764
    ds_write_b16 v15, v16 offset:12906
    ds_write_b16 v15, v16 offset:17048
    ds_write_b16 v15, v16 offset:21190
    ds_write_b16 v15, v16 offset:25332
    ds_write_b16 v15, v16 offset:29474
    ds_write_b16 v15, v16 offset:33616
    v_lshrrev_b32 v16, 16, v4
    ds_write_b16 v15, v16 offset:4620
    ds_write_b16 v15, v16 offset:8762
    ds_write_b16 v15, v16 offset:12904
    ds_write_b16 v15, v16 offset:17046
    ds_write_b16 v15, v16 offset:21188
    ds_write_b16 v15, v16 offset:25330
    ds_write_b16 v15, v16 offset:29472
    ds_write_b16 v15, v16 offset:33614
    v_and_b32 v16, 0xffff, v5
    ds_write_b16 v15, v16 offset:4618
    ds_write_b16 v15, v16 offset:8760
    ds_write_b16 v15, v16 offset:12902
    ds_write_b16 v15, v16 offset:17044
    ds_write_b16 v15, v16 offset:21186
    ds_write_b16 v15, v16 offset:25328
    ds_write_b16 v15, v16 offset:29470
    ds_write_b16 v15, v16 offset:33612
    v_lshrrev_b32 v16, 16, v5
    ds_write_b16 v15, v16 offset:4616
    ds_write_b16 v15, v16 offset:8758
    ds_write_b16 v15, v16 offset:12900
    ds_write_b16 v15, v16 offset:17042
    ds_write_b16 v15, v16 offset:21184
    ds_write_b16 v15, v16 offset:25326
    ds_write_b16 v15, v16 offset:29468
    ds_write_b16 v15, v16 offset:33610
    v_and_b32 v16, 0xffff, v6
    ds_write_b16 v15, v16 offset:4614
    ds_write_b16 v15, v16 offset:8756
    ds_write_b16 v15, v16 offset:12898
    ds_write_b16 v15, v16 offset:17040
    ds_write_b16 v15, v16 offset:21182
    ds_write_b16 v15, v16 offset:25324
    ds_write_b16 v15, v16 offset:29466
    ds_write_b16 v15, v16 offset:33608
    v_lshrrev_b32 v16, 16, v6
    ds_write_b16 v15, v16 offset:4612
    ds_write_b16 v15, v16 offset:8754
    ds_write_b16 v15, v16 offset:12896
    ds_write_b16 v15, v16 offset:17038
    ds_write_b16 v15, v16 offset:21180
    ds_write_b16 v15, v16 offset:25322
    ds_write_b16 v15, v16 offset:29464
    ds_write_b16 v15, v16 offset:33606
    v_and_b32 v16, 0xffff, v7
    ds_write_b16 v15, v16 offset:4610
    ds_write_b16 v15, v16 offset:8752
    ds_write_b16 v15, v16 offset:12894
    ds_write_b16 v15, v16 offset:17036
    ds_write_b16 v15, v16 offset:21178
    ds_write_b16 v15, v16 offset:25320
    ds_write_b16 v15, v16 offset:29462
    ds_write_b16 v15, v16 offset:33604
    v_lshrrev_b32 v16, 16, v7
    ds_write_b16 v15, v16 offset:4608
    ds_write_b16 v15, v16 offset:8750
    ds_write_b16 v15, v16 offset:12892
    ds_write_b16 v15, v16 offset:17034
    ds_write_b16 v15, v16 offset:21176
    ds_write_b16 v15, v16 offset:25318
    ds_write_b16 v15, v16 offset:29460
    ds_write_b16 v15, v16 offset:33602
    v_lshlrev_b32 v12, 16, v12
    s_waitcnt lgkmcnt(0)
    s_barrier
    v_and_b32 v20, 15, v0
    v_lshrrev_b32 v21, 4, v0
    v_and_b32 v21, 3, v21
    v_lshrrev_b32 v22, 6, v0
    s_nop 0
    v_readfirstlane_b32 s13, v22
    v_sub_u32 v23, 15, v20
    v_and_b32 v24, 7, v23
    v_mul_u32_u24 v24, 4144, v24
    v_lshrrev_b32 v23, 3, v23
    v_add_u32 v23, v23, v21
    v_lshlrev_b32 v23, 4, v23
    v_add_u32 v24, v24, v23
    v_add_u32 v24, 8192, v24
    v_lshlrev_b32 v25, 5, v20
    v_lshlrev_b32 v23, 4, v21
    v_add_u32 v25, v25, v23
    v_lshlrev_b32 v26, 5, v20
    v_lshlrev_b32 v23, 3, v21
    v_add_u32 v26, v26, v23
    s_mov_b32 s14, s13
    s_lshl_b32 s15, s14, 9
    v_subrev_u32 v27, s15, v24
    v_mov_b32 v28, v25
    s_add_u32 s16, s14, 1
    v_mov_b32 v100, 0
    v_mov_b32 v101, 0
    v_mov_b32 v102, 0
    v_mov_b32 v103, 0
K1_loop_6:
    ds_read_b128 v[32:35], v27 offset:0
    ds_read_b128 v[36:39], v28 offset:0
    ds_read_b128 v[40:43], v27 offset:64
    ds_read_b128 v[44:47], v28 offset:64
    ds_read_b128 v[48:51], v27 offset:128
    ds_read_b128 v[52:55], v28 offset:128
    ds_read_b128 v[56:59], v27 offset:192
    ds_read_b128 v[60:63], v28 offset:192
    ds_read_b128 v[64:67], v27 offset:256
    ds_read_b128 v[68:71], v28 offset:256
    ds_read_b128 v[72:75], v27 offset:320
    ds_read_b128 v[76:79], v28 offset:320
    ds_read_b128 v[80:83], v27 offset:384
    ds_read_b128 v[84:87], v28 offset:384
    ds_read_b128 v[88:91], v27 offset:448
    ds_read_b128 v[92:95], v28 offset:448
    s_waitcnt lgkmcnt(14)
    v_mfma_f32_16x16x32_bf16 v[100:103], v[32:35], v[36:39], v[100:103]
    s_waitcnt lgkmcnt(12)
    v_mfma_f32_16x16x32_bf16 v[100:103], v[40:43], v[44:47], v[100:103]
    s_waitcnt lgkmcnt(10)
    v_mfma_f32_16x16x32_bf16 v[100:103], v[48:51], v[52:55], v[100:103]
    s_waitcnt lgkmcnt(8)
    v_mfma_f32_16x16x32_bf16 v[100:103], v[56:59], v[60:63], v[100:103]
    s_waitcnt lgkmcnt(6)
    v_mfma_f32_16x16x32_bf16 v[100:103], v[64:67], v[68:71], v[100:103]
    s_waitcnt lgkmcnt(4)
    v_mfma_f32_16x16x32_bf16 v[100:103], v[72:75], v[76:79], v[100:103]
    s_waitcnt lgkmcnt(2)
    v_mfma_f32_16x16x32_bf16 v[100:103], v[80:83], v[84:87], v[100:103]
    s_waitcnt lgkmcnt(0)
    v_mfma_f32_16x16x32_bf16 v[100:103], v[88:91], v[92:95], v[100:103]
    v_add_u32 v27, 512, v27
    v_add_u32 v28, 512, v28
    s_sub_u32 s16, s16, 1
    s_cmp_lg_u32 s16, 0
    s_cbranch_scc1 K1_loop_6
    v_add_u32 v29, s15, v26
    ds_read_b64 v[30:31], v29 offset:480
    s_nop 7
    s_nop 1
    s_waitcnt lgkmcnt(0)
    v_lshlrev_b32 v104, 16, v30
    v_and_b32 v105, 0xffff0000, v30
    v_mul_f32 v104, v104, v12
    v_mul_f32 v105, v105, v12
    v_cvt_pk_bf16_f32 v106, v104, v105
    v_lshlrev_b32 v104, 16, v106
    v_and_b32 v105, 0xffff0000, v106
    v_cvt_pk_bf16_f32 v106, v100, v101
    v_lshlrev_b32 v107, 16, v106
    v_and_b32 v108, 0xffff0000, v106
    v_add_f32 v104, v104, v107
    v_add_f32 v105, v105, v108
    v_cvt_pk_bf16_f32 v110, v104, v105
    v_lshlrev_b32 v104, 16, v31
    v_and_b32 v105, 0xffff0000, v31
    v_mul_f32 v104, v104, v12
    v_mul_f32 v105, v105, v12
    v_cvt_pk_bf16_f32 v106, v104, v105
    v_lshlrev_b32 v104, 16, v106
    v_and_b32 v105, 0xffff0000, v106
    v_cvt_pk_bf16_f32 v106, v102, v103
    v_lshlrev_b32 v107, 16, v106
    v_and_b32 v108, 0xffff0000, v106
    v_add_f32 v104, v104, v107
    v_add_f32 v105, v105, v108
    v_cvt_pk_bf16_f32 v111, v104, v105
    v_add_u32 v29, s3, v29
    buffer_store_dwordx2 v[110:111], v29, s[32:35], 0 offen
    s_sub_u32 s14, 7, s13
    s_lshl_b32 s15, s14, 9
    v_subrev_u32 v27, s15, v24
    v_mov_b32 v28, v25
    s_add_u32 s16, s14, 1
    v_mov_b32 v100, 0
    v_mov_b32 v101, 0
    v_mov_b32 v102, 0
    v_mov_b32 v103, 0
K1_loop_7:
    ds_read_b128 v[32:35], v27 offset:0
    ds_read_b128 v[36:39], v28 offset:0
    ds_read_b128 v[40:43], v27 offset:64
    ds_read_b128 v[44:47], v28 offset:64
    ds_read_b128 v[48:51], v27 offset:128
    ds_read_b128 v[52:55], v28 offset:128
    ds_read_b128 v[56:59], v27 offset:192
    ds_read_b128 v[60:63], v28 offset:192
    ds_read_b128 v[64:67], v27 offset:256
    ds_read_b128 v[68:71], v28 offset:256
    ds_read_b128 v[72:75], v27 offset:320
    ds_read_b128 v[76:79], v28 offset:320
    ds_read_b128 v[80:83], v27 offset:384
    ds_read_b128 v[84:87], v28 offset:384
    ds_read_b128 v[88:91], v27 offset:448
    ds_read_b128 v[92:95], v28 offset:448
    s_waitcnt lgkmcnt(14)
    v_mfma_f32_16x16x32_bf16 v[100:103], v[32:35], v[36:39], v[100:103]
    s_waitcnt lgkmcnt(12)
    v_mfma_f32_16x16x32_bf16 v[100:103], v[40:43], v[44:47], v[100:103]
    s_waitcnt lgkmcnt(10)
    v_mfma_f32_16x16x32_bf16 v[100:103], v[48:51], v[52:55], v[100:103]
    s_waitcnt lgkmcnt(8)
    v_mfma_f32_16x16x32_bf16 v[100:103], v[56:59], v[60:63], v[100:103]
    s_waitcnt lgkmcnt(6)
    v_mfma_f32_16x16x32_bf16 v[100:103], v[64:67], v[68:71], v[100:103]
    s_waitcnt lgkmcnt(4)
    v_mfma_f32_16x16x32_bf16 v[100:103], v[72:75], v[76:79], v[100:103]
    s_waitcnt lgkmcnt(2)
    v_mfma_f32_16x16x32_bf16 v[100:103], v[80:83], v[84:87], v[100:103]
    s_waitcnt lgkmcnt(0)
    v_mfma_f32_16x16x32_bf16 v[100:103], v[88:91], v[92:95], v[100:103]
    v_add_u32 v27, 512, v27
    v_add_u32 v28, 512, v28
    s_sub_u32 s16, s16, 1
    s_cmp_lg_u32 s16, 0
    s_cbranch_scc1 K1_loop_7
    v_add_u32 v29, s15, v26
    ds_read_b64 v[30:31], v29 offset:480
    s_nop 7
    s_nop 1
    s_waitcnt lgkmcnt(0)
    v_lshlrev_b32 v104, 16, v30
    v_and_b32 v105, 0xffff0000, v30
    v_mul_f32 v104, v104, v12
    v_mul_f32 v105, v105, v12
    v_cvt_pk_bf16_f32 v106, v104, v105
    v_lshlrev_b32 v104, 16, v106
    v_and_b32 v105, 0xffff0000, v106
    v_cvt_pk_bf16_f32 v106, v100, v101
    v_lshlrev_b32 v107, 16, v106
    v_and_b32 v108, 0xffff0000, v106
    v_add_f32 v104, v104, v107
    v_add_f32 v105, v105, v108
    v_cvt_pk_bf16_f32 v110, v104, v105
    v_lshlrev_b32 v104, 16, v31
    v_and_b32 v105, 0xffff0000, v31
    v_mul_f32 v104, v104, v12
    v_mul_f32 v105, v105, v12
    v_cvt_pk_bf16_f32 v106, v104, v105
    v_lshlrev_b32 v104, 16, v106
    v_and_b32 v105, 0xffff0000, v106
    v_cvt_pk_bf16_f32 v106, v102, v103
    v_lshlrev_b32 v107, 16, v106
    v_and_b32 v108, 0xffff0000, v106
    v_add_f32 v104, v104, v107
    v_add_f32 v105, v105, v108
    v_cvt_pk_bf16_f32 v111, v104, v105
    v_add_u32 v29, s3, v29
    buffer_store_dwordx2 v[110:111], v29, s[32:35], 0 offen
K1_end_5:
    s_endpgm
.globl mid_kernel
.p2align 8
.type mid_kernel,@function
mid_kernel:
    s_cmp_ge_u32 s2, 256
    s_cbranch_scc1 K2_end_8
    s_load_dwordx2 s[4:5], s[0:1], 0
    s_load_dwordx2 s[8:9], s[0:1], 120
    s_waitcnt lgkmcnt(0)
    s_mov_b32 s20, s4
    s_mov_b32 s21, s5
    s_mov_b32 s22, 1835008
    s_mov_b32 s23, 0x00020000
    s_mov_b32 s24, s8
    s_mov_b32 s25, s9
    s_mov_b32 s26, 10752
    s_mov_b32 s27, 0x00020000
    s_add_u32 s28, s8, 2162688
    s_addc_u32 s29, s9, 0
    s_mov_b32 s30, 1835008
    s_mov_b32 s31, 0x00020000
    s_add_u32 s32, s8, 4259840
    s_addc_u32 s33, s9, 0
    s_mov_b32 s34, 1835008
    s_mov_b32 s35, 0x00020000
    s_add_u32 s36, s8, 6356992
    s_addc_u32 s37, s9, 0
    s_mov_b32 s38, 1605632
    s_mov_b32 s39, 0x00020000
    s_add_u32 s40, s8, 10551296
    s_addc_u32 s41, s9, 0
    s_mov_b32 s42, 3670016
    s_mov_b32 s43, 0x00020000
    s_add_u32 s44, s8, 14745600
    s_addc_u32 s45, s9, 0
    s_mov_b32 s46, 3670016
    s_mov_b32 s47, 0x00020000
    s_lshr_b32 s10, s2, 1
    s_and_b32 s11, s2, 1
    s_lshl_b32 s12, s10, 4
    s_lshl_b32 s13, s12, 1
    v_lshrrev_b32 v1, 4, v0
    v_and_b32 v2, 15, v0
    v_add_u32 v3, s12, v1
    v_mul_u32_u24 v3, 896, v3
    v_mul_u32_u24 v4, 56, v2
    v_add_u32 v3, v3, v4
    buffer_load_dwordx2 v[32:33], v3, s[20:23], 0 offen offset:0
    buffer_load_dwordx2 v[34:35], v3, s[20:23], 0 offen offset:8
    buffer_load_dwordx2 v[36:37], v3, s[20:23], 0 offen offset:16
    buffer_load_dwordx2 v[38:39], v3, s[20:23], 0 offen offset:24
    buffer_load_dwordx2 v[40:41], v3, s[20:23], 0 offen offset:32
    buffer_load_dwordx2 v[42:43], v3, s[20:23], 0 offen offset:40
    buffer_load_dwordx2 v[44:45], v3, s[20:23], 0 offen offset:48
    v_mul_u32_u24 v5, 112, v2
    s_mov_b32 s17, 1792
    buffer_load_dwordx4 v[96:99], v5, s[24:27], s17 offen offset:0
    buffer_load_dwordx4 v[100:103], v5, s[24:27], s17 offen offset:16
    buffer_load_dwordx4 v[104:107], v5, s[24:27], s17 offen offset:32
    buffer_load_dwordx4 v[108:111], v5, s[24:27], s17 offen offset:48
    buffer_load_dwordx4 v[112:115], v5, s[24:27], s17 offen offset:64
    buffer_load_dwordx4 v[116:119], v5, s[24:27], s17 offen offset:80
    buffer_load_dwordx4 v[120:123], v5, s[24:27], s17 offen offset:96
    s_mov_b32 s17, 0
    buffer_load_dwordx4 v[124:127], v5, s[24:27], s17 offen offset:0
    buffer_load_dwordx4 v[128:131], v5, s[24:27], s17 offen offset:16
    buffer_load_dwordx4 v[132:135], v5, s[24:27], s17 offen offset:32
    buffer_load_dwordx4 v[136:139], v5, s[24:27], s17 offen offset:48
    buffer_load_dwordx4 v[140:143], v5, s[24:27], s17 offen offset:64
    buffer_load_dwordx4 v[144:147], v5, s[24:27], s17 offen offset:80
    buffer_load_dwordx4 v[148:151], v5, s[24:27], s17 offen offset:96
    v_add_u32 v6, 0, v0
    v_lshrrev_b32 v7, 1, v6
    v_and_b32 v8, 1, v6
    v_lshlrev_b32 v7, 12, v7
    v_lshlrev_b32 v8, 4, v8
    v_add_u32 v7, v7, v8
    buffer_load_dwordx4 v[236:239], v7, s[28:31], s13 offen
    v_add_u32 v6, 256, v0
    v_lshrrev_b32 v7, 1, v6
    v_and_b32 v8, 1, v6
    v_lshlrev_b32 v7, 12, v7
    v_lshlrev_b32 v8, 4, v8
    v_add_u32 v7, v7, v8
    buffer_load_dwordx4 v[240:243], v7, s[28:31], s13 offen
    v_add_u32 v6, 512, v0
    v_lshrrev_b32 v7, 1, v6
    v_and_b32 v8, 1, v6
    v_lshlrev_b32 v7, 12, v7
    v_lshlrev_b32 v8, 4, v8
    v_add_u32 v7, v7, v8
    buffer_load_dwordx4 v[244:247], v7, s[28:31], s13 offen
    v_add_u32 v6, 768, v0
    v_lshrrev_b32 v7, 1, v6
    v_and_b32 v8, 1, v6
    v_lshlrev_b32 v7, 12, v7
    v_lshlrev_b32 v8, 4, v8
    v_add_u32 v7, v7, v8
    buffer_load_dwordx4 v[248:251], v7, s[28:31], s13 offen
    s_mov_b32 s17, 3584
    buffer_load_dwordx4 v[180:183], v5, s[24:27], s17 offen offset:0
    buffer_load_dwordx4 v[184:187], v5, s[24:27], s17 offen offset:16
    buffer_load_dwordx4 v[188:191], v5, s[24:27], s17 offen offset:32
    buffer_load_dwordx4 v[192:195], v5, s[24:27], s17 offen offset:48
    buffer_load_dwordx4 v[196:199], v5, s[24:27], s17 offen offset:64
    buffer_load_dwordx4 v[200:203], v5, s[24:27], s17 offen offset:80
    buffer_load_dwordx4 v[204:207], v5, s[24:27], s17 offen offset:96
    s_mov_b32 s17, 7168
    buffer_load_dwordx4 v[208:211], v5, s[24:27], s17 offen offset:0
    buffer_load_dwordx4 v[212:215], v5, s[24:27], s17 offen offset:16
    buffer_load_dwordx4 v[216:219], v5, s[24:27], s17 offen offset:32
    buffer_load_dwordx4 v[220:223], v5, s[24:27], s17 offen offset:48
    buffer_load_dwordx4 v[224:227], v5, s[24:27], s17 offen offset:64
    buffer_load_dwordx4 v[228:231], v5, s[24:27], s17 offen offset:80
    buffer_load_dwordx4 v[232:235], v5, s[24:27], s17 offen offset:96
    v_lshrrev_b32 v10, 6, v0
    v_mul_u32_u24 v252, 200704, v10
    v_and_b32 v9, 63, v0
    v_lshlrev_b32 v9, 4, v9
    v_add_u32 v252, v252, v9
    s_mul_i32 s19, s11, 802816
    s_add_u32 s18, s19, 0
    buffer_load_dwordx4 a[0:3], v252, s[36:39], s18 offen offset:0
    buffer_load_dwordx4 a[4:7], v252, s[36:39], s18 offen offset:1024
    buffer_load_dwordx4 a[8:11], v252, s[36:39], s18 offen offset:2048
    buffer_load_dwordx4 a[12:15], v252, s[36:39], s18 offen offset:3072
    s_add_u32 s18, s19, 4096
    buffer_load_dwordx4 a[16:19], v252, s[36:39], s18 offen offset:0
    buffer_load_dwordx4 a[20:23], v252, s[36:39], s18 offen offset:1024
    buffer_load_dwordx4 a[24:27], v252, s[36:39], s18 offen offset:2048
    buffer_load_dwordx4 a[28:31], v252, s[36:39], s18 offen offset:3072
    s_add_u32 s18, s19, 8192
    buffer_load_dwordx4 a[32:35], v252, s[36:39], s18 offen offset:0
    buffer_load_dwordx4 a[36:39], v252, s[36:39], s18 offen offset:1024
    buffer_load_dwordx4 a[40:43], v252, s[36:39], s18 offen offset:2048
    buffer_load_dwordx4 a[44:47], v252, s[36:39], s18 offen offset:3072
    s_add_u32 s18, s19, 12288
    buffer_load_dwordx4 a[48:51], v252, s[36:39], s18 offen offset:0
    buffer_load_dwordx4 a[52:55], v252, s[36:39], s18 offen offset:1024
    s_waitcnt vmcnt(46)
    v_lshlrev_b32 v64, 16, v32
    v_and_b32 v65, 0xffff0000, v32
    v_lshlrev_b32 v66, 16, v33
    v_and_b32 v67, 0xffff0000, v33
    v_lshlrev_b32 v68, 16, v34
    v_and_b32 v69, 0xffff0000, v34
    v_lshlrev_b32 v70, 16, v35
    v_and_b32 v71, 0xffff0000, v35
    v_lshlrev_b32 v72, 16, v36
    v_and_b32 v73, 0xffff0000, v36
    v_lshlrev_b32 v74, 16, v37
    v_and_b32 v75, 0xffff0000, v37
    v_lshlrev_b32 v76, 16, v38
    v_and_b32 v77, 0xffff0000, v38
    v_lshlrev_b32 v78, 16, v39
    v_and_b32 v79, 0xffff0000, v39
    v_lshlrev_b32 v80, 16, v40
    v_and_b32 v81, 0xffff0000, v40
    v_lshlrev_b32 v82, 16, v41
    v_and_b32 v83, 0xffff0000, v41
    v_lshlrev_b32 v84, 16, v42
    v_and_b32 v85, 0xffff0000, v42
    v_lshlrev_b32 v86, 16, v43
    v_and_b32 v87, 0xffff0000, v43
    v_lshlrev_b32 v88, 16, v44
    v_and_b32 v89, 0xffff0000, v44
    v_lshlrev_b32 v90, 16, v45
    v_and_b32 v91, 0xffff0000, v45
    v_add_f32 v15, v64, v65
    v_add_f32 v15, v15, v66
    v_add_f32 v15, v15, v67
    v_add_f32 v15, v15, v68
    v_add_f32 v15, v15, v69
    v_add_f32 v15, v15, v70
    v_add_f32 v15, v15, v71
    v_add_f32 v15, v15, v72
    v_add_f32 v15, v15, v73
    v_add_f32 v15, v15, v74
    v_add_f32 v15, v15, v75
    v_add_f32 v15, v15, v76
    v_add_f32 v15, v15, v77
    v_add_f32 v15, v15, v78
    v_add_f32 v15, v15, v79
    v_add_f32 v15, v15, v80
    v_add_f32 v15, v15, v81
    v_add_f32 v15, v15, v82
    v_add_f32 v15, v15, v83
    v_add_f32 v15, v15, v84
    v_add_f32 v15, v15, v85
    v_add_f32 v15, v15, v86
    v_add_f32 v15, v15, v87
    v_add_f32 v15, v15, v88
    v_add_f32 v15, v15, v89
    v_add_f32 v15, v15, v90
    v_add_f32 v15, v15, v91
    s_nop 1
    v_add_f32_dpp v16, v15, v15 row_ror:8 row_mask:0xf bank_mask:0xf
    v_mov_b32 v15, v16
    s_nop 1
    v_add_f32_dpp v16, v15, v15 row_ror:4 row_mask:0xf bank_mask:0xf
    v_mov_b32 v15, v16
    s_nop 1
    v_add_f32_dpp v16, v15, v15 row_ror:2 row_mask:0xf bank_mask:0xf
    v_mov_b32 v15, v16
    s_nop 1
    v_add_f32_dpp v16, v15, v15 row_ror:1 row_mask:0xf bank_mask:0xf
    v_mov_b32 v15, v16
    s_nop 1
    v_mov_b32_dpp v15, v16 row_newbcast:0 row_mask:0xf bank_mask:0xf
    v_mul_f32 v12, 0x3b124925, v15
    v_mov_b32 v15, 0
    v_sub_f32 v16, v64, v12
    v_fmac_f32 v15, v16, v16
    v_sub_f32 v16, v65, v12
    v_fmac_f32 v15, v16, v16
    v_sub_f32 v16, v66, v12
    v_fmac_f32 v15, v16, v16
    v_sub_f32 v16, v67, v12
    v_fmac_f32 v15, v16, v16
    v_sub_f32 v16, v68, v12
    v_fmac_f32 v15, v16, v16
    v_sub_f32 v16, v69, v12
    v_fmac_f32 v15, v16, v16
    v_sub_f32 v16, v70, v12
    v_fmac_f32 v15, v16, v16
    v_sub_f32 v16, v71, v12
    v_fmac_f32 v15, v16, v16
    v_sub_f32 v16, v72, v12
    v_fmac_f32 v15, v16, v16
    v_sub_f32 v16, v73, v12
    v_fmac_f32 v15, v16, v16
    v_sub_f32 v16, v74, v12
    v_fmac_f32 v15, v16, v16
    v_sub_f32 v16, v75, v12
    v_fmac_f32 v15, v16, v16
    v_sub_f32 v16, v76, v12
    v_fmac_f32 v15, v16, v16
    v_sub_f32 v16, v77, v12
    v_fmac_f32 v15, v16, v16
    v_sub_f32 v16, v78, v12
    v_fmac_f32 v15, v16, v16
    v_sub_f32 v16, v79, v12
    v_fmac_f32 v15, v16, v16
    v_sub_f32 v16, v80, v12
    v_fmac_f32 v15, v16, v16
    v_sub_f32 v16, v81, v12
    v_fmac_f32 v15, v16, v16
    v_sub_f32 v16, v82, v12
    v_fmac_f32 v15, v16, v16
    v_sub_f32 v16, v83, v12
    v_fmac_f32 v15, v16, v16
    v_sub_f32 v16, v84, v12
    v_fmac_f32 v15, v16, v16
    v_sub_f32 v16, v85, v12
    v_fmac_f32 v15, v16, v16
    v_sub_f32 v16, v86, v12
    v_fmac_f32 v15, v16, v16
    v_sub_f32 v16, v87, v12
    v_fmac_f32 v15, v16, v16
    v_sub_f32 v16, v88, v12
    v_fmac_f32 v15, v16, v16
    v_sub_f32 v16, v89, v12
    v_fmac_f32 v15, v16, v16
    v_sub_f32 v16, v90, v12
    v_fmac_f32 v15, v16, v16
    v_sub_f32 v16, v91, v12
    v_fmac_f32 v15, v16, v16
    s_nop 1
    v_add_f32_dpp v16, v15, v15 row_ror:8 row_mask:0xf bank_mask:0xf
    v_mov_b32 v15, v16
    s_nop 1
    v_add_f32_dpp v16, v15, v15 row_ror:4 row_mask:0xf bank_mask:0xf
    v_mov_b32 v15, v16
    s_nop 1
    v_add_f32_dpp v16, v15, v15 row_ror:2 row_mask:0xf bank_mask:0xf
    v_mov_b32 v15, v16
    s_nop 1
    v_add_f32_dpp v16, v15, v15 row_ror:1 row_mask:0xf bank_mask:0xf
    v_mov_b32 v15, v16
    s_nop 1
    v_mov_b32_dpp v15, v16 row_newbcast:0 row_mask:0xf bank_mask:0xf
    v_mul_f32 v13, 0x3b124925, v15
    v_cvt_pk_bf16_f32 v12, v12, v12
    v_lshlrev_b32 v12, 16, v12
    v_cvt_pk_bf16_f32 v13, v13, v13
    v_lshlrev_b32 v13, 16, v13
    v_add_f32 v13, 0x3727c5ac, v13
    v_cvt_pk_bf16_f32 v13, v13, v13
    v_lshlrev_b32 v13, 16, v13
    v_sqrt_f32 v13, v13
    s_nop 0
    v_cvt_pk_bf16_f32 v13, v13, v13
    v_lshlrev_b32 v13, 16, v13
    v_rcp_f32 v14, v13
    s_nop 0
    s_waitcnt vmcnt(28)
    v_add_u32 v6, 0, v0
    v_lshrrev_b32 v7, 1, v6
    v_and_b32 v8, 1, v6
    v_mul_u32_u24 v8, 7232, v8
    v_lshlrev_b32 v7, 1, v7
    v_add_u32 v7, v8, v7
    ds_write_b16 v7, v236 offset:0
    ds_write_b16_d16_hi v7, v236 offset:904
    ds_write_b16 v7, v237 offset:1808
    ds_write_b16_d16_hi v7, v237 offset:2712
    ds_write_b16 v7, v238 offset:3616
    ds_write_b16_d16_hi v7, v238 offset:4520
    ds_write_b16 v7, v239 offset:5424
    ds_write_b16_d16_hi v7, v239 offset:6328
    v_add_u32 v6, 256, v0
    v_lshrrev_b32 v7, 1, v6
    v_and_b32 v8, 1, v6
    v_mul_u32_u24 v8, 7232, v8
    v_lshlrev_b32 v7, 1, v7
    v_add_u32 v7, v8, v7
    ds_write_b16 v7, v240 offset:0
    ds_write_b16_d16_hi v7, v240 offset:904
    ds_write_b16 v7, v241 offset:1808
    ds_write_b16_d16_hi v7, v241 offset:2712
    ds_write_b16 v7, v242 offset:3616
    ds_write_b16_d16_hi v7, v242 offset:4520
    ds_write_b16 v7, v243 offset:5424
    ds_write_b16_d16_hi v7, v243 offset:6328
    v_add_u32 v6, 512, v0
    v_lshrrev_b32 v7, 1, v6
    v_and_b32 v8, 1, v6
    v_mul_u32_u24 v8, 7232, v8
    v_lshlrev_b32 v7, 1, v7
    v_add_u32 v7, v8, v7
    ds_write_b16 v7, v244 offset:0
    ds_write_b16_d16_hi v7, v244 offset:904
    ds_write_b16 v7, v245 offset:1808
    ds_write_b16_d16_hi v7, v245 offset:2712
    ds_write_b16 v7, v246 offset:3616
    ds_write_b16_d16_hi v7, v246 offset:4520
    ds_write_b16 v7, v247 offset:5424
    ds_write_b16_d16_hi v7, v247 offset:6328
    v_cmp_gt_u32 vcc, 128, v0
    s_and_saveexec_b64 s[50:51], vcc
    s_cbranch_execz K2_sk_12
    v_add_u32 v6, 768, v0
    v_lshrrev_b32 v7, 1, v6
    v_and_b32 v8, 1, v6
    v_mul_u32_u24 v8, 7232, v8
    v_lshlrev_b32 v7, 1, v7
    v_add_u32 v7, v8, v7
    ds_write_b16 v7, v248 offset:0
    ds_write_b16_d16_hi v7, v248 offset:904
    ds_write_b16 v7, v249 offset:1808
    ds_write_b16_d16_hi v7, v249 offset:2712
    ds_write_b16 v7, v250 offset:3616
    ds_write_b16_d16_hi v7, v250 offset:4520
    ds_write_b16 v7, v251 offset:5424
    ds_write_b16_d16_hi v7, v251 offset:6328
K2_sk_12:
    s_or_b64 exec, exec, s[50:51]
    s_add_u32 s18, s19, 14336
    buffer_load_dwordx4 a[56:59], v252, s[36:39], s18 offen offset:0
    buffer_load_dwordx4 a[60:63], v252, s[36:39], s18 offen offset:1024
    buffer_load_dwordx4 a[64:67], v252, s[36:39], s18 offen offset:2048
    buffer_load_dwordx4 a[68:71], v252, s[36:39], s18 offen offset:3072
    s_add_u32 s18, s19, 18432
    buffer_load_dwordx4 a[72:75], v252, s[36:39], s18 offen offset:0
    buffer_load_dwordx4 a[76:79], v252, s[36:39], s18 offen offset:1024
    buffer_load_dwordx4 a[80:83], v252, s[36:39], s18 offen offset:2048
    buffer_load_dwordx4 a[84:87], v252, s[36:39], s18 offen offset:3072
    s_add_u32 s18, s19, 22528
    buffer_load_dwordx4 a[88:91], v252, s[36:39], s18 offen offset:0
    buffer_load_dwordx4 a[92:95], v252, s[36:39], s18 offen offset:1024
    buffer_load_dwordx4 a[96:99], v252, s[36:39], s18 offen offset:2048
    buffer_load_dwordx4 a[100:103], v252, s[36:39], s18 offen offset:3072
    s_add_u32 s18, s19, 26624
    buffer_load_dwordx4 a[104:107], v252, s[36:39], s18 offen offset:0
    buffer_load_dwordx4 a[108:111], v252, s[36:39], s18 offen offset:1024
    s_waitcnt lgkmcnt(0)
    s_barrier
    v_mul_u32_u24 v6, 904, v1
    v_add_u32 v6, v6, v4
    ds_read_b64 v[46:47], v6 offset:0
    ds_read_b64 v[48:49], v6 offset:8
    ds_read_b64 v[50:51], v6 offset:16
    ds_read_b64 v[52:53], v6 offset:24
    ds_read_b64 v[54:55], v6 offset:32
    ds_read_b64 v[56:57], v6 offset:40
    ds_read_b64 v[58:59], v6 offset:48
    v_sub_f32 v16, v64, v12
    v_sub_f32 v17, v65, v12
    v_cvt_pk_bf16_f32 v18, v16, v17
    v_lshlrev_b32 v16, 16, v18
    v_and_b32 v17, 0xffff0000, v18
    v_mul_f32 v18, v16, v14
    v_mul_f32 v19, v17, v14
    v_fma_f32 v16, -v18, v13, v16
    v_fma_f32 v17, -v19, v13, v17
    v_fma_f32 v16, v16, v14, v18
    v_fma_f32 v17, v17, v14, v19
    v_cvt_pk_bf16_f32 v18, v16, v17
    v_lshlrev_b32 v16, 16, v18
    v_and_b32 v17, 0xffff0000, v18
    v_add_f32 v18, 1.0, v96
    v_add_f32 v19, 1.0, v97
    v_cvt_pk_bf16_f32 v20, v18, v19
    v_lshlrev_b32 v18, 16, v20
    v_and_b32 v19, 0xffff0000, v20
    v_mul_f32 v16, v16, v18
    v_mul_f32 v17, v17, v19
    v_cvt_pk_bf16_f32 v18, v16, v17
    v_lshlrev_b32 v16, 16, v18
    v_and_b32 v17, 0xffff0000, v18
    v_add_f32 v16, v16, v124
    v_add_f32 v17, v17, v125
    v_cvt_pk_bf16_f32 v18, v16, v17
    v_lshlrev_b32 v16, 16, v18
    v_and_b32 v17, 0xffff0000, v18
    v_mov_b32 v152, v16
    v_mov_b32 v153, v17
    v_sub_f32 v16, v66, v12
    v_sub_f32 v17, v67, v12
    v_cvt_pk_bf16_f32 v18, v16, v17
    v_lshlrev_b32 v16, 16, v18
    v_and_b32 v17, 0xffff0000, v18
    v_mul_f32 v18, v16, v14
    v_mul_f32 v19, v17, v14
    v_fma_f32 v16, -v18, v13, v16
    v_fma_f32 v17, -v19, v13, v17
    v_fma_f32 v16, v16, v14, v18
    v_fma_f32 v17, v17, v14, v19
    v_cvt_pk_bf16_f32 v18, v16, v17
    v_lshlrev_b32 v16, 16, v18
    v_and_b32 v17, 0xffff0000, v18
    v_add_f32 v18, 1.0, v98
    v_add_f32 v19, 1.0, v99
    v_cvt_pk_bf16_f32 v20, v18, v19
    v_lshlrev_b32 v18, 16, v20
    v_and_b32 v19, 0xffff0000, v20
    v_mul_f32 v16, v16, v18
    v_mul_f32 v17, v17, v19
    v_cvt_pk_bf16_f32 v18, v16, v17
    v_lshlrev_b32 v16, 16, v18
    v_and_b32 v17, 0xffff0000, v18
    v_add_f32 v16, v16, v126
    v_add_f32 v17, v17, v127
    v_cvt_pk_bf16_f32 v18, v16, v17
    v_lshlrev_b32 v16, 16, v18
    v_and_b32 v17, 0xffff0000, v18
    v_mov_b32 v154, v16
    v_mov_b32 v155, v17
    v_sub_f32 v16, v68, v12
    v_sub_f32 v17, v69, v12
    v_cvt_pk_bf16_f32 v18, v16, v17
    v_lshlrev_b32 v16, 16, v18
    v_and_b32 v17, 0xffff0000, v18
    v_mul_f32 v18, v16, v14
    v_mul_f32 v19, v17, v14
    v_fma_f32 v16, -v18, v13, v16
    v_fma_f32 v17, -v19, v13, v17
    v_fma_f32 v16, v16, v14, v18
    v_fma_f32 v17, v17, v14, v19
    v_cvt_pk_bf16_f32 v18, v16, v17
    v_lshlrev_b32 v16, 16, v18
    v_and_b32 v17, 0xffff0000, v18
    v_add_f32 v18, 1.0, v100
    v_add_f32 v19, 1.0, v101
    v_cvt_pk_bf16_f32 v20, v18, v19
    v_lshlrev_b32 v18, 16, v20
    v_and_b32 v19, 0xffff0000, v20
    v_mul_f32 v16, v16, v18
    v_mul_f32 v17, v17, v19
    v_cvt_pk_bf16_f32 v18, v16, v17
    v_lshlrev_b32 v16, 16, v18
    v_and_b32 v17, 0xffff0000, v18
    v_add_f32 v16, v16, v128
    v_add_f32 v17, v17, v129
    v_cvt_pk_bf16_f32 v18, v16, v17
    v_lshlrev_b32 v16, 16, v18
    v_and_b32 v17, 0xffff0000, v18
    v_mov_b32 v156, v16
    v_mov_b32 v157, v17
    v_sub_f32 v16, v70, v12
    v_sub_f32 v17, v71, v12
    v_cvt_pk_bf16_f32 v18, v16, v17
    v_lshlrev_b32 v16, 16, v18
    v_and_b32 v17, 0xffff0000, v18
    v_mul_f32 v18, v16, v14
    v_mul_f32 v19, v17, v14
    v_fma_f32 v16, -v18, v13, v16
    v_fma_f32 v17, -v19, v13, v17
    v_fma_f32 v16, v16, v14, v18
    v_fma_f32 v17, v17, v14, v19
    v_cvt_pk_bf16_f32 v18, v16, v17
    v_lshlrev_b32 v16, 16, v18
    v_and_b32 v17, 0xffff0000, v18
    v_add_f32 v18, 1.0, v102
    v_add_f32 v19, 1.0, v103
    v_cvt_pk_bf16_f32 v20, v18, v19
    v_lshlrev_b32 v18, 16, v20
    v_and_b32 v19, 0xffff0000, v20
    v_mul_f32 v16, v16, v18
    v_mul_f32 v17, v17, v19
    v_cvt_pk_bf16_f32 v18, v16, v17
    v_lshlrev_b32 v16, 16, v18
    v_and_b32 v17, 0xffff0000, v18
    v_add_f32 v16, v16, v130
    v_add_f32 v17, v17, v131
    v_cvt_pk_bf16_f32 v18, v16, v17
    v_lshlrev_b32 v16, 16, v18
    v_and_b32 v17, 0xffff0000, v18
    v_mov_b32 v158, v16
    v_mov_b32 v159, v17
    v_sub_f32 v16, v72, v12
    v_sub_f32 v17, v73, v12
    v_cvt_pk_bf16_f32 v18, v16, v17
    v_lshlrev_b32 v16, 16, v18
    v_and_b32 v17, 0xffff0000, v18
    v_mul_f32 v18, v16, v14
    v_mul_f32 v19, v17, v14
    v_fma_f32 v16, -v18, v13, v16
    v_fma_f32 v17, -v19, v13, v17
    v_fma_f32 v16, v16, v14, v18
    v_fma_f32 v17, v17, v14, v19
    v_cvt_pk_bf16_f32 v18, v16, v17
    v_lshlrev_b32 v16, 16, v18
    v_and_b32 v17, 0xffff0000, v18
    v_add_f32 v18, 1.0, v104
    v_add_f32 v19, 1.0, v105
    v_cvt_pk_bf16_f32 v20, v18, v19
    v_lshlrev_b32 v18, 16, v20
    v_and_b32 v19, 0xffff0000, v20
    v_mul_f32 v16, v16, v18
    v_mul_f32 v17, v17, v19
    v_cvt_pk_bf16_f32 v18, v16, v17
    v_lshlrev_b32 v16, 16, v18
    v_and_b32 v17, 0xffff0000, v18
    v_add_f32 v16, v16, v132
    v_add_f32 v17, v17, v133
    v_cvt_pk_bf16_f32 v18, v16, v17
    v_lshlrev_b32 v16, 16, v18
    v_and_b32 v17, 0xffff0000, v18
    v_mov_b32 v160, v16
    v_mov_b32 v161, v17
    v_sub_f32 v16, v74, v12
    v_sub_f32 v17, v75, v12
    v_cvt_pk_bf16_f32 v18, v16, v17
    v_lshlrev_b32 v16, 16, v18
    v_and_b32 v17, 0xffff0000, v18
    v_mul_f32 v18, v16, v14
    v_mul_f32 v19, v17, v14
    v_fma_f32 v16, -v18, v13, v16
    v_fma_f32 v17, -v19, v13, v17
    v_fma_f32 v16, v16, v14, v18
    v_fma_f32 v17, v17, v14, v19
    v_cvt_pk_bf16_f32 v18, v16, v17
    v_lshlrev_b32 v16, 16, v18
    v_and_b32 v17, 0xffff0000, v18
    v_add_f32 v18, 1.0, v106
    v_add_f32 v19, 1.0, v107
    v_cvt_pk_bf16_f32 v20, v18, v19
    v_lshlrev_b32 v18, 16, v20
    v_and_b32 v19, 0xffff0000, v20
    v_mul_f32 v16, v16, v18
    v_mul_f32 v17, v17, v19
    v_cvt_pk_bf16_f32 v18, v16, v17
    v_lshlrev_b32 v16, 16, v18
    v_and_b32 v17, 0xffff0000, v18
    v_add_f32 v16, v16, v134
    v_add_f32 v17, v17, v135
    v_cvt_pk_bf16_f32 v18, v16, v17
    v_lshlrev_b32 v16, 16, v18
    v_and_b32 v17, 0xffff0000, v18
    v_mov_b32 v162, v16
    v_mov_b32 v163, v17
    v_sub_f32 v16, v76, v12
    v_sub_f32 v17, v77, v12
    v_cvt_pk_bf16_f32 v18, v16, v17
    v_lshlrev_b32 v16, 16, v18
    v_and_b32 v17, 0xffff0000, v18
    v_mul_f32 v18, v16, v14
    v_mul_f32 v19, v17, v14
    v_fma_f32 v16, -v18, v13, v16
    v_fma_f32 v17, -v19, v13, v17
    v_fma_f32 v16, v16, v14, v18
    v_fma_f32 v17, v17, v14, v19
    v_cvt_pk_bf16_f32 v18, v16, v17
    v_lshlrev_b32 v16, 16, v18
    v_and_b32 v17, 0xffff0000, v18
    v_add_f32 v18, 1.0, v108
    v_add_f32 v19, 1.0, v109
    v_cvt_pk_bf16_f32 v20, v18, v19
    v_lshlrev_b32 v18, 16, v20
    v_and_b32 v19, 0xffff0000, v20
    v_mul_f32 v16, v16, v18
    v_mul_f32 v17, v17, v19
    v_cvt_pk_bf16_f32 v18, v16, v17
    v_lshlrev_b32 v16, 16, v18
    v_and_b32 v17, 0xffff0000, v18
    v_add_f32 v16, v16, v136
    v_add_f32 v17, v17, v137
    v_cvt_pk_bf16_f32 v18, v16, v17
    v_lshlrev_b32 v16, 16, v18
    v_and_b32 v17, 0xffff0000, v18
    v_mov_b32 v164, v16
    v_mov_b32 v165, v17
    v_sub_f32 v16, v78, v12
    v_sub_f32 v17, v79, v12
    v_cvt_pk_bf16_f32 v18, v16, v17
    v_lshlrev_b32 v16, 16, v18
    v_and_b32 v17, 0xffff0000, v18
    v_mul_f32 v18, v16, v14
    v_mul_f32 v19, v17, v14
    v_fma_f32 v16, -v18, v13, v16
    v_fma_f32 v17, -v19, v13, v17
    v_fma_f32 v16, v16, v14, v18
    v_fma_f32 v17, v17, v14, v19
    v_cvt_pk_bf16_f32 v18, v16, v17
    v_lshlrev_b32 v16, 16, v18
    v_and_b32 v17, 0xffff0000, v18
    v_add_f32 v18, 1.0, v110
    v_add_f32 v19, 1.0, v111
    v_cvt_pk_bf16_f32 v20, v18, v19
    v_lshlrev_b32 v18, 16, v20
    v_and_b32 v19, 0xffff0000, v20
    v_mul_f32 v16, v16, v18
    v_mul_f32 v17, v17, v19
    v_cvt_pk_bf16_f32 v18, v16, v17
    v_lshlrev_b32 v16, 16, v18
    v_and_b32 v17, 0xffff0000, v18
    v_add_f32 v16, v16, v138
    v_add_f32 v17, v17, v139
    v_cvt_pk_bf16_f32 v18, v16, v17
    v_lshlrev_b32 v16, 16, v18
    v_and_b32 v17, 0xffff0000, v18
    v_mov_b32 v166, v16
    v_mov_b32 v167, v17
    v_sub_f32 v16, v80, v12
    v_sub_f32 v17, v81, v12
    v_cvt_pk_bf16_f32 v18, v16, v17
    v_lshlrev_b32 v16, 16, v18
    v_and_b32 v17, 0xffff0000, v18
    v_mul_f32 v18, v16, v14
    v_mul_f32 v19, v17, v14
    v_fma_f32 v16, -v18, v13, v16
    v_fma_f32 v17, -v19, v13, v17
    v_fma_f32 v16, v16, v14, v18
    v_fma_f32 v17, v17, v14, v19
    v_cvt_pk_bf16_f32 v18, v16, v17
    v_lshlrev_b32 v16, 16, v18
    v_and_b32 v17, 0xffff0000, v18
    v_add_f32 v18, 1.0, v112
    v_add_f32 v19, 1.0, v113
    v_cvt_pk_bf16_f32 v20, v18, v19
    v_lshlrev_b32 v18, 16, v20
    v_and_b32 v19, 0xffff0000, v20
    v_mul_f32 v16, v16, v18
    v_mul_f32 v17, v17, v19
    v_cvt_pk_bf16_f32 v18, v16, v17
    v_lshlrev_b32 v16, 16, v18
    v_and_b32 v17, 0xffff0000, v18
    v_add_f32 v16, v16, v140
    v_add_f32 v17, v17, v141
    v_cvt_pk_bf16_f32 v18, v16, v17
    v_lshlrev_b32 v16, 16, v18
    v_and_b32 v17, 0xffff0000, v18
    v_mov_b32 v168, v16
    v_mov_b32 v169, v17
    v_sub_f32 v16, v82, v12
    v_sub_f32 v17, v83, v12
    v_cvt_pk_bf16_f32 v18, v16, v17
    v_lshlrev_b32 v16, 16, v18
    v_and_b32 v17, 0xffff0000, v18
    v_mul_f32 v18, v16, v14
    v_mul_f32 v19, v17, v14
    v_fma_f32 v16, -v18, v13, v16
    v_fma_f32 v17, -v19, v13, v17
    v_fma_f32 v16, v16, v14, v18
    v_fma_f32 v17, v17, v14, v19
    v_cvt_pk_bf16_f32 v18, v16, v17
    v_lshlrev_b32 v16, 16, v18
    v_and_b32 v17, 0xffff0000, v18
    v_add_f32 v18, 1.0, v114
    v_add_f32 v19, 1.0, v115
    v_cvt_pk_bf16_f32 v20, v18, v19
    v_lshlrev_b32 v18, 16, v20
    v_and_b32 v19, 0xffff0000, v20
    v_mul_f32 v16, v16, v18
    v_mul_f32 v17, v17, v19
    v_cvt_pk_bf16_f32 v18, v16, v17
    v_lshlrev_b32 v16, 16, v18
    v_and_b32 v17, 0xffff0000, v18
    v_add_f32 v16, v16, v142
    v_add_f32 v17, v17, v143
    v_cvt_pk_bf16_f32 v18, v16, v17
    v_lshlrev_b32 v16, 16, v18
    v_and_b32 v17, 0xffff0000, v18
    v_mov_b32 v170, v16
    v_mov_b32 v171, v17
    v_sub_f32 v16, v84, v12
    v_sub_f32 v17, v85, v12
    v_cvt_pk_bf16_f32 v18, v16, v17
    v_lshlrev_b32 v16, 16, v18
    v_and_b32 v17, 0xffff0000, v18
    v_mul_f32 v18, v16, v14
    v_mul_f32 v19, v17, v14
    v_fma_f32 v16, -v18, v13, v16
    v_fma_f32 v17, -v19, v13, v17
    v_fma_f32 v16, v16, v14, v18
    v_fma_f32 v17, v17, v14, v19
    v_cvt_pk_bf16_f32 v18, v16, v17
    v_lshlrev_b32 v16, 16, v18
    v_and_b32 v17, 0xffff0000, v18
    v_add_f32 v18, 1.0, v116
    v_add_f32 v19, 1.0, v117
    v_cvt_pk_bf16_f32 v20, v18, v19
    v_lshlrev_b32 v18, 16, v20
    v_and_b32 v19, 0xffff0000, v20
    v_mul_f32 v16, v16, v18
    v_mul_f32 v17, v17, v19
    v_cvt_pk_bf16_f32 v18, v16, v17
    v_lshlrev_b32 v16, 16, v18
    v_and_b32 v17, 0xffff0000, v18
    v_add_f32 v16, v16, v144
    v_add_f32 v17, v17, v145
    v_cvt_pk_bf16_f32 v18, v16, v17
    v_lshlrev_b32 v16, 16, v18
    v_and_b32 v17, 0xffff0000, v18
    v_mov_b32 v172, v16
    v_mov_b32 v173, v17
    v_sub_f32 v16, v86, v12
    v_sub_f32 v17, v87, v12
    v_cvt_pk_bf16_f32 v18, v16, v17
    v_lshlrev_b32 v16, 16, v18
    v_and_b32 v17, 0xffff0000, v18
    v_mul_f32 v18, v16, v14
    v_mul_f32 v19, v17, v14
    v_fma_f32 v16, -v18, v13, v16
    v_fma_f32 v17, -v19, v13, v17
    v_fma_f32 v16, v16, v14, v18
    v_fma_f32 v17, v17, v14, v19
    v_cvt_pk_bf16_f32 v18, v16, v17
    v_lshlrev_b32 v16, 16, v18
    v_and_b32 v17, 0xffff0000, v18
    v_add_f32 v18, 1.0, v118
    v_add_f32 v19, 1.0, v119
    v_cvt_pk_bf16_f32 v20, v18, v19
    v_lshlrev_b32 v18, 16, v20
    v_and_b32 v19, 0xffff0000, v20
    v_mul_f32 v16, v16, v18
    v_mul_f32 v17, v17, v19
    v_cvt_pk_bf16_f32 v18, v16, v17
    v_lshlrev_b32 v16, 16, v18
    v_and_b32 v17, 0xffff0000, v18
    v_add_f32 v16, v16, v146
    v_add_f32 v17, v17, v147
    v_cvt_pk_bf16_f32 v18, v16, v17
    v_lshlrev_b32 v16, 16, v18
    v_and_b32 v17, 0xffff0000, v18
    v_mov_b32 v174, v16
    v_mov_b32 v175, v17
    v_sub_f32 v16, v88, v12
    v_sub_f32 v17, v89, v12
    v_cvt_pk_bf16_f32 v18, v16, v17
    v_lshlrev_b32 v16, 16, v18
    v_and_b32 v17, 0xffff0000, v18
    v_mul_f32 v18, v16, v14
    v_mul_f32 v19, v17, v14
    v_fma_f32 v16, -v18, v13, v16
    v_fma_f32 v17, -v19, v13, v17
    v_fma_f32 v16, v16, v14, v18
    v_fma_f32 v17, v17, v14, v19
    v_cvt_pk_bf16_f32 v18, v16, v17
    v_lshlrev_b32 v16, 16, v18
    v_and_b32 v17, 0xffff0000, v18
    v_add_f32 v18, 1.0, v120
    v_add_f32 v19, 1.0, v121
    v_cvt_pk_bf16_f32 v20, v18, v19
    v_lshlrev_b32 v18, 16, v20
    v_and_b32 v19, 0xffff0000, v20
    v_mul_f32 v16, v16, v18
    v_mul_f32 v17, v17, v19
    v_cvt_pk_bf16_f32 v18, v16, v17
    v_lshlrev_b32 v16, 16, v18
    v_and_b32 v17, 0xffff0000, v18
    v_add_f32 v16, v16, v148
    v_add_f32 v17, v17, v149
    v_cvt_pk_bf16_f32 v18, v16, v17
    v_lshlrev_b32 v16, 16, v18
    v_and_b32 v17, 0xffff0000, v18
    v_mov_b32 v176, v16
    v_mov_b32 v177, v17
    v_sub_f32 v16, v90, v12
    v_sub_f32 v17, v91, v12
    v_cvt_pk_bf16_f32 v18, v16, v17
    v_lshlrev_b32 v16, 16, v18
    v_and_b32 v17, 0xffff0000, v18
    v_mul_f32 v18, v16, v14
    v_mul_f32 v19, v17, v14
    v_fma_f32 v16, -v18, v13, v16
    v_fma_f32 v17, -v19, v13, v17
    v_fma_f32 v16, v16, v14, v18
    v_fma_f32 v17, v17, v14, v19
    v_cvt_pk_bf16_f32 v18, v16, v17
    v_lshlrev_b32 v16, 16, v18
    v_and_b32 v17, 0xffff0000, v18
    v_add_f32 v18, 1.0, v122
    v_add_f32 v19, 1.0, v123
    v_cvt_pk_bf16_f32 v20, v18, v19
    v_lshlrev_b32 v18, 16, v20
    v_and_b32 v19, 0xffff0000, v20
    v_mul_f32 v16, v16, v18
    v_mul_f32 v17, v17, v19
    v_cvt_pk_bf16_f32 v18, v16, v17
    v_lshlrev_b32 v16, 16, v18
    v_and_b32 v17, 0xffff0000, v18
    v_add_f32 v16, v16, v150
    v_add_f32 v17, v17, v151
    v_cvt_pk_bf16_f32 v18, v16, v17
    v_lshlrev_b32 v16, 16, v18
    v_and_b32 v17, 0xffff0000, v18
    v_mov_b32 v178, v16
    v_mov_b32 v179, v17
    s_mov_b32 s17, 5376
    buffer_load_dwordx4 v[96:99], v5, s[24:27], s17 offen offset:0
    buffer_load_dwordx4 v[100:103], v5, s[24:27], s17 offen offset:16
    buffer_load_dwordx4 v[104:107], v5, s[24:27], s17 offen offset:32
    buffer_load_dwordx4 v[108:111], v5, s[24:27], s17 offen offset:48
    buffer_load_dwordx4 v[112:115], v5, s[24:27], s17 offen offset:64
    buffer_load_dwordx4 v[116:119], v5, s[24:27], s17 offen offset:80
    buffer_load_dwordx4 v[120:123], v5, s[24:27], s17 offen offset:96
    s_waitcnt vmcnt(42) lgkmcnt(0)
    v_lshlrev_b32 v18, 16, v46
    v_and_b32 v19, 0xffff0000, v46
    v_mul_f32 v16, v152, v18
    v_mul_f32 v17, v153, v19
    v_cvt_pk_bf16_f32 v18, v16, v17
    v_lshlrev_b32 v16, 16, v18
    v_and_b32 v17, 0xffff0000, v18
    v_mul_f32 v16, v16, v180
    v_mul_f32 v17, v17, v181
    v_cvt_pk_bf16_f32 v18, v16, v17
    v_lshlrev_b32 v16, 16, v18
    v_and_b32 v17, 0xffff0000, v18
    v_add_f32 v16, v16, v64
    v_add_f32 v17, v17, v65
    v_cvt_pk_bf16_f32 v32, v16, v17
    v_lshlrev_b32 v64, 16, v32
    v_and_b32 v65, 0xffff0000, v32
    v_lshlrev_b32 v18, 16, v47
    v_and_b32 v19, 0xffff0000, v47
    v_mul_f32 v16, v154, v18
    v_mul_f32 v17, v155, v19
    v_cvt_pk_bf16_f32 v18, v16, v17
    v_lshlrev_b32 v16, 16, v18
    v_and_b32 v17, 0xffff0000, v18
    v_mul_f32 v16, v16, v182
    v_mul_f32 v17, v17, v183
    v_cvt_pk_bf16_f32 v18, v16, v17
    v_lshlrev_b32 v16, 16, v18
    v_and_b32 v17, 0xffff0000, v18
    v_add_f32 v16, v16, v66
    v_add_f32 v17, v17, v67
    v_cvt_pk_bf16_f32 v33, v16, v17
    v_lshlrev_b32 v66, 16, v33
    v_and_b32 v67, 0xffff0000, v33
    v_lshlrev_b32 v18, 16, v48
    v_and_b32 v19, 0xffff0000, v48
    v_mul_f32 v16, v156, v18
    v_mul_f32 v17, v157, v19
    v_cvt_pk_bf16_f32 v18, v16, v17
    v_lshlrev_b32 v16, 16, v18
    v_and_b32 v17, 0xffff0000, v18
    v_mul_f32 v16, v16, v184
    v_mul_f32 v17, v17, v185
    v_cvt_pk_bf16_f32 v18, v16, v17
    v_lshlrev_b32 v16, 16, v18
    v_and_b32 v17, 0xffff0000, v18
    v_add_f32 v16, v16, v68
    v_add_f32 v17, v17, v69
    v_cvt_pk_bf16_f32 v34, v16, v17
    v_lshlrev_b32 v68, 16, v34
    v_and_b32 v69, 0xffff0000, v34
    v_lshlrev_b32 v18, 16, v49
    v_and_b32 v19, 0xffff0000, v49
    v_mul_f32 v16, v158, v18
    v_mul_f32 v17, v159, v19
    v_cvt_pk_bf16_f32 v18, v16, v17
    v_lshlrev_b32 v16, 16, v18
    v_and_b32 v17, 0xffff0000, v18
    v_mul_f32 v16, v16, v186
    v_mul_f32 v17, v17, v187
    v_cvt_pk_bf16_f32 v18, v16, v17
    v_lshlrev_b32 v16, 16, v18
    v_and_b32 v17, 0xffff0000, v18
    v_add_f32 v16, v16, v70
    v_add_f32 v17, v17, v71
    v_cvt_pk_bf16_f32 v35, v16, v17
    v_lshlrev_b32 v70, 16, v35
    v_and_b32 v71, 0xffff0000, v35
    v_lshlrev_b32 v18, 16, v50
    v_and_b32 v19, 0xffff0000, v50
    v_mul_f32 v16, v160, v18
    v_mul_f32 v17, v161, v19
    v_cvt_pk_bf16_f32 v18, v16, v17
    v_lshlrev_b32 v16, 16, v18
    v_and_b32 v17, 0xffff0000, v18
    v_mul_f32 v16, v16, v188
    v_mul_f32 v17, v17, v189
    v_cvt_pk_bf16_f32 v18, v16, v17
    v_lshlrev_b32 v16, 16, v18
    v_and_b32 v17, 0xffff0000, v18
    v_add_f32 v16, v16, v72
    v_add_f32 v17, v17, v73
    v_cvt_pk_bf16_f32 v36, v16, v17
    v_lshlrev_b32 v72, 16, v36
    v_and_b32 v73, 0xffff0000, v36
    v_lshlrev_b32 v18, 16, v51
    v_and_b32 v19, 0xffff0000, v51
    v_mul_f32 v16, v162, v18
    v_mul_f32 v17, v163, v19
    v_cvt_pk_bf16_f32 v18, v16, v17
    v_lshlrev_b32 v16, 16, v18
    v_and_b32 v17, 0xffff0000, v18
    v_mul_f32 v16, v16, v190
    v_mul_f32 v17, v17, v191
    v_cvt_pk_bf16_f32 v18, v16, v17
    v_lshlrev_b32 v16, 16, v18
    v_and_b32 v17, 0xffff0000, v18
    v_add_f32 v16, v16, v74
    v_add_f32 v17, v17, v75
    v_cvt_pk_bf16_f32 v37, v16, v17
    v_lshlrev_b32 v74, 16, v37
    v_and_b32 v75, 0xffff0000, v37
    v_lshlrev_b32 v18, 16, v52
    v_and_b32 v19, 0xffff0000, v52
    v_mul_f32 v16, v164, v18
    v_mul_f32 v17, v165, v19
    v_cvt_pk_bf16_f32 v18, v16, v17
    v_lshlrev_b32 v16, 16, v18
    v_and_b32 v17, 0xffff0000, v18
    v_mul_f32 v16, v16, v192
    v_mul_f32 v17, v17, v193
    v_cvt_pk_bf16_f32 v18, v16, v17
    v_lshlrev_b32 v16, 16, v18
    v_and_b32 v17, 0xffff0000, v18
    v_add_f32 v16, v16, v76
    v_add_f32 v17, v17, v77
    v_cvt_pk_bf16_f32 v38, v16, v17
    v_lshlrev_b32 v76, 16, v38
    v_and_b32 v77, 0xffff0000, v38
    v_lshlrev_b32 v18, 16, v53
    v_and_b32 v19, 0xffff0000, v53
    v_mul_f32 v16, v166, v18
    v_mul_f32 v17, v167, v19
    v_cvt_pk_bf16_f32 v18, v16, v17
    v_lshlrev_b32 v16, 16, v18
    v_and_b32 v17, 0xffff0000, v18
    v_mul_f32 v16, v16, v194
    v_mul_f32 v17, v17, v195
    v_cvt_pk_bf16_f32 v18, v16, v17
    v_lshlrev_b32 v16, 16, v18
    v_and_b32 v17, 0xffff0000, v18
    v_add_f32 v16, v16, v78
    v_add_f32 v17, v17, v79
    v_cvt_pk_bf16_f32 v39, v16, v17
    v_lshlrev_b32 v78, 16, v39
    v_and_b32 v79, 0xffff0000, v39
    v_lshlrev_b32 v18, 16, v54
    v_and_b32 v19, 0xffff0000, v54
    v_mul_f32 v16, v168, v18
    v_mul_f32 v17, v169, v19
    v_cvt_pk_bf16_f32 v18, v16, v17
    v_lshlrev_b32 v16, 16, v18
    v_and_b32 v17, 0xffff0000, v18
    v_mul_f32 v16, v16, v196
    v_mul_f32 v17, v17, v197
    v_cvt_pk_bf16_f32 v18, v16, v17
    v_lshlrev_b32 v16, 16, v18
    v_and_b32 v17, 0xffff0000, v18
    v_add_f32 v16, v16, v80
    v_add_f32 v17, v17, v81
    v_cvt_pk_bf16_f32 v40, v16, v17
    v_lshlrev_b32 v80, 16, v40
    v_and_b32 v81, 0xffff0000, v40
    v_lshlrev_b32 v18, 16, v55
    v_and_b32 v19, 0xffff0000, v55
    v_mul_f32 v16, v170, v18
    v_mul_f32 v17, v171, v19
    v_cvt_pk_bf16_f32 v18, v16, v17
    v_lshlrev_b32 v16, 16, v18
    v_and_b32 v17, 0xffff0000, v18
    v_mul_f32 v16, v16, v198
    v_mul_f32 v17, v17, v199
    v_cvt_pk_bf16_f32 v18, v16, v17
    v_lshlrev_b32 v16, 16, v18
    v_and_b32 v17, 0xffff0000, v18
    v_add_f32 v16, v16, v82
    v_add_f32 v17, v17, v83
    v_cvt_pk_bf16_f32 v41, v16, v17
    v_lshlrev_b32 v82, 16, v41
    v_and_b32 v83, 0xffff0000, v41
    v_lshlrev_b32 v18, 16, v56
    v_and_b32 v19, 0xffff0000, v56
    v_mul_f32 v16, v172, v18
    v_mul_f32 v17, v173, v19
    v_cvt_pk_bf16_f32 v18, v16, v17
    v_lshlrev_b32 v16, 16, v18
    v_and_b32 v17, 0xffff0000, v18
    v_mul_f32 v16, v16, v200
    v_mul_f32 v17, v17, v201
    v_cvt_pk_bf16_f32 v18, v16, v17
    v_lshlrev_b32 v16, 16, v18
    v_and_b32 v17, 0xffff0000, v18
    v_add_f32 v16, v16, v84
    v_add_f32 v17, v17, v85
    v_cvt_pk_bf16_f32 v42, v16, v17
    v_lshlrev_b32 v84, 16, v42
    v_and_b32 v85, 0xffff0000, v42
    v_lshlrev_b32 v18, 16, v57
    v_and_b32 v19, 0xffff0000, v57
    v_mul_f32 v16, v174, v18
    v_mul_f32 v17, v175, v19
    v_cvt_pk_bf16_f32 v18, v16, v17
    v_lshlrev_b32 v16, 16, v18
    v_and_b32 v17, 0xffff0000, v18
    v_mul_f32 v16, v16, v202
    v_mul_f32 v17, v17, v203
    v_cvt_pk_bf16_f32 v18, v16, v17
    v_lshlrev_b32 v16, 16, v18
    v_and_b32 v17, 0xffff0000, v18
    v_add_f32 v16, v16, v86
    v_add_f32 v17, v17, v87
    v_cvt_pk_bf16_f32 v43, v16, v17
    v_lshlrev_b32 v86, 16, v43
    v_and_b32 v87, 0xffff0000, v43
    v_lshlrev_b32 v18, 16, v58
    v_and_b32 v19, 0xffff0000, v58
    v_mul_f32 v16, v176, v18
    v_mul_f32 v17, v177, v19
    v_cvt_pk_bf16_f32 v18, v16, v17
    v_lshlrev_b32 v16, 16, v18
    v_and_b32 v17, 0xffff0000, v18
    v_mul_f32 v16, v16, v204
    v_mul_f32 v17, v17, v205
    v_cvt_pk_bf16_f32 v18, v16, v17
    v_lshlrev_b32 v16, 16, v18
    v_and_b32 v17, 0xffff0000, v18
    v_add_f32 v16, v16, v88
    v_add_f32 v17, v17, v89
    v_cvt_pk_bf16_f32 v44, v16, v17
    v_lshlrev_b32 v88, 16, v44
    v_and_b32 v89, 0xffff0000, v44
    v_lshlrev_b32 v18, 16, v59
    v_and_b32 v19, 0xffff0000, v59
    v_mul_f32 v16, v178, v18
    v_mul_f32 v17, v179, v19
    v_cvt_pk_bf16_f32 v18, v16, v17
    v_lshlrev_b32 v16, 16, v18
    v_and_b32 v17, 0xffff0000, v18
    v_mul_f32 v16, v16, v206
    v_mul_f32 v17, v17, v207
    v_cvt_pk_bf16_f32 v18, v16, v17
    v_lshlrev_b32 v16, 16, v18
    v_and_b32 v17, 0xffff0000, v18
    v_add_f32 v16, v16, v90
    v_add_f32 v17, v17, v91
    v_cvt_pk_bf16_f32 v45, v16, v17
    v_lshlrev_b32 v90, 16, v45
    v_and_b32 v91, 0xffff0000, v45
    s_cmp_lg_u32 s11, 0
    s_cbranch_scc1 K2_nostore_13
    buffer_store_dwordx2 v[32:33], v3, s[32:35], 0 offen offset:0
    buffer_store_dwordx2 v[34:35], v3, s[32:35], 0 offen offset:8
    buffer_store_dwordx2 v[36:37], v3, s[32:35], 0 offen offset:16
    buffer_store_dwordx2 v[38:39], v3, s[32:35], 0 offen offset:24
    buffer_store_dwordx2 v[40:41], v3, s[32:35], 0 offen offset:32
    buffer_store_dwordx2 v[42:43], v3, s[32:35], 0 offen offset:40
    buffer_store_dwordx2 v[44:45], v3, s[32:35], 0 offen offset:48
K2_nostore_13:
    v_add_f32 v15, v64, v65
    v_add_f32 v15, v15, v66
    v_add_f32 v15, v15, v67
    v_add_f32 v15, v15, v68
    v_add_f32 v15, v15, v69
    v_add_f32 v15, v15, v70
    v_add_f32 v15, v15, v71
    v_add_f32 v15, v15, v72
    v_add_f32 v15, v15, v73
    v_add_f32 v15, v15, v74
    v_add_f32 v15, v15, v75
    v_add_f32 v15, v15, v76
    v_add_f32 v15, v15, v77
    v_add_f32 v15, v15, v78
    v_add_f32 v15, v15, v79
    v_add_f32 v15, v15, v80
    v_add_f32 v15, v15, v81
    v_add_f32 v15, v15, v82
    v_add_f32 v15, v15, v83
    v_add_f32 v15, v15, v84
    v_add_f32 v15, v15, v85
    v_add_f32 v15, v15, v86
    v_add_f32 v15, v15, v87
    v_add_f32 v15, v15, v88
    v_add_f32 v15, v15, v89
    v_add_f32 v15, v15, v90
    v_add_f32 v15, v15, v91
    s_nop 1
    v_add_f32_dpp v16, v15, v15 row_ror:8 row_mask:0xf bank_mask:0xf
    v_mov_b32 v15, v16
    s_nop 1
    v_add_f32_dpp v16, v15, v15 row_ror:4 row_mask:0xf bank_mask:0xf
    v_mov_b32 v15, v16
    s_nop 1
    v_add_f32_dpp v16, v15, v15 row_ror:2 row_mask:0xf bank_mask:0xf
    v_mov_b32 v15, v16
    s_nop 1
    v_add_f32_dpp v16, v15, v15 row_ror:1 row_mask:0xf bank_mask:0xf
    v_mov_b32 v15, v16
    s_nop 1
    v_mov_b32_dpp v15, v16 row_newbcast:0 row_mask:0xf bank_mask:0xf
    v_mul_f32 v12, 0x3b124925, v15
    v_mov_b32 v15, 0
    v_sub_f32 v16, v64, v12
    v_fmac_f32 v15, v16, v16
    v_sub_f32 v16, v65, v12
    v_fmac_f32 v15, v16, v16
    v_sub_f32 v16, v66, v12
    v_fmac_f32 v15, v16, v16
    v_sub_f32 v16, v67, v12
    v_fmac_f32 v15, v16, v16
    v_sub_f32 v16, v68, v12
    v_fmac_f32 v15, v16, v16
    v_sub_f32 v16, v69, v12
    v_fmac_f32 v15, v16, v16
    v_sub_f32 v16, v70, v12
    v_fmac_f32 v15, v16, v16
    v_sub_f32 v16, v71, v12
    v_fmac_f32 v15, v16, v16
    v_sub_f32 v16, v72, v12
    v_fmac_f32 v15, v16, v16
    v_sub_f32 v16, v73, v12
    v_fmac_f32 v15, v16, v16
    v_sub_f32 v16, v74, v12
    v_fmac_f32 v15, v16, v16
    v_sub_f32 v16, v75, v12
    v_fmac_f32 v15, v16, v16
    v_sub_f32 v16, v76, v12
    v_fmac_f32 v15, v16, v16
    v_sub_f32 v16, v77, v12
    v_fmac_f32 v15, v16, v16
    v_sub_f32 v16, v78, v12
    v_fmac_f32 v15, v16, v16
    v_sub_f32 v16, v79, v12
    v_fmac_f32 v15, v16, v16
    v_sub_f32 v16, v80, v12
    v_fmac_f32 v15, v16, v16
    v_sub_f32 v16, v81, v12
    v_fmac_f32 v15, v16, v16
    v_sub_f32 v16, v82, v12
    v_fmac_f32 v15, v16, v16
    v_sub_f32 v16, v83, v12
    v_fmac_f32 v15, v16, v16
    v_sub_f32 v16, v84, v12
    v_fmac_f32 v15, v16, v16
    v_sub_f32 v16, v85, v12
    v_fmac_f32 v15, v16, v16
    v_sub_f32 v16, v86, v12
    v_fmac_f32 v15, v16, v16
    v_sub_f32 v16, v87, v12
    v_fmac_f32 v15, v16, v16
    v_sub_f32 v16, v88, v12
    v_fmac_f32 v15, v16, v16
    v_sub_f32 v16, v89, v12
    v_fmac_f32 v15, v16, v16
    v_sub_f32 v16, v90, v12
    v_fmac_f32 v15, v16, v16
    v_sub_f32 v16, v91, v12
    v_fmac_f32 v15, v16, v16
    s_nop 1
    v_add_f32_dpp v16, v15, v15 row_ror:8 row_mask:0xf bank_mask:0xf
    v_mov_b32 v15, v16
    s_nop 1
    v_add_f32_dpp v16, v15, v15 row_ror:4 row_mask:0xf bank_mask:0xf
    v_mov_b32 v15, v16
    s_nop 1
    v_add_f32_dpp v16, v15, v15 row_ror:2 row_mask:0xf bank_mask:0xf
    v_mov_b32 v15, v16
    s_nop 1
    v_add_f32_dpp v16, v15, v15 row_ror:1 row_mask:0xf bank_mask:0xf
    v_mov_b32 v15, v16
    s_nop 1
    v_mov_b32_dpp v15, v16 row_newbcast:0 row_mask:0xf bank_mask:0xf
    v_mul_f32 v13, 0x3b124925, v15
    v_cvt_pk_bf16_f32 v12, v12, v12
    v_lshlrev_b32 v12, 16, v12
    v_cvt_pk_bf16_f32 v13, v13, v13
    v_lshlrev_b32 v13, 16, v13
    v_add_f32 v13, 0x3727c5ac, v13
    v_cvt_pk_bf16_f32 v13, v13, v13
    v_lshlrev_b32 v13, 16, v13
    v_sqrt_f32 v13, v13
    s_nop 0
    v_cvt_pk_bf16_f32 v13, v13, v13
    v_lshlrev_b32 v13, 16, v13
    v_rcp_f32 v14, v13
    s_nop 0
    s_waitcnt vmcnt(0)
    s_add_u32 s18, s19, 28672
    buffer_load_dwordx4 a[112:115], v252, s[36:39], s18 offen offset:0
    buffer_load_dwordx4 a[116:119], v252, s[36:39], s18 offen offset:1024
    buffer_load_dwordx4 a[120:123], v252, s[36:39], s18 offen offset:2048
    buffer_load_dwordx4 a[124:127], v252, s[36:39], s18 offen offset:3072
    s_add_u32 s18, s19, 32768
    buffer_load_dwordx4 a[128:131], v252, s[36:39], s18 offen offset:0
    buffer_load_dwordx4 a[132:135], v252, s[36:39], s18 offen offset:1024
    buffer_load_dwordx4 a[136:139], v252, s[36:39], s18 offen offset:2048
    buffer_load_dwordx4 a[140:143], v252, s[36:39], s18 offen offset:3072
    s_add_u32 s18, s19, 36864
    buffer_load_dwordx4 a[144:147], v252, s[36:39], s18 offen offset:0
    buffer_load_dwordx4 a[148:151], v252, s[36:39], s18 offen offset:1024
    buffer_load_dwordx4 a[152:155], v252, s[36:39], s18 offen offset:2048
    buffer_load_dwordx4 a[156:159], v252, s[36:39], s18 offen offset:3072
    s_add_u32 s18, s19, 40960
    buffer_load_dwordx4 a[160:163], v252, s[36:39], s18 offen offset:0
    buffer_load_dwordx4 a[164:167], v252, s[36:39], s18 offen offset:1024
    v_sub_f32 v16, v64, v12
    v_sub_f32 v17, v65, v12
    v_cvt_pk_bf16_f32 v18, v16, v17
    v_lshlrev_b32 v16, 16, v18
    v_and_b32 v17, 0xffff0000, v18
    v_mul_f32 v18, v16, v14
    v_mul_f32 v19, v17, v14
    v_fma_f32 v16, -v18, v13, v16
    v_fma_f32 v17, -v19, v13, v17
    v_fma_f32 v16, v16, v14, v18
    v_fma_f32 v17, v17, v14, v19
    v_cvt_pk_bf16_f32 v18, v16, v17
    v_lshlrev_b32 v16, 16, v18
    v_and_b32 v17, 0xffff0000, v18
    v_add_f32 v18, 1.0, v208
    v_add_f32 v19, 1.0, v209
    v_cvt_pk_bf16_f32 v20, v18, v19
    v_lshlrev_b32 v18, 16, v20
    v_and_b32 v19, 0xffff0000, v20
    v_mul_f32 v16, v16, v18
    v_mul_f32 v17, v17, v19
    v_cvt_pk_bf16_f32 v18, v16, v17
    v_lshlrev_b32 v16, 16, v18
    v_and_b32 v17, 0xffff0000, v18
    v_add_f32 v16, v16, v96
    v_add_f32 v17, v17, v97
    v_cvt_pk_bf16_f32 v46, v16, v17
    v_sub_f32 v16, v66, v12
    v_sub_f32 v17, v67, v12
    v_cvt_pk_bf16_f32 v18, v16, v17
    v_lshlrev_b32 v16, 16, v18
    v_and_b32 v17, 0xffff0000, v18
    v_mul_f32 v18, v16, v14
    v_mul_f32 v19, v17, v14
    v_fma_f32 v16, -v18, v13, v16
    v_fma_f32 v17, -v19, v13, v17
    v_fma_f32 v16, v16, v14, v18
    v_fma_f32 v17, v17, v14, v19
    v_cvt_pk_bf16_f32 v18, v16, v17
    v_lshlrev_b32 v16, 16, v18
    v_and_b32 v17, 0xffff0000, v18
    v_add_f32 v18, 1.0, v210
    v_add_f32 v19, 1.0, v211
    v_cvt_pk_bf16_f32 v20, v18, v19
    v_lshlrev_b32 v18, 16, v20
    v_and_b32 v19, 0xffff0000, v20
    v_mul_f32 v16, v16, v18
    v_mul_f32 v17, v17, v19
    v_cvt_pk_bf16_f32 v18, v16, v17
    v_lshlrev_b32 v16, 16, v18
    v_and_b32 v17, 0xffff0000, v18
    v_add_f32 v16, v16, v98
    v_add_f32 v17, v17, v99
    v_cvt_pk_bf16_f32 v47, v16, v17
    v_sub_f32 v16, v68, v12
    v_sub_f32 v17, v69, v12
    v_cvt_pk_bf16_f32 v18, v16, v17
    v_lshlrev_b32 v16, 16, v18
    v_and_b32 v17, 0xffff0000, v18
    v_mul_f32 v18, v16, v14
    v_mul_f32 v19, v17, v14
    v_fma_f32 v16, -v18, v13, v16
    v_fma_f32 v17, -v19, v13, v17
    v_fma_f32 v16, v16, v14, v18
    v_fma_f32 v17, v17, v14, v19
    v_cvt_pk_bf16_f32 v18, v16, v17
    v_lshlrev_b32 v16, 16, v18
    v_and_b32 v17, 0xffff0000, v18
    v_add_f32 v18, 1.0, v212
    v_add_f32 v19, 1.0, v213
    v_cvt_pk_bf16_f32 v20, v18, v19
    v_lshlrev_b32 v18, 16, v20
    v_and_b32 v19, 0xffff0000, v20
    v_mul_f32 v16, v16, v18
    v_mul_f32 v17, v17, v19
    v_cvt_pk_bf16_f32 v18, v16, v17
    v_lshlrev_b32 v16, 16, v18
    v_and_b32 v17, 0xffff0000, v18
    v_add_f32 v16, v16, v100
    v_add_f32 v17, v17, v101
    v_cvt_pk_bf16_f32 v48, v16, v17
    v_sub_f32 v16, v70, v12
    v_sub_f32 v17, v71, v12
    v_cvt_pk_bf16_f32 v18, v16, v17
    v_lshlrev_b32 v16, 16, v18
    v_and_b32 v17, 0xffff0000, v18
    v_mul_f32 v18, v16, v14
    v_mul_f32 v19, v17, v14
    v_fma_f32 v16, -v18, v13, v16
    v_fma_f32 v17, -v19, v13, v17
    v_fma_f32 v16, v16, v14, v18
    v_fma_f32 v17, v17, v14, v19
    v_cvt_pk_bf16_f32 v18, v16, v17
    v_lshlrev_b32 v16, 16, v18
    v_and_b32 v17, 0xffff0000, v18
    v_add_f32 v18, 1.0, v214
    v_add_f32 v19, 1.0, v215
    v_cvt_pk_bf16_f32 v20, v18, v19
    v_lshlrev_b32 v18, 16, v20
    v_and_b32 v19, 0xffff0000, v20
    v_mul_f32 v16, v16, v18
    v_mul_f32 v17, v17, v19
    v_cvt_pk_bf16_f32 v18, v16, v17
    v_lshlrev_b32 v16, 16, v18
    v_and_b32 v17, 0xffff0000, v18
    v_add_f32 v16, v16, v102
    v_add_f32 v17, v17, v103
    v_cvt_pk_bf16_f32 v49, v16, v17
    v_sub_f32 v16, v72, v12
    v_sub_f32 v17, v73, v12
    v_cvt_pk_bf16_f32 v18, v16, v17
    v_lshlrev_b32 v16, 16, v18
    v_and_b32 v17, 0xffff0000, v18
    v_mul_f32 v18, v16, v14
    v_mul_f32 v19, v17, v14
    v_fma_f32 v16, -v18, v13, v16
    v_fma_f32 v17, -v19, v13, v17
    v_fma_f32 v16, v16, v14, v18
    v_fma_f32 v17, v17, v14, v19
    v_cvt_pk_bf16_f32 v18, v16, v17
    v_lshlrev_b32 v16, 16, v18
    v_and_b32 v17, 0xffff0000, v18
    v_add_f32 v18, 1.0, v216
    v_add_f32 v19, 1.0, v217
    v_cvt_pk_bf16_f32 v20, v18, v19
    v_lshlrev_b32 v18, 16, v20
    v_and_b32 v19, 0xffff0000, v20
    v_mul_f32 v16, v16, v18
    v_mul_f32 v17, v17, v19
    v_cvt_pk_bf16_f32 v18, v16, v17
    v_lshlrev_b32 v16, 16, v18
    v_and_b32 v17, 0xffff0000, v18
    v_add_f32 v16, v16, v104
    v_add_f32 v17, v17, v105
    v_cvt_pk_bf16_f32 v50, v16, v17
    v_sub_f32 v16, v74, v12
    v_sub_f32 v17, v75, v12
    v_cvt_pk_bf16_f32 v18, v16, v17
    v_lshlrev_b32 v16, 16, v18
    v_and_b32 v17, 0xffff0000, v18
    v_mul_f32 v18, v16, v14
    v_mul_f32 v19, v17, v14
    v_fma_f32 v16, -v18, v13, v16
    v_fma_f32 v17, -v19, v13, v17
    v_fma_f32 v16, v16, v14, v18
    v_fma_f32 v17, v17, v14, v19
    v_cvt_pk_bf16_f32 v18, v16, v17
    v_lshlrev_b32 v16, 16, v18
    v_and_b32 v17, 0xffff0000, v18
    v_add_f32 v18, 1.0, v218
    v_add_f32 v19, 1.0, v219
    v_cvt_pk_bf16_f32 v20, v18, v19
    v_lshlrev_b32 v18, 16, v20
    v_and_b32 v19, 0xffff0000, v20
    v_mul_f32 v16, v16, v18
    v_mul_f32 v17, v17, v19
    v_cvt_pk_bf16_f32 v18, v16, v17
    v_lshlrev_b32 v16, 16, v18
    v_and_b32 v17, 0xffff0000, v18
    v_add_f32 v16, v16, v106
    v_add_f32 v17, v17, v107
    v_cvt_pk_bf16_f32 v51, v16, v17
    v_sub_f32 v16, v76, v12
    v_sub_f32 v17, v77, v12
    v_cvt_pk_bf16_f32 v18, v16, v17
    v_lshlrev_b32 v16, 16, v18
    v_and_b32 v17, 0xffff0000, v18
    v_mul_f32 v18, v16, v14
    v_mul_f32 v19, v17, v14
    v_fma_f32 v16, -v18, v13, v16
    v_fma_f32 v17, -v19, v13, v17
    v_fma_f32 v16, v16, v14, v18
    v_fma_f32 v17, v17, v14, v19
    v_cvt_pk_bf16_f32 v18, v16, v17
    v_lshlrev_b32 v16, 16, v18
    v_and_b32 v17, 0xffff0000, v18
    v_add_f32 v18, 1.0, v220
    v_add_f32 v19, 1.0, v221
    v_cvt_pk_bf16_f32 v20, v18, v19
    v_lshlrev_b32 v18, 16, v20
    v_and_b32 v19, 0xffff0000, v20
    v_mul_f32 v16, v16, v18
    v_mul_f32 v17, v17, v19
    v_cvt_pk_bf16_f32 v18, v16, v17
    v_lshlrev_b32 v16, 16, v18
    v_and_b32 v17, 0xffff0000, v18
    v_add_f32 v16, v16, v108
    v_add_f32 v17, v17, v109
    v_cvt_pk_bf16_f32 v52, v16, v17
    v_sub_f32 v16, v78, v12
    v_sub_f32 v17, v79, v12
    v_cvt_pk_bf16_f32 v18, v16, v17
    v_lshlrev_b32 v16, 16, v18
    v_and_b32 v17, 0xffff0000, v18
    v_mul_f32 v18, v16, v14
    v_mul_f32 v19, v17, v14
    v_fma_f32 v16, -v18, v13, v16
    v_fma_f32 v17, -v19, v13, v17
    v_fma_f32 v16, v16, v14, v18
    v_fma_f32 v17, v17, v14, v19
    v_cvt_pk_bf16_f32 v18, v16, v17
    v_lshlrev_b32 v16, 16, v18
    v_and_b32 v17, 0xffff0000, v18
    v_add_f32 v18, 1.0, v222
    v_add_f32 v19, 1.0, v223
    v_cvt_pk_bf16_f32 v20, v18, v19
    v_lshlrev_b32 v18, 16, v20
    v_and_b32 v19, 0xffff0000, v20
    v_mul_f32 v16, v16, v18
    v_mul_f32 v17, v17, v19
    v_cvt_pk_bf16_f32 v18, v16, v17
    v_lshlrev_b32 v16, 16, v18
    v_and_b32 v17, 0xffff0000, v18
    v_add_f32 v16, v16, v110
    v_add_f32 v17, v17, v111
    v_cvt_pk_bf16_f32 v53, v16, v17
    v_sub_f32 v16, v80, v12
    v_sub_f32 v17, v81, v12
    v_cvt_pk_bf16_f32 v18, v16, v17
    v_lshlrev_b32 v16, 16, v18
    v_and_b32 v17, 0xffff0000, v18
    v_mul_f32 v18, v16, v14
    v_mul_f32 v19, v17, v14
    v_fma_f32 v16, -v18, v13, v16
    v_fma_f32 v17, -v19, v13, v17
    v_fma_f32 v16, v16, v14, v18
    v_fma_f32 v17, v17, v14, v19
    v_cvt_pk_bf16_f32 v18, v16, v17
    v_lshlrev_b32 v16, 16, v18
    v_and_b32 v17, 0xffff0000, v18
    v_add_f32 v18, 1.0, v224
    v_add_f32 v19, 1.0, v225
    v_cvt_pk_bf16_f32 v20, v18, v19
    v_lshlrev_b32 v18, 16, v20
    v_and_b32 v19, 0xffff0000, v20
    v_mul_f32 v16, v16, v18
    v_mul_f32 v17, v17, v19
    v_cvt_pk_bf16_f32 v18, v16, v17
    v_lshlrev_b32 v16, 16, v18
    v_and_b32 v17, 0xffff0000, v18
    v_add_f32 v16, v16, v112
    v_add_f32 v17, v17, v113
    v_cvt_pk_bf16_f32 v54, v16, v17
    v_sub_f32 v16, v82, v12
    v_sub_f32 v17, v83, v12
    v_cvt_pk_bf16_f32 v18, v16, v17
    v_lshlrev_b32 v16, 16, v18
    v_and_b32 v17, 0xffff0000, v18
    v_mul_f32 v18, v16, v14
    v_mul_f32 v19, v17, v14
    v_fma_f32 v16, -v18, v13, v16
    v_fma_f32 v17, -v19, v13, v17
    v_fma_f32 v16, v16, v14, v18
    v_fma_f32 v17, v17, v14, v19
    v_cvt_pk_bf16_f32 v18, v16, v17
    v_lshlrev_b32 v16, 16, v18
    v_and_b32 v17, 0xffff0000, v18
    v_add_f32 v18, 1.0, v226
    v_add_f32 v19, 1.0, v227
    v_cvt_pk_bf16_f32 v20, v18, v19
    v_lshlrev_b32 v18, 16, v20
    v_and_b32 v19, 0xffff0000, v20
    v_mul_f32 v16, v16, v18
    v_mul_f32 v17, v17, v19
    v_cvt_pk_bf16_f32 v18, v16, v17
    v_lshlrev_b32 v16, 16, v18
    v_and_b32 v17, 0xffff0000, v18
    v_add_f32 v16, v16, v114
    v_add_f32 v17, v17, v115
    v_cvt_pk_bf16_f32 v55, v16, v17
    v_sub_f32 v16, v84, v12
    v_sub_f32 v17, v85, v12
    v_cvt_pk_bf16_f32 v18, v16, v17
    v_lshlrev_b32 v16, 16, v18
    v_and_b32 v17, 0xffff0000, v18
    v_mul_f32 v18, v16, v14
    v_mul_f32 v19, v17, v14
    v_fma_f32 v16, -v18, v13, v16
    v_fma_f32 v17, -v19, v13, v17
    v_fma_f32 v16, v16, v14, v18
    v_fma_f32 v17, v17, v14, v19
    v_cvt_pk_bf16_f32 v18, v16, v17
    v_lshlrev_b32 v16, 16, v18
    v_and_b32 v17, 0xffff0000, v18
    v_add_f32 v18, 1.0, v228
    v_add_f32 v19, 1.0, v229
    v_cvt_pk_bf16_f32 v20, v18, v19
    v_lshlrev_b32 v18, 16, v20
    v_and_b32 v19, 0xffff0000, v20
    v_mul_f32 v16, v16, v18
    v_mul_f32 v17, v17, v19
    v_cvt_pk_bf16_f32 v18, v16, v17
    v_lshlrev_b32 v16, 16, v18
    v_and_b32 v17, 0xffff0000, v18
    v_add_f32 v16, v16, v116
    v_add_f32 v17, v17, v117
    v_cvt_pk_bf16_f32 v56, v16, v17
    v_sub_f32 v16, v86, v12
    v_sub_f32 v17, v87, v12
    v_cvt_pk_bf16_f32 v18, v16, v17
    v_lshlrev_b32 v16, 16, v18
    v_and_b32 v17, 0xffff0000, v18
    v_mul_f32 v18, v16, v14
    v_mul_f32 v19, v17, v14
    v_fma_f32 v16, -v18, v13, v16
    v_fma_f32 v17, -v19, v13, v17
    v_fma_f32 v16, v16, v14, v18
    v_fma_f32 v17, v17, v14, v19
    v_cvt_pk_bf16_f32 v18, v16, v17
    v_lshlrev_b32 v16, 16, v18
    v_and_b32 v17, 0xffff0000, v18
    v_add_f32 v18, 1.0, v230
    v_add_f32 v19, 1.0, v231
    v_cvt_pk_bf16_f32 v20, v18, v19
    v_lshlrev_b32 v18, 16, v20
    v_and_b32 v19, 0xffff0000, v20
    v_mul_f32 v16, v16, v18
    v_mul_f32 v17, v17, v19
    v_cvt_pk_bf16_f32 v18, v16, v17
    v_lshlrev_b32 v16, 16, v18
    v_and_b32 v17, 0xffff0000, v18
    v_add_f32 v16, v16, v118
    v_add_f32 v17, v17, v119
    v_cvt_pk_bf16_f32 v57, v16, v17
    v_sub_f32 v16, v88, v12
    v_sub_f32 v17, v89, v12
    v_cvt_pk_bf16_f32 v18, v16, v17
    v_lshlrev_b32 v16, 16, v18
    v_and_b32 v17, 0xffff0000, v18
    v_mul_f32 v18, v16, v14
    v_mul_f32 v19, v17, v14
    v_fma_f32 v16, -v18, v13, v16
    v_fma_f32 v17, -v19, v13, v17
    v_fma_f32 v16, v16, v14, v18
    v_fma_f32 v17, v17, v14, v19
    v_cvt_pk_bf16_f32 v18, v16, v17
    v_lshlrev_b32 v16, 16, v18
    v_and_b32 v17, 0xffff0000, v18
    v_add_f32 v18, 1.0, v232
    v_add_f32 v19, 1.0, v233
    v_cvt_pk_bf16_f32 v20, v18, v19
    v_lshlrev_b32 v18, 16, v20
    v_and_b32 v19, 0xffff0000, v20
    v_mul_f32 v16, v16, v18
    v_mul_f32 v17, v17, v19
    v_cvt_pk_bf16_f32 v18, v16, v17
    v_lshlrev_b32 v16, 16, v18
    v_and_b32 v17, 0xffff0000, v18
    v_add_f32 v16, v16, v120
    v_add_f32 v17, v17, v121
    v_cvt_pk_bf16_f32 v58, v16, v17
    v_sub_f32 v16, v90, v12
    v_sub_f32 v17, v91, v12
    v_cvt_pk_bf16_f32 v18, v16, v17
    v_lshlrev_b32 v16, 16, v18
    v_and_b32 v17, 0xffff0000, v18
    v_mul_f32 v18, v16, v14
    v_mul_f32 v19, v17, v14
    v_fma_f32 v16, -v18, v13, v16
    v_fma_f32 v17, -v19, v13, v17
    v_fma_f32 v16, v16, v14, v18
    v_fma_f32 v17, v17, v14, v19
    v_cvt_pk_bf16_f32 v18, v16, v17
    v_lshlrev_b32 v16, 16, v18
    v_and_b32 v17, 0xffff0000, v18
    v_add_f32 v18, 1.0, v234
    v_add_f32 v19, 1.0, v235
    v_cvt_pk_bf16_f32 v20, v18, v19
    v_lshlrev_b32 v18, 16, v20
    v_and_b32 v19, 0xffff0000, v20
    v_mul_f32 v16, v16, v18
    v_mul_f32 v17, v17, v19
    v_cvt_pk_bf16_f32 v18, v16, v17
    v_lshlrev_b32 v16, 16, v18
    v_and_b32 v17, 0xffff0000, v18
    v_add_f32 v16, v16, v122
    v_add_f32 v17, v17, v123
    v_cvt_pk_bf16_f32 v59, v16, v17
    v_mul_u32_u24 v6, 912, v1
    v_add_u32 v6, v6, v4
    ds_write_b64 v6, v[46:47] offset:14848
    ds_write_b64 v6, v[48:49] offset:14856
    ds_write_b64 v6, v[50:51] offset:14864
    ds_write_b64 v6, v[52:53] offset:14872
    ds_write_b64 v6, v[54:55] offset:14880
    ds_write_b64 v6, v[56:57] offset:14888
    ds_write_b64 v6, v[58:59] offset:14896
    s_waitcnt lgkmcnt(0)
    s_barrier
    v_and_b32 v1, 15, v0
    v_lshrrev_b32 v2, 4, v0
    v_and_b32 v2, 3, v2
    v_lshrrev_b32 v3, 6, v0
    v_mul_u32_u24 v4, 912, v1
    v_lshlrev_b32 v5, 4, v2
    v_add_u32 v4, v4, v5
    ds_read_b128 v[32:35], v4 offset:14848
    ds_read_b128 v[36:39], v4 offset:14912
    ds_read_b128 v[40:43], v4 offset:14976
    ds_read_b128 v[44:47], v4 offset:15040
    ds_read_b128 v[48:51], v4 offset:15104
    ds_read_b128 v[52:55], v4 offset:15168
    ds_read_b128 v[56:59], v4 offset:15232
    ds_read_b128 v[60:63], v4 offset:15296
    ds_read_b128 v[64:67], v4 offset:15360
    ds_read_b128 v[68:71], v4 offset:15424
    ds_read_b128 v[72:75], v4 offset:15488
    ds_read_b128 v[76:79], v4 offset:15552
    ds_read_b128 v[80:83], v4 offset:15616
    ds_read_b128 v[84:87], v4 offset:15680
    s_mov_b32 s14, 0xbdd2d3e8
    v_mov_b32 v254, 0xc0135761
    s_cmp_eq_u32 s11, 1
    s_cbranch_scc1 K2_half1_14
    v_add_u32 v8, s12, v1
    v_mul_u32_u24 v8, 1792, v8
    v_mul_u32_u24 v9, 448, v3
    v_add_u32 v8, v8, v9
    v_lshlrev_b32 v9, 3, v2
    v_add_u32 v8, v8, v9
    s_add_u32 s18, s19, 43008
    buffer_load_dwordx4 a[168:171], v252, s[36:39], s18 offen offset:0
    buffer_load_dwordx4 a[172:175], v252, s[36:39], s18 offen offset:1024
    buffer_load_dwordx4 a[176:179], v252, s[36:39], s18 offen offset:2048
    buffer_load_dwordx4 a[180:183], v252, s[36:39], s18 offen offset:3072
    s_add_u32 s18, s19, 47104
    buffer_load_dwordx4 a[184:187], v252, s[36:39], s18 offen offset:0
    buffer_load_dwordx4 a[188:191], v252, s[36:39], s18 offen offset:1024
    buffer_load_dwordx4 a[192:195], v252, s[36:39], s18 offen offset:2048
    buffer_load_dwordx4 a[196:199], v252, s[36:39], s18 offen offset:3072
    s_add_u32 s18, s19, 51200
    buffer_load_dwordx4 a[200:203], v252, s[36:39], s18 offen offset:0
    buffer_load_dwordx4 a[204:207], v252, s[36:39], s18 offen offset:1024
    buffer_load_dwordx4 a[208:211], v252, s[36:39], s18 offen offset:2048
    buffer_load_dwordx4 a[212:215], v252, s[36:39], s18 offen offset:3072
    s_add_u32 s18, s19, 55296
    buffer_load_dwordx4 a[216:219], v252, s[36:39], s18 offen offset:0
    buffer_load_dwordx4 a[220:223], v252, s[36:39], s18 offen offset:1024
    v_mov_b32 v228, 0
    v_mov_b32 v229, 0
    v_mov_b32 v230, 0
    v_mov_b32 v231, 0
    s_nop 1
    s_waitcnt vmcnt(42) lgkmcnt(0)
    v_mfma_f32_16x16x32_bf16 v[228:231], a[0:3], v[32:35], v[228:231]
    v_mfma_f32_16x16x32_bf16 v[228:231], a[4:7], v[36:39], v[228:231]
    v_mfma_f32_16x16x32_bf16 v[228:231], a[8:11], v[40:43], v[228:231]
    v_mfma_f32_16x16x32_bf16 v[228:231], a[12:15], v[44:47], v[228:231]
    v_mfma_f32_16x16x32_bf16 v[228:231], a[16:19], v[48:51], v[228:231]
    v_mfma_f32_16x16x32_bf16 v[228:231], a[20:23], v[52:55], v[228:231]
    v_mfma_f32_16x16x32_bf16 v[228:231], a[24:27], v[56:59], v[228:231]
    v_mfma_f32_16x16x32_bf16 v[228:231], a[28:31], v[60:63], v[228:231]
    v_mfma_f32_16x16x32_bf16 v[228:231], a[32:35], v[64:67], v[228:231]
    v_mfma_f32_16x16x32_bf16 v[228:231], a[36:39], v[68:71], v[228:231]
    v_mfma_f32_16x16x32_bf16 v[228:231], a[40:43], v[72:75], v[228:231]
    v_mfma_f32_16x16x32_bf16 v[228:231], a[44:47], v[76:79], v[228:231]
    v_mfma_f32_16x16x32_bf16 v[228:231], a[48:51], v[80:83], v[228:231]
    v_mfma_f32_16x16x32_bf16 v[228:231], a[52:55], v[84:87], v[228:231]
    s_nop 7
    s_nop 1
    v_cvt_pk_bf16_f32 v232, v228, v229
    v_lshlrev_b32 v228, 16, v232
    v_and_b32 v229, 0xffff0000, v232
    v_cvt_pk_bf16_f32 v232, v230, v231
    v_lshlrev_b32 v230, 16, v232
    v_and_b32 v231, 0xffff0000, v232
    v_mul_f32 v233, v228, v228
    v_fma_f32 v233, v233, s14, v254
    v_mul_f32 v233, v233, v228
    v_exp_f32 v233, v233
    v_mul_f32 v234, v229, v229
    v_fma_f32 v234, v234, s14, v254
    v_mul_f32 v234, v234, v229
    v_exp_f32 v234, v234
    v_mul_f32 v235, v230, v230
    v_fma_f32 v235, v235, s14, v254
    v_mul_f32 v235, v235, v230
    v_exp_f32 v235, v235
    v_mul_f32 v236, v231, v231
    v_fma_f32 v236, v236, s14, v254
    v_mul_f32 v236, v236, v231
    v_exp_f32 v236, v236
    s_nop 0
    v_add_f32 v233, 1.0, v233
    v_rcp_f32 v233, v233
    v_add_f32 v234, 1.0, v234
    v_rcp_f32 v234, v234
    v_add_f32 v235, 1.0, v235
    v_rcp_f32 v235, v235
    v_add_f32 v236, 1.0, v236
    v_rcp_f32 v236, v236
    s_nop 0
    v_mul_f32 v228, v228, v233
    v_mul_f32 v229, v229, v234
    v_mul_f32 v230, v230, v235
    v_mul_f32 v231, v231, v236
    v_cvt_pk_bf16_f32 v200, v228, v229
    v_cvt_pk_bf16_f32 v201, v230, v231
    buffer_store_dwordx2 v[200:201], v8, s[40:43], 0 offen offset:0
    s_add_u32 s18, s19, 57344
    buffer_load_dwordx4 a[0:3], v252, s[36:39], s18 offen offset:0
    buffer_load_dwordx4 a[4:7], v252, s[36:39], s18 offen offset:1024
    buffer_load_dwordx4 a[8:11], v252, s[36:39], s18 offen offset:2048
    buffer_load_dwordx4 a[12:15], v252, s[36:39], s18 offen offset:3072
    s_add_u32 s18, s19, 61440
    buffer_load_dwordx4 a[16:19], v252, s[36:39], s18 offen offset:0
    buffer_load_dwordx4 a[20:23], v252, s[36:39], s18 offen offset:1024
    buffer_load_dwordx4 a[24:27], v252, s[36:39], s18 offen offset:2048
    buffer_load_dwordx4 a[28:31], v252, s[36:39], s18 offen offset:3072
    s_add_u32 s18, s19, 65536
    buffer_load_dwordx4 a[32:35], v252, s[36:39], s18 offen offset:0
    buffer_load_dwordx4 a[36:39], v252, s[36:39], s18 offen offset:1024
    buffer_load_dwordx4 a[40:43], v252, s[36:39], s18 offen offset:2048
    buffer_load_dwordx4 a[44:47], v252, s[36:39], s18 offen offset:3072
    s_add_u32 s18, s19, 69632
    buffer_load_dwordx4 a[48:51], v252, s[36:39], s18 offen offset:0
    buffer_load_dwordx4 a[52:55], v252, s[36:39], s18 offen offset:1024
    v_mov_b32 v228, 0
    v_mov_b32 v229, 0
    v_mov_b32 v230, 0
    v_mov_b32 v231, 0
    s_nop 1
    s_waitcnt vmcnt(42) lgkmcnt(0)
    v_mfma_f32_16x16x32_bf16 v[228:231], a[56:59], v[32:35], v[228:231]
    v_mfma_f32_16x16x32_bf16 v[228:231], a[60:63], v[36:39], v[228:231]
    v_mfma_f32_16x16x32_bf16 v[228:231], a[64:67], v[40:43], v[228:231]
    v_mfma_f32_16x16x32_bf16 v[228:231], a[68:71], v[44:47], v[228:231]
    v_mfma_f32_16x16x32_bf16 v[228:231], a[72:75], v[48:51], v[228:231]
    v_mfma_f32_16x16x32_bf16 v[228:231], a[76:79], v[52:55], v[228:231]
    v_mfma_f32_16x16x32_bf16 v[228:231], a[80:83], v[56:59], v[228:231]
    v_mfma_f32_16x16x32_bf16 v[228:231], a[84:87], v[60:63], v[228:231]
    v_mfma_f32_16x16x32_bf16 v[228:231], a[88:91], v[64:67], v[228:231]
    v_mfma_f32_16x16x32_bf16 v[228:231], a[92:95], v[68:71], v[228:231]
    v_mfma_f32_16x16x32_bf16 v[228:231], a[96:99], v[72:75], v[228:231]
    v_mfma_f32_16x16x32_bf16 v[228:231], a[100:103], v[76:79], v[228:231]
    v_mfma_f32_16x16x32_bf16 v[228:231], a[104:107], v[80:83], v[228:231]
    v_mfma_f32_16x16x32_bf16 v[228:231], a[108:111], v[84:87], v[228:231]
    s_nop 7
    s_nop 1
    v_cvt_pk_bf16_f32 v232, v228, v229
    v_lshlrev_b32 v228, 16, v232
    v_and_b32 v229, 0xffff0000, v232
    v_cvt_pk_bf16_f32 v232, v230, v231
    v_lshlrev_b32 v230, 16, v232
    v_and_b32 v231, 0xffff0000, v232
    v_mul_f32 v233, v228, v228
    v_fma_f32 v233, v233, s14, v254
    v_mul_f32 v233, v233, v228
    v_exp_f32 v233, v233
    v_mul_f32 v234, v229, v229
    v_fma_f32 v234, v234, s14, v254
    v_mul_f32 v234, v234, v229
    v_exp_f32 v234, v234
    v_mul_f32 v235, v230, v230
    v_fma_f32 v235, v235, s14, v254
    v_mul_f32 v235, v235, v230
    v_exp_f32 v235, v235
    v_mul_f32 v236, v231, v231
    v_fma_f32 v236, v236, s14, v254
    v_mul_f32 v236, v236, v231
    v_exp_f32 v236, v236
    s_nop 0
    v_add_f32 v233, 1.0, v233
    v_rcp_f32 v233, v233
    v_add_f32 v234, 1.0, v234
    v_rcp_f32 v234, v234
    v_add_f32 v235, 1.0, v235
    v_rcp_f32 v235, v235
    v_add_f32 v236, 1.0, v236
    v_rcp_f32 v236, v236
    s_nop 0
    v_mul_f32 v228, v228, v233
    v_mul_f32 v229, v229, v234
    v_mul_f32 v230, v230, v235
    v_mul_f32 v231, v231, v236
    v_cvt_pk_bf16_f32 v202, v228, v229
    v_cvt_pk_bf16_f32 v203, v230, v231
    buffer_store_dwordx2 v[202:203], v8, s[40:43], 0 offen offset:32
    s_add_u32 s18, s19, 71680
    buffer_load_dwordx4 a[56:59], v252, s[36:39], s18 offen offset:0
    buffer_load_dwordx4 a[60:63], v252, s[36:39], s18 offen offset:1024
    buffer_load_dwordx4 a[64:67], v252, s[36:39], s18 offen offset:2048
    buffer_load_dwordx4 a[68:71], v252, s[36:39], s18 offen offset:3072
    s_add_u32 s18, s19, 75776
    buffer_load_dwordx4 a[72:75], v252, s[36:39], s18 offen offset:0
    buffer_load_dwordx4 a[76:79], v252, s[36:39], s18 offen offset:1024
    buffer_load_dwordx4 a[80:83], v252, s[36:39], s18 offen offset:2048
    buffer_load_dwordx4 a[84:87], v252, s[36:39], s18 offen offset:3072
    s_add_u32 s18, s19, 79872
    buffer_load_dwordx4 a[88:91], v252, s[36:39], s18 offen offset:0
    buffer_load_dwordx4 a[92:95], v252, s[36:39], s18 offen offset:1024
    buffer_load_dwordx4 a[96:99], v252, s[36:39], s18 offen offset:2048
    buffer_load_dwordx4 a[100:103], v252, s[36:39], s18 offen offset:3072
    s_add_u32 s18, s19, 83968
    buffer_load_dwordx4 a[104:107], v252, s[36:39], s18 offen offset:0
    buffer_load_dwordx4 a[108:111], v252, s[36:39], s18 offen offset:1024
    v_mov_b32 v228, 0
    v_mov_b32 v229, 0
    v_mov_b32 v230, 0
    v_mov_b32 v231, 0
    s_nop 1
    s_waitcnt vmcnt(42) lgkmcnt(0)
    v_mfma_f32_16x16x32_bf16 v[228:231], a[112:115], v[32:35], v[228:231]
    v_mfma_f32_16x16x32_bf16 v[228:231], a[116:119], v[36:39], v[228:231]
    v_mfma_f32_16x16x32_bf16 v[228:231], a[120:123], v[40:43], v[228:231]
    v_mfma_f32_16x16x32_bf16 v[228:231], a[124:127], v[44:47], v[228:231]
    v_mfma_f32_16x16x32_bf16 v[228:231], a[128:131], v[48:51], v[228:231]
    v_mfma_f32_16x16x32_bf16 v[228:231], a[132:135], v[52:55], v[228:231]
    v_mfma_f32_16x16x32_bf16 v[228:231], a[136:139], v[56:59], v[228:231]
    v_mfma_f32_16x16x32_bf16 v[228:231], a[140:143], v[60:63], v[228:231]
    v_mfma_f32_16x16x32_bf16 v[228:231], a[144:147], v[64:67], v[228:231]
    v_mfma_f32_16x16x32_bf16 v[228:231], a[148:151], v[68:71], v[228:231]
    v_mfma_f32_16x16x32_bf16 v[228:231], a[152:155], v[72:75], v[228:231]
    v_mfma_f32_16x16x32_bf16 v[228:231], a[156:159], v[76:79], v[228:231]
    v_mfma_f32_16x16x32_bf16 v[228:231], a[160:163], v[80:83], v[228:231]
    v_mfma_f32_16x16x32_bf16 v[228:231], a[164:167], v[84:87], v[228:231]
    s_nop 7
    s_nop 1
    v_cvt_pk_bf16_f32 v232, v228, v229
    v_lshlrev_b32 v228, 16, v232
    v_and_b32 v229, 0xffff0000, v232
    v_cvt_pk_bf16_f32 v232, v230, v231
    v_lshlrev_b32 v230, 16, v232
    v_and_b32 v231, 0xffff0000, v232
    v_mul_f32 v233, v228, v228
    v_fma_f32 v233, v233, s14, v254
    v_mul_f32 v233, v233, v228
    v_exp_f32 v233, v233
    v_mul_f32 v234, v229, v229
    v_fma_f32 v234, v234, s14, v254
    v_mul_f32 v234, v234, v229
    v_exp_f32 v234, v234
    v_mul_f32 v235, v230, v230
    v_fma_f32 v235, v235, s14, v254
    v_mul_f32 v235, v235, v230
    v_exp_f32 v235, v235
    v_mul_f32 v236, v231, v231
    v_fma_f32 v236, v236, s14, v254
    v_mul_f32 v236, v236, v231
    v_exp_f32 v236, v236
    s_nop 0
    v_add_f32 v233, 1.0, v233
    v_rcp_f32 v233, v233
    v_add_f32 v234, 1.0, v234
    v_rcp_f32 v234, v234
    v_add_f32 v235, 1.0, v235
    v_rcp_f32 v235, v235
    v_add_f32 v236, 1.0, v236
    v_rcp_f32 v236, v236
    s_nop 0
    v_mul_f32 v228, v228, v233
    v_mul_f32 v229, v229, v234
    v_mul_f32 v230, v230, v235
    v_mul_f32 v231, v231, v236
    v_cvt_pk_bf16_f32 v204, v228, v229
    v_cvt_pk_bf16_f32 v205, v230, v231
    buffer_store_dwordx2 v[204:205], v8, s[40:43], 0 offen offset:64
    s_add_u32 s18, s19, 86016
    buffer_load_dwordx4 a[112:115], v252, s[36:39], s18 offen offset:0
    buffer_load_dwordx4 a[116:119], v252, s[36:39], s18 offen offset:1024
    buffer_load_dwordx4 a[120:123], v252, s[36:39], s18 offen offset:2048
    buffer_load_dwordx4 a[124:127], v252, s[36:39], s18 offen offset:3072
    s_add_u32 s18, s19, 90112
    buffer_load_dwordx4 a[128:131], v252, s[36:39], s18 offen offset:0
    buffer_load_dwordx4 a[132:135], v252, s[36:39], s18 offen offset:1024
    buffer_load_dwordx4 a[136:139], v252, s[36:39], s18 offen offset:2048
    buffer_load_dwordx4 a[140:143], v252, s[36:39], s18 offen offset:3072
    s_add_u32 s18, s19, 94208
    buffer_load_dwordx4 a[144:147], v252, s[36:39], s18 offen offset:0
    buffer_load_dwordx4 a[148:151], v252, s[36:39], s18 offen offset:1024
    buffer_load_dwordx4 a[152:155], v252, s[36:39], s18 offen offset:2048
    buffer_load_dwordx4 a[156:159], v252, s[36:39], s18 offen offset:3072
    s_add_u32 s18, s19, 98304
    buffer_load_dwordx4 a[160:163], v252, s[36:39], s18 offen offset:0
    buffer_load_dwordx4 a[164:167], v252, s[36:39], s18 offen offset:1024
    v_mov_b32 v228, 0
    v_mov_b32 v229, 0
    v_mov_b32 v230, 0
    v_mov_b32 v231, 0
    s_nop 1
    s_waitcnt vmcnt(42) lgkmcnt(0)
    v_mfma_f32_16x16x32_bf16 v[228:231], a[168:171], v[32:35], v[228:231]
    v_mfma_f32_16x16x32_bf16 v[228:231], a[172:175], v[36:39], v[228:231]
    v_mfma_f32_16x16x32_bf16 v[228:231], a[176:179], v[40:43], v[228:231]
    v_mfma_f32_16x16x32_bf16 v[228:231], a[180:183], v[44:47], v[228:231]
    v_mfma_f32_16x16x32_bf16 v[228:231], a[184:187], v[48:51], v[228:231]
    v_mfma_f32_16x16x32_bf16 v[228:231], a[188:191], v[52:55], v[228:231]
    v_mfma_f32_16x16x32_bf16 v[228:231], a[192:195], v[56:59], v[228:231]
    v_mfma_f32_16x16x32_bf16 v[228:231], a[196:199], v[60:63], v[228:231]
    v_mfma_f32_16x16x32_bf16 v[228:231], a[200:203], v[64:67], v[228:231]
    v_mfma_f32_16x16x32_bf16 v[228:231], a[204:207], v[68:71], v[228:231]
    v_mfma_f32_16x16x32_bf16 v[228:231], a[208:211], v[72:75], v[228:231]
    v_mfma_f32_16x16x32_bf16 v[228:231], a[212:215], v[76:79], v[228:231]
    v_mfma_f32_16x16x32_bf16 v[228:231], a[216:219], v[80:83], v[228:231]
    v_mfma_f32_16x16x32_bf16 v[228:231], a[220:223], v[84:87], v[228:231]
    s_nop 7
    s_nop 1
    v_cvt_pk_bf16_f32 v232, v228, v229
    v_lshlrev_b32 v228, 16, v232
    v_and_b32 v229, 0xffff0000, v232
    v_cvt_pk_bf16_f32 v232, v230, v231
    v_lshlrev_b32 v230, 16, v232
    v_and_b32 v231, 0xffff0000, v232
    v_mul_f32 v233, v228, v228
    v_fma_f32 v233, v233, s14, v254
    v_mul_f32 v233, v233, v228
    v_exp_f32 v233, v233
    v_mul_f32 v234, v229, v229
    v_fma_f32 v234, v234, s14, v254
    v_mul_f32 v234, v234, v229
    v_exp_f32 v234, v234
    v_mul_f32 v235, v230, v230
    v_fma_f32 v235, v235, s14, v254
    v_mul_f32 v235, v235, v230
    v_exp_f32 v235, v235
    v_mul_f32 v236, v231, v231
    v_fma_f32 v236, v236, s14, v254
    v_mul_f32 v236, v236, v231
    v_exp_f32 v236, v236
    s_nop 0
    v_add_f32 v233, 1.0, v233
    v_rcp_f32 v233, v233
    v_add_f32 v234, 1.0, v234
    v_rcp_f32 v234, v234
    v_add_f32 v235, 1.0, v235
    v_rcp_f32 v235, v235
    v_add_f32 v236, 1.0, v236
    v_rcp_f32 v236, v236
    s_nop 0
    v_mul_f32 v228, v228, v233
    v_mul_f32 v229, v229, v234
    v_mul_f32 v230, v230, v235
    v_mul_f32 v231, v231, v236
    v_cvt_pk_bf16_f32 v206, v228, v229
    v_cvt_pk_bf16_f32 v207, v230, v231
    buffer_store_dwordx2 v[206:207], v8, s[40:43], 0 offen offset:96
    s_add_u32 s18, s19, 100352
    buffer_load_dwordx4 a[168:171], v252, s[36:39], s18 offen offset:0
    buffer_load_dwordx4 a[172:175], v252, s[36:39], s18 offen offset:1024
    buffer_load_dwordx4 a[176:179], v252, s[36:39], s18 offen offset:2048
    buffer_load_dwordx4 a[180:183], v252, s[36:39], s18 offen offset:3072
    s_add_u32 s18, s19, 104448
    buffer_load_dwordx4 a[184:187], v252, s[36:39], s18 offen offset:0
    buffer_load_dwordx4 a[188:191], v252, s[36:39], s18 offen offset:1024
    buffer_load_dwordx4 a[192:195], v252, s[36:39], s18 offen offset:2048
    buffer_load_dwordx4 a[196:199], v252, s[36:39], s18 offen offset:3072
    s_add_u32 s18, s19, 108544
    buffer_load_dwordx4 a[200:203], v252, s[36:39], s18 offen offset:0
    buffer_load_dwordx4 a[204:207], v252, s[36:39], s18 offen offset:1024
    buffer_load_dwordx4 a[208:211], v252, s[36:39], s18 offen offset:2048
    buffer_load_dwordx4 a[212:215], v252, s[36:39], s18 offen offset:3072
    s_add_u32 s18, s19, 112640
    buffer_load_dwordx4 a[216:219], v252, s[36:39], s18 offen offset:0
    buffer_load_dwordx4 a[220:223], v252, s[36:39], s18 offen offset:1024
    v_mov_b32 v228, 0
    v_mov_b32 v229, 0
    v_mov_b32 v230, 0
    v_mov_b32 v231, 0
    s_nop 1
    s_waitcnt vmcnt(42) lgkmcnt(0)
    v_mfma_f32_16x16x32_bf16 v[228:231], a[0:3], v[32:35], v[228:231]
    v_mfma_f32_16x16x32_bf16 v[228:231], a[4:7], v[36:39], v[228:231]
    v_mfma_f32_16x16x32_bf16 v[228:231], a[8:11], v[40:43], v[228:231]
    v_mfma_f32_16x16x32_bf16 v[228:231], a[12:15], v[44:47], v[228:231]
    v_mfma_f32_16x16x32_bf16 v[228:231], a[16:19], v[48:51], v[228:231]
    v_mfma_f32_16x16x32_bf16 v[228:231], a[20:23], v[52:55], v[228:231]
    v_mfma_f32_16x16x32_bf16 v[228:231], a[24:27], v[56:59], v[228:231]
    v_mfma_f32_16x16x32_bf16 v[228:231], a[28:31], v[60:63], v[228:231]
    v_mfma_f32_16x16x32_bf16 v[228:231], a[32:35], v[64:67], v[228:231]
    v_mfma_f32_16x16x32_bf16 v[228:231], a[36:39], v[68:71], v[228:231]
    v_mfma_f32_16x16x32_bf16 v[228:231], a[40:43], v[72:75], v[228:231]
    v_mfma_f32_16x16x32_bf16 v[228:231], a[44:47], v[76:79], v[228:231]
    v_mfma_f32_16x16x32_bf16 v[228:231], a[48:51], v[80:83], v[228:231]
    v_mfma_f32_16x16x32_bf16 v[228:231], a[52:55], v[84:87], v[228:231]
    s_nop 7
    s_nop 1
    v_cvt_pk_bf16_f32 v232, v228, v229
    v_lshlrev_b32 v228, 16, v232
    v_and_b32 v229, 0xffff0000, v232
    v_cvt_pk_bf16_f32 v232, v230, v231
    v_lshlrev_b32 v230, 16, v232
    v_and_b32 v231, 0xffff0000, v232
    v_mul_f32 v233, v228, v228
    v_fma_f32 v233, v233, s14, v254
    v_mul_f32 v233, v233, v228
    v_exp_f32 v233, v233
    v_mul_f32 v234, v229, v229
    v_fma_f32 v234, v234, s14, v254
    v_mul_f32 v234, v234, v229
    v_exp_f32 v234, v234
    v_mul_f32 v235, v230, v230
    v_fma_f32 v235, v235, s14, v254
    v_mul_f32 v235, v235, v230
    v_exp_f32 v235, v235
    v_mul_f32 v236, v231, v231
    v_fma_f32 v236, v236, s14, v254
    v_mul_f32 v236, v236, v231
    v_exp_f32 v236, v236
    s_nop 0
    v_add_f32 v233, 1.0, v233
    v_rcp_f32 v233, v233
    v_add_f32 v234, 1.0, v234
    v_rcp_f32 v234, v234
    v_add_f32 v235, 1.0, v235
    v_rcp_f32 v235, v235
    v_add_f32 v236, 1.0, v236
    v_rcp_f32 v236, v236
    s_nop 0
    v_mul_f32 v228, v228, v233
    v_mul_f32 v229, v229, v234
    v_mul_f32 v230, v230, v235
    v_mul_f32 v231, v231, v236
    v_cvt_pk_bf16_f32 v208, v228, v229
    v_cvt_pk_bf16_f32 v209, v230, v231
    buffer_store_dwordx2 v[208:209], v8, s[40:43], 0 offen offset:128
    s_add_u32 s18, s19, 114688
    buffer_load_dwordx4 a[0:3], v252, s[36:39], s18 offen offset:0
    buffer_load_dwordx4 a[4:7], v252, s[36:39], s18 offen offset:1024
    buffer_load_dwordx4 a[8:11], v252, s[36:39], s18 offen offset:2048
    buffer_load_dwordx4 a[12:15], v252, s[36:39], s18 offen offset:3072
    s_add_u32 s18, s19, 118784
    buffer_load_dwordx4 a[16:19], v252, s[36:39], s18 offen offset:0
    buffer_load_dwordx4 a[20:23], v252, s[36:39], s18 offen offset:1024
    buffer_load_dwordx4 a[24:27], v252, s[36:39], s18 offen offset:2048
    buffer_load_dwordx4 a[28:31], v252, s[36:39], s18 offen offset:3072
    s_add_u32 s18, s19, 122880
    buffer_load_dwordx4 a[32:35], v252, s[36:39], s18 offen offset:0
    buffer_load_dwordx4 a[36:39], v252, s[36:39], s18 offen offset:1024
    buffer_load_dwordx4 a[40:43], v252, s[36:39], s18 offen offset:2048
    buffer_load_dwordx4 a[44:47], v252, s[36:39], s18 offen offset:3072
    s_add_u32 s18, s19, 126976
    buffer_load_dwordx4 a[48:51], v252, s[36:39], s18 offen offset:0
    buffer_load_dwordx4 a[52:55], v252, s[36:39], s18 offen offset:1024
    v_mov_b32 v228, 0
    v_mov_b32 v229, 0
    v_mov_b32 v230, 0
    v_mov_b32 v231, 0
    s_nop 1
    s_waitcnt vmcnt(42) lgkmcnt(0)
    v_mfma_f32_16x16x32_bf16 v[228:231], a[56:59], v[32:35], v[228:231]
    v_mfma_f32_16x16x32_bf16 v[228:231], a[60:63], v[36:39], v[228:231]
    v_mfma_f32_16x16x32_bf16 v[228:231], a[64:67], v[40:43], v[228:231]
    v_mfma_f32_16x16x32_bf16 v[228:231], a[68:71], v[44:47], v[228:231]
    v_mfma_f32_16x16x32_bf16 v[228:231], a[72:75], v[48:51], v[228:231]
    v_mfma_f32_16x16x32_bf16 v[228:231], a[76:79], v[52:55], v[228:231]
    v_mfma_f32_16x16x32_bf16 v[228:231], a[80:83], v[56:59], v[228:231]
    v_mfma_f32_16x16x32_bf16 v[228:231], a[84:87], v[60:63], v[228:231]
    v_mfma_f32_16x16x32_bf16 v[228:231], a[88:91], v[64:67], v[228:231]
    v_mfma_f32_16x16x32_bf16 v[228:231], a[92:95], v[68:71], v[228:231]
    v_mfma_f32_16x16x32_bf16 v[228:231], a[96:99], v[72:75], v[228:231]
    v_mfma_f32_16x16x32_bf16 v[228:231], a[100:103], v[76:79], v[228:231]
    v_mfma_f32_16x16x32_bf16 v[228:231], a[104:107], v[80:83], v[228:231]
    v_mfma_f32_16x16x32_bf16 v[228:231], a[108:111], v[84:87], v[228:231]
    s_nop 7
    s_nop 1
    v_cvt_pk_bf16_f32 v232, v228, v229
    v_lshlrev_b32 v228, 16, v232
    v_and_b32 v229, 0xffff0000, v232
    v_cvt_pk_bf16_f32 v232, v230, v231
    v_lshlrev_b32 v230, 16, v232
    v_and_b32 v231, 0xffff0000, v232
    v_mul_f32 v233, v228, v228
    v_fma_f32 v233, v233, s14, v254
    v_mul_f32 v233, v233, v228
    v_exp_f32 v233, v233
    v_mul_f32 v234, v229, v229
    v_fma_f32 v234, v234, s14, v254
    v_mul_f32 v234, v234, v229
    v_exp_f32 v234, v234
    v_mul_f32 v235, v230, v230
    v_fma_f32 v235, v235, s14, v254
    v_mul_f32 v235, v235, v230
    v_exp_f32 v235, v235
    v_mul_f32 v236, v231, v231
    v_fma_f32 v236, v236, s14, v254
    v_mul_f32 v236, v236, v231
    v_exp_f32 v236, v236
    s_nop 0
    v_add_f32 v233, 1.0, v233
    v_rcp_f32 v233, v233
    v_add_f32 v234, 1.0, v234
    v_rcp_f32 v234, v234
    v_add_f32 v235, 1.0, v235
    v_rcp_f32 v235, v235
    v_add_f32 v236, 1.0, v236
    v_rcp_f32 v236, v236
    s_nop 0
    v_mul_f32 v228, v228, v233
    v_mul_f32 v229, v229, v234
    v_mul_f32 v230, v230, v235
    v_mul_f32 v231, v231, v236
    v_cvt_pk_bf16_f32 v210, v228, v229
    v_cvt_pk_bf16_f32 v211, v230, v231
    buffer_store_dwordx2 v[210:211], v8, s[40:43], 0 offen offset:160
    s_add_u32 s18, s19, 129024
    buffer_load_dwordx4 a[56:59], v252, s[36:39], s18 offen offset:0
    buffer_load_dwordx4 a[60:63], v252, s[36:39], s18 offen offset:1024
    buffer_load_dwordx4 a[64:67], v252, s[36:39], s18 offen offset:2048
    buffer_load_dwordx4 a[68:71], v252, s[36:39], s18 offen offset:3072
    s_add_u32 s18, s19, 133120
    buffer_load_dwordx4 a[72:75], v252, s[36:39], s18 offen offset:0
    buffer_load_dwordx4 a[76:79], v252, s[36:39], s18 offen offset:1024
    buffer_load_dwordx4 a[80:83], v252, s[36:39], s18 offen offset:2048
    buffer_load_dwordx4 a[84:87], v252, s[36:39], s18 offen offset:3072
    s_add_u32 s18, s19, 137216
    buffer_load_dwordx4 a[88:91], v252, s[36:39], s18 offen offset:0
    buffer_load_dwordx4 a[92:95], v252, s[36:39], s18 offen offset:1024
    buffer_load_dwordx4 a[96:99], v252, s[36:39], s18 offen offset:2048
    buffer_load_dwordx4 a[100:103], v252, s[36:39], s18 offen offset:3072
    s_add_u32 s18, s19, 141312
    buffer_load_dwordx4 a[104:107], v252, s[36:39], s18 offen offset:0
    buffer_load_dwordx4 a[108:111], v252, s[36:39], s18 offen offset:1024
    v_mov_b32 v228, 0
    v_mov_b32 v229, 0
    v_mov_b32 v230, 0
    v_mov_b32 v231, 0
    s_nop 1
    s_waitcnt vmcnt(42) lgkmcnt(0)
    v_mfma_f32_16x16x32_bf16 v[228:231], a[112:115], v[32:35], v[228:231]
    v_mfma_f32_16x16x32_bf16 v[228:231], a[116:119], v[36:39], v[228:231]
    v_mfma_f32_16x16x32_bf16 v[228:231], a[120:123], v[40:43], v[228:231]
    v_mfma_f32_16x16x32_bf16 v[228:231], a[124:127], v[44:47], v[228:231]
    v_mfma_f32_16x16x32_bf16 v[228:231], a[128:131], v[48:51], v[228:231]
    v_mfma_f32_16x16x32_bf16 v[228:231], a[132:135], v[52:55], v[228:231]
    v_mfma_f32_16x16x32_bf16 v[228:231], a[136:139], v[56:59], v[228:231]
    v_mfma_f32_16x16x32_bf16 v[228:231], a[140:143], v[60:63], v[228:231]
    v_mfma_f32_16x16x32_bf16 v[228:231], a[144:147], v[64:67], v[228:231]
    v_mfma_f32_16x16x32_bf16 v[228:231], a[148:151], v[68:71], v[228:231]
    v_mfma_f32_16x16x32_bf16 v[228:231], a[152:155], v[72:75], v[228:231]
    v_mfma_f32_16x16x32_bf16 v[228:231], a[156:159], v[76:79], v[228:231]
    v_mfma_f32_16x16x32_bf16 v[228:231], a[160:163], v[80:83], v[228:231]
    v_mfma_f32_16x16x32_bf16 v[228:231], a[164:167], v[84:87], v[228:231]
    s_nop 7
    s_nop 1
    v_cvt_pk_bf16_f32 v232, v228, v229
    v_lshlrev_b32 v228, 16, v232
    v_and_b32 v229, 0xffff0000, v232
    v_cvt_pk_bf16_f32 v232, v230, v231
    v_lshlrev_b32 v230, 16, v232
    v_and_b32 v231, 0xffff0000, v232
    v_mul_f32 v233, v228, v228
    v_fma_f32 v233, v233, s14, v254
    v_mul_f32 v233, v233, v228
    v_exp_f32 v233, v233
    v_mul_f32 v234, v229, v229
    v_fma_f32 v234, v234, s14, v254
    v_mul_f32 v234, v234, v229
    v_exp_f32 v234, v234
    v_mul_f32 v235, v230, v230
    v_fma_f32 v235, v235, s14, v254
    v_mul_f32 v235, v235, v230
    v_exp_f32 v235, v235
    v_mul_f32 v236, v231, v231
    v_fma_f32 v236, v236, s14, v254
    v_mul_f32 v236, v236, v231
    v_exp_f32 v236, v236
    s_nop 0
    v_add_f32 v233, 1.0, v233
    v_rcp_f32 v233, v233
    v_add_f32 v234, 1.0, v234
    v_rcp_f32 v234, v234
    v_add_f32 v235, 1.0, v235
    v_rcp_f32 v235, v235
    v_add_f32 v236, 1.0, v236
    v_rcp_f32 v236, v236
    s_nop 0
    v_mul_f32 v228, v228, v233
    v_mul_f32 v229, v229, v234
    v_mul_f32 v230, v230, v235
    v_mul_f32 v231, v231, v236
    v_cvt_pk_bf16_f32 v212, v228, v229
    v_cvt_pk_bf16_f32 v213, v230, v231
    buffer_store_dwordx2 v[212:213], v8, s[40:43], 0 offen offset:192
    s_add_u32 s18, s19, 143360
    buffer_load_dwordx4 a[112:115], v252, s[36:39], s18 offen offset:0
    buffer_load_dwordx4 a[116:119], v252, s[36:39], s18 offen offset:1024
    buffer_load_dwordx4 a[120:123], v252, s[36:39], s18 offen offset:2048
    buffer_load_dwordx4 a[124:127], v252, s[36:39], s18 offen offset:3072
    s_add_u32 s18, s19, 147456
    buffer_load_dwordx4 a[128:131], v252, s[36:39], s18 offen offset:0
    buffer_load_dwordx4 a[132:135], v252, s[36:39], s18 offen offset:1024
    buffer_load_dwordx4 a[136:139], v252, s[36:39], s18 offen offset:2048
    buffer_load_dwordx4 a[140:143], v252, s[36:39], s18 offen offset:3072
    s_add_u32 s18, s19, 151552
    buffer_load_dwordx4 a[144:147], v252, s[36:39], s18 offen offset:0
    buffer_load_dwordx4 a[148:151], v252, s[36:39], s18 offen offset:1024
    buffer_load_dwordx4 a[152:155], v252, s[36:39], s18 offen offset:2048
    buffer_load_dwordx4 a[156:159], v252, s[36:39], s18 offen offset:3072
    s_add_u32 s18, s19, 155648
    buffer_load_dwordx4 a[160:163], v252, s[36:39], s18 offen offset:0
    buffer_load_dwordx4 a[164:167], v252, s[36:39], s18 offen offset:1024
    v_mov_b32 v228, 0
    v_mov_b32 v229, 0
    v_mov_b32 v230, 0
    v_mov_b32 v231, 0
    s_nop 1
    s_waitcnt vmcnt(42) lgkmcnt(0)
    v_mfma_f32_16x16x32_bf16 v[228:231], a[168:171], v[32:35], v[228:231]
    v_mfma_f32_16x16x32_bf16 v[228:231], a[172:175], v[36:39], v[228:231]
    v_mfma_f32_16x16x32_bf16 v[228:231], a[176:179], v[40:43], v[228:231]
    v_mfma_f32_16x16x32_bf16 v[228:231], a[180:183], v[44:47], v[228:231]
    v_mfma_f32_16x16x32_bf16 v[228:231], a[184:187], v[48:51], v[228:231]
    v_mfma_f32_16x16x32_bf16 v[228:231], a[188:191], v[52:55], v[228:231]
    v_mfma_f32_16x16x32_bf16 v[228:231], a[192:195], v[56:59], v[228:231]
    v_mfma_f32_16x16x32_bf16 v[228:231], a[196:199], v[60:63], v[228:231]
    v_mfma_f32_16x16x32_bf16 v[228:231], a[200:203], v[64:67], v[228:231]
    v_mfma_f32_16x16x32_bf16 v[228:231], a[204:207], v[68:71], v[228:231]
    v_mfma_f32_16x16x32_bf16 v[228:231], a[208:211], v[72:75], v[228:231]
    v_mfma_f32_16x16x32_bf16 v[228:231], a[212:215], v[76:79], v[228:231]
    v_mfma_f32_16x16x32_bf16 v[228:231], a[216:219], v[80:83], v[228:231]
    v_mfma_f32_16x16x32_bf16 v[228:231], a[220:223], v[84:87], v[228:231]
    s_nop 7
    s_nop 1
    v_cvt_pk_bf16_f32 v232, v228, v229
    v_lshlrev_b32 v228, 16, v232
    v_and_b32 v229, 0xffff0000, v232
    v_cvt_pk_bf16_f32 v232, v230, v231
    v_lshlrev_b32 v230, 16, v232
    v_and_b32 v231, 0xffff0000, v232
    v_mul_f32 v233, v228, v228
    v_fma_f32 v233, v233, s14, v254
    v_mul_f32 v233, v233, v228
    v_exp_f32 v233, v233
    v_mul_f32 v234, v229, v229
    v_fma_f32 v234, v234, s14, v254
    v_mul_f32 v234, v234, v229
    v_exp_f32 v234, v234
    v_mul_f32 v235, v230, v230
    v_fma_f32 v235, v235, s14, v254
    v_mul_f32 v235, v235, v230
    v_exp_f32 v235, v235
    v_mul_f32 v236, v231, v231
    v_fma_f32 v236, v236, s14, v254
    v_mul_f32 v236, v236, v231
    v_exp_f32 v236, v236
    s_nop 0
    v_add_f32 v233, 1.0, v233
    v_rcp_f32 v233, v233
    v_add_f32 v234, 1.0, v234
    v_rcp_f32 v234, v234
    v_add_f32 v235, 1.0, v235
    v_rcp_f32 v235, v235
    v_add_f32 v236, 1.0, v236
    v_rcp_f32 v236, v236
    s_nop 0
    v_mul_f32 v228, v228, v233
    v_mul_f32 v229, v229, v234
    v_mul_f32 v230, v230, v235
    v_mul_f32 v231, v231, v236
    v_cvt_pk_bf16_f32 v214, v228, v229
    v_cvt_pk_bf16_f32 v215, v230, v231
    buffer_store_dwordx2 v[214:215], v8, s[40:43], 0 offen offset:224
    s_add_u32 s18, s19, 157696
    buffer_load_dwordx4 a[168:171], v252, s[36:39], s18 offen offset:0
    buffer_load_dwordx4 a[172:175], v252, s[36:39], s18 offen offset:1024
    buffer_load_dwordx4 a[176:179], v252, s[36:39], s18 offen offset:2048
    buffer_load_dwordx4 a[180:183], v252, s[36:39], s18 offen offset:3072
    s_add_u32 s18, s19, 161792
    buffer_load_dwordx4 a[184:187], v252, s[36:39], s18 offen offset:0
    buffer_load_dwordx4 a[188:191], v252, s[36:39], s18 offen offset:1024
    buffer_load_dwordx4 a[192:195], v252, s[36:39], s18 offen offset:2048
    buffer_load_dwordx4 a[196:199], v252, s[36:39], s18 offen offset:3072
    s_add_u32 s18, s19, 165888
    buffer_load_dwordx4 a[200:203], v252, s[36:39], s18 offen offset:0
    buffer_load_dwordx4 a[204:207], v252, s[36:39], s18 offen offset:1024
    buffer_load_dwordx4 a[208:211], v252, s[36:39], s18 offen offset:2048
    buffer_load_dwordx4 a[212:215], v252, s[36:39], s18 offen offset:3072
    s_add_u32 s18, s19, 169984
    buffer_load_dwordx4 a[216:219], v252, s[36:39], s18 offen offset:0
    buffer_load_dwordx4 a[220:223], v252, s[36:39], s18 offen offset:1024
    v_mov_b32 v228, 0
    v_mov_b32 v229, 0
    v_mov_b32 v230, 0
    v_mov_b32 v231, 0
    s_nop 1
    s_waitcnt vmcnt(42) lgkmcnt(0)
    v_mfma_f32_16x16x32_bf16 v[228:231], a[0:3], v[32:35], v[228:231]
    v_mfma_f32_16x16x32_bf16 v[228:231], a[4:7], v[36:39], v[228:231]
    v_mfma_f32_16x16x32_bf16 v[228:231], a[8:11], v[40:43], v[228:231]
    v_mfma_f32_16x16x32_bf16 v[228:231], a[12:15], v[44:47], v[228:231]
    v_mfma_f32_16x16x32_bf16 v[228:231], a[16:19], v[48:51], v[228:231]
    v_mfma_f32_16x16x32_bf16 v[228:231], a[20:23], v[52:55], v[228:231]
    v_mfma_f32_16x16x32_bf16 v[228:231], a[24:27], v[56:59], v[228:231]
    v_mfma_f32_16x16x32_bf16 v[228:231], a[28:31], v[60:63], v[228:231]
    v_mfma_f32_16x16x32_bf16 v[228:231], a[32:35], v[64:67], v[228:231]
    v_mfma_f32_16x16x32_bf16 v[228:231], a[36:39], v[68:71], v[228:231]
    v_mfma_f32_16x16x32_bf16 v[228:231], a[40:43], v[72:75], v[228:231]
    v_mfma_f32_16x16x32_bf16 v[228:231], a[44:47], v[76:79], v[228:231]
    v_mfma_f32_16x16x32_bf16 v[228:231], a[48:51], v[80:83], v[228:231]
    v_mfma_f32_16x16x32_bf16 v[228:231], a[52:55], v[84:87], v[228:231]
    s_nop 7
    s_nop 1
    v_cvt_pk_bf16_f32 v232, v228, v229
    v_lshlrev_b32 v228, 16, v232
    v_and_b32 v229, 0xffff0000, v232
    v_cvt_pk_bf16_f32 v232, v230, v231
    v_lshlrev_b32 v230, 16, v232
    v_and_b32 v231, 0xffff0000, v232
    v_mul_f32 v233, v228, v228
    v_fma_f32 v233, v233, s14, v254
    v_mul_f32 v233, v233, v228
    v_exp_f32 v233, v233
    v_mul_f32 v234, v229, v229
    v_fma_f32 v234, v234, s14, v254
    v_mul_f32 v234, v234, v229
    v_exp_f32 v234, v234
    v_mul_f32 v235, v230, v230
    v_fma_f32 v235, v235, s14, v254
    v_mul_f32 v235, v235, v230
    v_exp_f32 v235, v235
    v_mul_f32 v236, v231, v231
    v_fma_f32 v236, v236, s14, v254
    v_mul_f32 v236, v236, v231
    v_exp_f32 v236, v236
    s_nop 0
    v_add_f32 v233, 1.0, v233
    v_rcp_f32 v233, v233
    v_add_f32 v234, 1.0, v234
    v_rcp_f32 v234, v234
    v_add_f32 v235, 1.0, v235
    v_rcp_f32 v235, v235
    v_add_f32 v236, 1.0, v236
    v_rcp_f32 v236, v236
    s_nop 0
    v_mul_f32 v228, v228, v233
    v_mul_f32 v229, v229, v234
    v_mul_f32 v230, v230, v235
    v_mul_f32 v231, v231, v236
    v_cvt_pk_bf16_f32 v216, v228, v229
    v_cvt_pk_bf16_f32 v217, v230, v231
    buffer_store_dwordx2 v[216:217], v8, s[40:43], 0 offen offset:256
    s_add_u32 s18, s19, 172032
    buffer_load_dwordx4 a[0:3], v252, s[36:39], s18 offen offset:0
    buffer_load_dwordx4 a[4:7], v252, s[36:39], s18 offen offset:1024
    buffer_load_dwordx4 a[8:11], v252, s[36:39], s18 offen offset:2048
    buffer_load_dwordx4 a[12:15], v252, s[36:39], s18 offen offset:3072
    s_add_u32 s18, s19, 176128
    buffer_load_dwordx4 a[16:19], v252, s[36:39], s18 offen offset:0
    buffer_load_dwordx4 a[20:23], v252, s[36:39], s18 offen offset:1024
    buffer_load_dwordx4 a[24:27], v252, s[36:39], s18 offen offset:2048
    buffer_load_dwordx4 a[28:31], v252, s[36:39], s18 offen offset:3072
    s_add_u32 s18, s19, 180224
    buffer_load_dwordx4 a[32:35], v252, s[36:39], s18 offen offset:0
    buffer_load_dwordx4 a[36:39], v252, s[36:39], s18 offen offset:1024
    buffer_load_dwordx4 a[40:43], v252, s[36:39], s18 offen offset:2048
    buffer_load_dwordx4 a[44:47], v252, s[36:39], s18 offen offset:3072
    s_add_u32 s18, s19, 184320
    buffer_load_dwordx4 a[48:51], v252, s[36:39], s18 offen offset:0
    buffer_load_dwordx4 a[52:55], v252, s[36:39], s18 offen offset:1024
    v_mov_b32 v228, 0
    v_mov_b32 v229, 0
    v_mov_b32 v230, 0
    v_mov_b32 v231, 0
    s_nop 1
    s_waitcnt vmcnt(42) lgkmcnt(0)
    v_mfma_f32_16x16x32_bf16 v[228:231], a[56:59], v[32:35], v[228:231]
    v_mfma_f32_16x16x32_bf16 v[228:231], a[60:63], v[36:39], v[228:231]
    v_mfma_f32_16x16x32_bf16 v[228:231], a[64:67], v[40:43], v[228:231]
    v_mfma_f32_16x16x32_bf16 v[228:231], a[68:71], v[44:47], v[228:231]
    v_mfma_f32_16x16x32_bf16 v[228:231], a[72:75], v[48:51], v[228:231]
    v_mfma_f32_16x16x32_bf16 v[228:231], a[76:79], v[52:55], v[228:231]
    v_mfma_f32_16x16x32_bf16 v[228:231], a[80:83], v[56:59], v[228:231]
    v_mfma_f32_16x16x32_bf16 v[228:231], a[84:87], v[60:63], v[228:231]
    v_mfma_f32_16x16x32_bf16 v[228:231], a[88:91], v[64:67], v[228:231]
    v_mfma_f32_16x16x32_bf16 v[228:231], a[92:95], v[68:71], v[228:231]
    v_mfma_f32_16x16x32_bf16 v[228:231], a[96:99], v[72:75], v[228:231]
    v_mfma_f32_16x16x32_bf16 v[228:231], a[100:103], v[76:79], v[228:231]
    v_mfma_f32_16x16x32_bf16 v[228:231], a[104:107], v[80:83], v[228:231]
    v_mfma_f32_16x16x32_bf16 v[228:231], a[108:111], v[84:87], v[228:231]
    s_nop 7
    s_nop 1
    v_cvt_pk_bf16_f32 v232, v228, v229
    v_lshlrev_b32 v228, 16, v232
    v_and_b32 v229, 0xffff0000, v232
    v_cvt_pk_bf16_f32 v232, v230, v231
    v_lshlrev_b32 v230, 16, v232
    v_and_b32 v231, 0xffff0000, v232
    v_mul_f32 v233, v228, v228
    v_fma_f32 v233, v233, s14, v254
    v_mul_f32 v233, v233, v228
    v_exp_f32 v233, v233
    v_mul_f32 v234, v229, v229
    v_fma_f32 v234, v234, s14, v254
    v_mul_f32 v234, v234, v229
    v_exp_f32 v234, v234
    v_mul_f32 v235, v230, v230
    v_fma_f32 v235, v235, s14, v254
    v_mul_f32 v235, v235, v230
    v_exp_f32 v235, v235
    v_mul_f32 v236, v231, v231
    v_fma_f32 v236, v236, s14, v254
    v_mul_f32 v236, v236, v231
    v_exp_f32 v236, v236
    s_nop 0
    v_add_f32 v233, 1.0, v233
    v_rcp_f32 v233, v233
    v_add_f32 v234, 1.0, v234
    v_rcp_f32 v234, v234
    v_add_f32 v235, 1.0, v235
    v_rcp_f32 v235, v235
    v_add_f32 v236, 1.0, v236
    v_rcp_f32 v236, v236
    s_nop 0
    v_mul_f32 v228, v228, v233
    v_mul_f32 v229, v229, v234
    v_mul_f32 v230, v230, v235
    v_mul_f32 v231, v231, v236
    v_cvt_pk_bf16_f32 v218, v228, v229
    v_cvt_pk_bf16_f32 v219, v230, v231
    buffer_store_dwordx2 v[218:219], v8, s[40:43], 0 offen offset:288
    s_add_u32 s18, s19, 186368
    buffer_load_dwordx4 a[56:59], v252, s[36:39], s18 offen offset:0
    buffer_load_dwordx4 a[60:63], v252, s[36:39], s18 offen offset:1024
    buffer_load_dwordx4 a[64:67], v252, s[36:39], s18 offen offset:2048
    buffer_load_dwordx4 a[68:71], v252, s[36:39], s18 offen offset:3072
    s_add_u32 s18, s19, 190464
    buffer_load_dwordx4 a[72:75], v252, s[36:39], s18 offen offset:0
    buffer_load_dwordx4 a[76:79], v252, s[36:39], s18 offen offset:1024
    buffer_load_dwordx4 a[80:83], v252, s[36:39], s18 offen offset:2048
    buffer_load_dwordx4 a[84:87], v252, s[36:39], s18 offen offset:3072
    s_add_u32 s18, s19, 194560
    buffer_load_dwordx4 a[88:91], v252, s[36:39], s18 offen offset:0
    buffer_load_dwordx4 a[92:95], v252, s[36:39], s18 offen offset:1024
    buffer_load_dwordx4 a[96:99], v252, s[36:39], s18 offen offset:2048
    buffer_load_dwordx4 a[100:103], v252, s[36:39], s18 offen offset:3072
    s_add_u32 s18, s19, 198656
    buffer_load_dwordx4 a[104:107], v252, s[36:39], s18 offen offset:0
    buffer_load_dwordx4 a[108:111], v252, s[36:39], s18 offen offset:1024
    v_mov_b32 v228, 0
    v_mov_b32 v229, 0
    v_mov_b32 v230, 0
    v_mov_b32 v231, 0
    s_nop 1
    s_waitcnt vmcnt(42) lgkmcnt(0)
    v_mfma_f32_16x16x32_bf16 v[228:231], a[112:115], v[32:35], v[228:231]
    v_mfma_f32_16x16x32_bf16 v[228:231], a[116:119], v[36:39], v[228:231]
    v_mfma_f32_16x16x32_bf16 v[228:231], a[120:123], v[40:43], v[228:231]
    v_mfma_f32_16x16x32_bf16 v[228:231], a[124:127], v[44:47], v[228:231]
    v_mfma_f32_16x16x32_bf16 v[228:231], a[128:131], v[48:51], v[228:231]
    v_mfma_f32_16x16x32_bf16 v[228:231], a[132:135], v[52:55], v[228:231]
    v_mfma_f32_16x16x32_bf16 v[228:231], a[136:139], v[56:59], v[228:231]
    v_mfma_f32_16x16x32_bf16 v[228:231], a[140:143], v[60:63], v[228:231]
    v_mfma_f32_16x16x32_bf16 v[228:231], a[144:147], v[64:67], v[228:231]
    v_mfma_f32_16x16x32_bf16 v[228:231], a[148:151], v[68:71], v[228:231]
    v_mfma_f32_16x16x32_bf16 v[228:231], a[152:155], v[72:75], v[228:231]
    v_mfma_f32_16x16x32_bf16 v[228:231], a[156:159], v[76:79], v[228:231]
    v_mfma_f32_16x16x32_bf16 v[228:231], a[160:163], v[80:83], v[228:231]
    v_mfma_f32_16x16x32_bf16 v[228:231], a[164:167], v[84:87], v[228:231]
    s_nop 7
    s_nop 1
    v_cvt_pk_bf16_f32 v232, v228, v229
    v_lshlrev_b32 v228, 16, v232
    v_and_b32 v229, 0xffff0000, v232
    v_cvt_pk_bf16_f32 v232, v230, v231
    v_lshlrev_b32 v230, 16, v232
    v_and_b32 v231, 0xffff0000, v232
    v_mul_f32 v233, v228, v228
    v_fma_f32 v233, v233, s14, v254
    v_mul_f32 v233, v233, v228
    v_exp_f32 v233, v233
    v_mul_f32 v234, v229, v229
    v_fma_f32 v234, v234, s14, v254
    v_mul_f32 v234, v234, v229
    v_exp_f32 v234, v234
    v_mul_f32 v235, v230, v230
    v_fma_f32 v235, v235, s14, v254
    v_mul_f32 v235, v235, v230
    v_exp_f32 v235, v235
    v_mul_f32 v236, v231, v231
    v_fma_f32 v236, v236, s14, v254
    v_mul_f32 v236, v236, v231
    v_exp_f32 v236, v236
    s_nop 0
    v_add_f32 v233, 1.0, v233
    v_rcp_f32 v233, v233
    v_add_f32 v234, 1.0, v234
    v_rcp_f32 v234, v234
    v_add_f32 v235, 1.0, v235
    v_rcp_f32 v235, v235
    v_add_f32 v236, 1.0, v236
    v_rcp_f32 v236, v236
    s_nop 0
    v_mul_f32 v228, v228, v233
    v_mul_f32 v229, v229, v234
    v_mul_f32 v230, v230, v235
    v_mul_f32 v231, v231, v236
    v_cvt_pk_bf16_f32 v220, v228, v229
    v_cvt_pk_bf16_f32 v221, v230, v231
    buffer_store_dwordx2 v[220:221], v8, s[40:43], 0 offen offset:320
    v_mov_b32 v228, 0
    v_mov_b32 v229, 0
    v_mov_b32 v230, 0
    v_mov_b32 v231, 0
    s_nop 1
    s_waitcnt vmcnt(28) lgkmcnt(0)
    v_mfma_f32_16x16x32_bf16 v[228:231], a[168:171], v[32:35], v[228:231]
    v_mfma_f32_16x16x32_bf16 v[228:231], a[172:175], v[36:39], v[228:231]
    v_mfma_f32_16x16x32_bf16 v[228:231], a[176:179], v[40:43], v[228:231]
    v_mfma_f32_16x16x32_bf16 v[228:231], a[180:183], v[44:47], v[228:231]
    v_mfma_f32_16x16x32_bf16 v[228:231], a[184:187], v[48:51], v[228:231]
    v_mfma_f32_16x16x32_bf16 v[228:231], a[188:191], v[52:55], v[228:231]
    v_mfma_f32_16x16x32_bf16 v[228:231], a[192:195], v[56:59], v[228:231]
    v_mfma_f32_16x16x32_bf16 v[228:231], a[196:199], v[60:63], v[228:231]
    v_mfma_f32_16x16x32_bf16 v[228:231], a[200:203], v[64:67], v[228:231]
    v_mfma_f32_16x16x32_bf16 v[228:231], a[204:207], v[68:71], v[228:231]
    v_mfma_f32_16x16x32_bf16 v[228:231], a[208:211], v[72:75], v[228:231]
    v_mfma_f32_16x16x32_bf16 v[228:231], a[212:215], v[76:79], v[228:231]
    v_mfma_f32_16x16x32_bf16 v[228:231], a[216:219], v[80:83], v[228:231]
    v_mfma_f32_16x16x32_bf16 v[228:231], a[220:223], v[84:87], v[228:231]
    s_nop 7
    s_nop 1
    v_cvt_pk_bf16_f32 v232, v228, v229
    v_lshlrev_b32 v228, 16, v232
    v_and_b32 v229, 0xffff0000, v232
    v_cvt_pk_bf16_f32 v232, v230, v231
    v_lshlrev_b32 v230, 16, v232
    v_and_b32 v231, 0xffff0000, v232
    v_mul_f32 v233, v228, v228
    v_fma_f32 v233, v233, s14, v254
    v_mul_f32 v233, v233, v228
    v_exp_f32 v233, v233
    v_mul_f32 v234, v229, v229
    v_fma_f32 v234, v234, s14, v254
    v_mul_f32 v234, v234, v229
    v_exp_f32 v234, v234
    v_mul_f32 v235, v230, v230
    v_fma_f32 v235, v235, s14, v254
    v_mul_f32 v235, v235, v230
    v_exp_f32 v235, v235
    v_mul_f32 v236, v231, v231
    v_fma_f32 v236, v236, s14, v254
    v_mul_f32 v236, v236, v231
    v_exp_f32 v236, v236
    s_nop 0
    v_add_f32 v233, 1.0, v233
    v_rcp_f32 v233, v233
    v_add_f32 v234, 1.0, v234
    v_rcp_f32 v234, v234
    v_add_f32 v235, 1.0, v235
    v_rcp_f32 v235, v235
    v_add_f32 v236, 1.0, v236
    v_rcp_f32 v236, v236
    s_nop 0
    v_mul_f32 v228, v228, v233
    v_mul_f32 v229, v229, v234
    v_mul_f32 v230, v230, v235
    v_mul_f32 v231, v231, v236
    v_cvt_pk_bf16_f32 v222, v228, v229
    v_cvt_pk_bf16_f32 v223, v230, v231
    buffer_store_dwordx2 v[222:223], v8, s[40:43], 0 offen offset:352
    v_mov_b32 v228, 0
    v_mov_b32 v229, 0
    v_mov_b32 v230, 0
    v_mov_b32 v231, 0
    s_nop 1
    s_waitcnt vmcnt(14) lgkmcnt(0)
    v_mfma_f32_16x16x32_bf16 v[228:231], a[0:3], v[32:35], v[228:231]
    v_mfma_f32_16x16x32_bf16 v[228:231], a[4:7], v[36:39], v[228:231]
    v_mfma_f32_16x16x32_bf16 v[228:231], a[8:11], v[40:43], v[228:231]
    v_mfma_f32_16x16x32_bf16 v[228:231], a[12:15], v[44:47], v[228:231]
    v_mfma_f32_16x16x32_bf16 v[228:231], a[16:19], v[48:51], v[228:231]
    v_mfma_f32_16x16x32_bf16 v[228:231], a[20:23], v[52:55], v[228:231]
    v_mfma_f32_16x16x32_bf16 v[228:231], a[24:27], v[56:59], v[228:231]
    v_mfma_f32_16x16x32_bf16 v[228:231], a[28:31], v[60:63], v[228:231]
    v_mfma_f32_16x16x32_bf16 v[228:231], a[32:35], v[64:67], v[228:231]
    v_mfma_f32_16x16x32_bf16 v[228:231], a[36:39], v[68:71], v[228:231]
    v_mfma_f32_16x16x32_bf16 v[228:231], a[40:43], v[72:75], v[228:231]
    v_mfma_f32_16x16x32_bf16 v[228:231], a[44:47], v[76:79], v[228:231]
    v_mfma_f32_16x16x32_bf16 v[228:231], a[48:51], v[80:83], v[228:231]
    v_mfma_f32_16x16x32_bf16 v[228:231], a[52:55], v[84:87], v[228:231]
    s_nop 7
    s_nop 1
    v_cvt_pk_bf16_f32 v232, v228, v229
    v_lshlrev_b32 v228, 16, v232
    v_and_b32 v229, 0xffff0000, v232
    v_cvt_pk_bf16_f32 v232, v230, v231
    v_lshlrev_b32 v230, 16, v232
    v_and_b32 v231, 0xffff0000, v232
    v_mul_f32 v233, v228, v228
    v_fma_f32 v233, v233, s14, v254
    v_mul_f32 v233, v233, v228
    v_exp_f32 v233, v233
    v_mul_f32 v234, v229, v229
    v_fma_f32 v234, v234, s14, v254
    v_mul_f32 v234, v234, v229
    v_exp_f32 v234, v234
    v_mul_f32 v235, v230, v230
    v_fma_f32 v235, v235, s14, v254
    v_mul_f32 v235, v235, v230
    v_exp_f32 v235, v235
    v_mul_f32 v236, v231, v231
    v_fma_f32 v236, v236, s14, v254
    v_mul_f32 v236, v236, v231
    v_exp_f32 v236, v236
    s_nop 0
    v_add_f32 v233, 1.0, v233
    v_rcp_f32 v233, v233
    v_add_f32 v234, 1.0, v234
    v_rcp_f32 v234, v234
    v_add_f32 v235, 1.0, v235
    v_rcp_f32 v235, v235
    v_add_f32 v236, 1.0, v236
    v_rcp_f32 v236, v236
    s_nop 0
    v_mul_f32 v228, v228, v233
    v_mul_f32 v229, v229, v234
    v_mul_f32 v230, v230, v235
    v_mul_f32 v231, v231, v236
    v_cvt_pk_bf16_f32 v224, v228, v229
    v_cvt_pk_bf16_f32 v225, v230, v231
    buffer_store_dwordx2 v[224:225], v8, s[40:43], 0 offen offset:384
    v_mov_b32 v228, 0
    v_mov_b32 v229, 0
    v_mov_b32 v230, 0
    v_mov_b32 v231, 0
    s_nop 1
    s_waitcnt vmcnt(0) lgkmcnt(0)
    v_mfma_f32_16x16x32_bf16 v[228:231], a[56:59], v[32:35], v[228:231]
    v_mfma_f32_16x16x32_bf16 v[228:231], a[60:63], v[36:39], v[228:231]
    v_mfma_f32_16x16x32_bf16 v[228:231], a[64:67], v[40:43], v[228:231]
    v_mfma_f32_16x16x32_bf16 v[228:231], a[68:71], v[44:47], v[228:231]
    v_mfma_f32_16x16x32_bf16 v[228:231], a[72:75], v[48:51], v[228:231]
    v_mfma_f32_16x16x32_bf16 v[228:231], a[76:79], v[52:55], v[228:231]
    v_mfma_f32_16x16x32_bf16 v[228:231], a[80:83], v[56:59], v[228:231]
    v_mfma_f32_16x16x32_bf16 v[228:231], a[84:87], v[60:63], v[228:231]
    v_mfma_f32_16x16x32_bf16 v[228:231], a[88:91], v[64:67], v[228:231]
    v_mfma_f32_16x16x32_bf16 v[228:231], a[92:95], v[68:71], v[228:231]
    v_mfma_f32_16x16x32_bf16 v[228:231], a[96:99], v[72:75], v[228:231]
    v_mfma_f32_16x16x32_bf16 v[228:231], a[100:103], v[76:79], v[228:231]
    v_mfma_f32_16x16x32_bf16 v[228:231], a[104:107], v[80:83], v[228:231]
    v_mfma_f32_16x16x32_bf16 v[228:231], a[108:111], v[84:87], v[228:231]
    s_nop 7
    s_nop 1
    v_cvt_pk_bf16_f32 v232, v228, v229
    v_lshlrev_b32 v228, 16, v232
    v_and_b32 v229, 0xffff0000, v232
    v_cvt_pk_bf16_f32 v232, v230, v231
    v_lshlrev_b32 v230, 16, v232
    v_and_b32 v231, 0xffff0000, v232
    v_mul_f32 v233, v228, v228
    v_fma_f32 v233, v233, s14, v254
    v_mul_f32 v233, v233, v228
    v_exp_f32 v233, v233
    v_mul_f32 v234, v229, v229
    v_fma_f32 v234, v234, s14, v254
    v_mul_f32 v234, v234, v229
    v_exp_f32 v234, v234
    v_mul_f32 v235, v230, v230
    v_fma_f32 v235, v235, s14, v254
    v_mul_f32 v235, v235, v230
    v_exp_f32 v235, v235
    v_mul_f32 v236, v231, v231
    v_fma_f32 v236, v236, s14, v254
    v_mul_f32 v236, v236, v231
    v_exp_f32 v236, v236
    s_nop 0
    v_add_f32 v233, 1.0, v233
    v_rcp_f32 v233, v233
    v_add_f32 v234, 1.0, v234
    v_rcp_f32 v234, v234
    v_add_f32 v235, 1.0, v235
    v_rcp_f32 v235, v235
    v_add_f32 v236, 1.0, v236
    v_rcp_f32 v236, v236
    s_nop 0
    v_mul_f32 v228, v228, v233
    v_mul_f32 v229, v229, v234
    v_mul_f32 v230, v230, v235
    v_mul_f32 v231, v231, v236
    v_cvt_pk_bf16_f32 v226, v228, v229
    v_cvt_pk_bf16_f32 v227, v230, v231
    buffer_store_dwordx2 v[226:227], v8, s[40:43], 0 offen offset:416
    s_branch K2_end_8
K2_half1_14:
    s_add_u32 s18, s19, 43008
    buffer_load_dwordx4 a[168:171], v252, s[36:39], s18 offen offset:0
    buffer_load_dwordx4 a[172:175], v252, s[36:39], s18 offen offset:1024
    buffer_load_dwordx4 a[176:179], v252, s[36:39], s18 offen offset:2048
    buffer_load_dwordx4 a[180:183], v252, s[36:39], s18 offen offset:3072
    s_add_u32 s18, s19, 47104
    buffer_load_dwordx4 a[184:187], v252, s[36:39], s18 offen offset:0
    buffer_load_dwordx4 a[188:191], v252, s[36:39], s18 offen offset:1024
    buffer_load_dwordx4 a[192:195], v252, s[36:39], s18 offen offset:2048
    buffer_load_dwordx4 a[196:199], v252, s[36:39], s18 offen offset:3072
    s_add_u32 s18, s19, 51200
    buffer_load_dwordx4 a[200:203], v252, s[36:39], s18 offen offset:0
    buffer_load_dwordx4 a[204:207], v252, s[36:39], s18 offen offset:1024
    buffer_load_dwordx4 a[208:211], v252, s[36:39], s18 offen offset:2048
    buffer_load_dwordx4 a[212:215], v252, s[36:39], s18 offen offset:3072
    s_add_u32 s18, s19, 55296
    buffer_load_dwordx4 a[216:219], v252, s[36:39], s18 offen offset:0
    buffer_load_dwordx4 a[220:223], v252, s[36:39], s18 offen offset:1024
    v_mov_b32 v228, 0
    v_mov_b32 v229, 0
    v_mov_b32 v230, 0
    v_mov_b32 v231, 0
    s_nop 1
    s_waitcnt vmcnt(42) lgkmcnt(0)
    v_mfma_f32_16x16x32_bf16 v[228:231], v[32:35], a[0:3], v[228:231]
    v_mfma_f32_16x16x32_bf16 v[228:231], v[36:39], a[4:7], v[228:231]
    v_mfma_f32_16x16x32_bf16 v[228:231], v[40:43], a[8:11], v[228:231]
    v_mfma_f32_16x16x32_bf16 v[228:231], v[44:47], a[12:15], v[228:231]
    v_mfma_f32_16x16x32_bf16 v[228:231], v[48:51], a[16:19], v[228:231]
    v_mfma_f32_16x16x32_bf16 v[228:231], v[52:55], a[20:23], v[228:231]
    v_mfma_f32_16x16x32_bf16 v[228:231], v[56:59], a[24:27], v[228:231]
    v_mfma_f32_16x16x32_bf16 v[228:231], v[60:63], a[28:31], v[228:231]
    v_mfma_f32_16x16x32_bf16 v[228:231], v[64:67], a[32:35], v[228:231]
    v_mfma_f32_16x16x32_bf16 v[228:231], v[68:71], a[36:39], v[228:231]
    v_mfma_f32_16x16x32_bf16 v[228:231], v[72:75], a[40:43], v[228:231]
    v_mfma_f32_16x16x32_bf16 v[228:231], v[76:79], a[44:47], v[228:231]
    v_mfma_f32_16x16x32_bf16 v[228:231], v[80:83], a[48:51], v[228:231]
    v_mfma_f32_16x16x32_bf16 v[228:231], v[84:87], a[52:55], v[228:231]
    s_nop 7
    s_nop 1
    v_cvt_pk_bf16_f32 v232, v228, v229
    v_lshlrev_b32 v228, 16, v232
    v_and_b32 v229, 0xffff0000, v232
    v_cvt_pk_bf16_f32 v232, v230, v231
    v_lshlrev_b32 v230, 16, v232
    v_and_b32 v231, 0xffff0000, v232
    v_mul_f32 v233, v228, v228
    v_fma_f32 v233, v233, s14, v254
    v_mul_f32 v233, v233, v228
    v_exp_f32 v233, v233
    v_mul_f32 v234, v229, v229
    v_fma_f32 v234, v234, s14, v254
    v_mul_f32 v234, v234, v229
    v_exp_f32 v234, v234
    v_mul_f32 v235, v230, v230
    v_fma_f32 v235, v235, s14, v254
    v_mul_f32 v235, v235, v230
    v_exp_f32 v235, v235
    v_mul_f32 v236, v231, v231
    v_fma_f32 v236, v236, s14, v254
    v_mul_f32 v236, v236, v231
    v_exp_f32 v236, v236
    s_nop 0
    v_add_f32 v233, 1.0, v233
    v_rcp_f32 v233, v233
    v_add_f32 v234, 1.0, v234
    v_rcp_f32 v234, v234
    v_add_f32 v235, 1.0, v235
    v_rcp_f32 v235, v235
    v_add_f32 v236, 1.0, v236
    v_rcp_f32 v236, v236
    s_nop 0
    v_mul_f32 v228, v228, v233
    v_mul_f32 v229, v229, v234
    v_mul_f32 v230, v230, v235
    v_mul_f32 v231, v231, v236
    v_cvt_pk_bf16_f32 v200, v228, v229
    v_cvt_pk_bf16_f32 v201, v230, v231
    s_add_u32 s18, s19, 57344
    buffer_load_dwordx4 a[0:3], v252, s[36:39], s18 offen offset:0
    buffer_load_dwordx4 a[4:7], v252, s[36:39], s18 offen offset:1024
    buffer_load_dwordx4 a[8:11], v252, s[36:39], s18 offen offset:2048
    buffer_load_dwordx4 a[12:15], v252, s[36:39], s18 offen offset:3072
    s_add_u32 s18, s19, 61440
    buffer_load_dwordx4 a[16:19], v252, s[36:39], s18 offen offset:0
    buffer_load_dwordx4 a[20:23], v252, s[36:39], s18 offen offset:1024
    buffer_load_dwordx4 a[24:27], v252, s[36:39], s18 offen offset:2048
    buffer_load_dwordx4 a[28:31], v252, s[36:39], s18 offen offset:3072
    s_add_u32 s18, s19, 65536
    buffer_load_dwordx4 a[32:35], v252, s[36:39], s18 offen offset:0
    buffer_load_dwordx4 a[36:39], v252, s[36:39], s18 offen offset:1024
    buffer_load_dwordx4 a[40:43], v252, s[36:39], s18 offen offset:2048
    buffer_load_dwordx4 a[44:47], v252, s[36:39], s18 offen offset:3072
    s_add_u32 s18, s19, 69632
    buffer_load_dwordx4 a[48:51], v252, s[36:39], s18 offen offset:0
    buffer_load_dwordx4 a[52:55], v252, s[36:39], s18 offen offset:1024
    v_mov_b32 v228, 0
    v_mov_b32 v229, 0
    v_mov_b32 v230, 0
    v_mov_b32 v231, 0
    s_nop 1
    s_waitcnt vmcnt(42) lgkmcnt(0)
    v_mfma_f32_16x16x32_bf16 v[228:231], v[32:35], a[56:59], v[228:231]
    v_mfma_f32_16x16x32_bf16 v[228:231], v[36:39], a[60:63], v[228:231]
    v_mfma_f32_16x16x32_bf16 v[228:231], v[40:43], a[64:67], v[228:231]
    v_mfma_f32_16x16x32_bf16 v[228:231], v[44:47], a[68:71], v[228:231]
    v_mfma_f32_16x16x32_bf16 v[228:231], v[48:51], a[72:75], v[228:231]
    v_mfma_f32_16x16x32_bf16 v[228:231], v[52:55], a[76:79], v[228:231]
    v_mfma_f32_16x16x32_bf16 v[228:231], v[56:59], a[80:83], v[228:231]
    v_mfma_f32_16x16x32_bf16 v[228:231], v[60:63], a[84:87], v[228:231]
    v_mfma_f32_16x16x32_bf16 v[228:231], v[64:67], a[88:91], v[228:231]
    v_mfma_f32_16x16x32_bf16 v[228:231], v[68:71], a[92:95], v[228:231]
    v_mfma_f32_16x16x32_bf16 v[228:231], v[72:75], a[96:99], v[228:231]
    v_mfma_f32_16x16x32_bf16 v[228:231], v[76:79], a[100:103], v[228:231]
    v_mfma_f32_16x16x32_bf16 v[228:231], v[80:83], a[104:107], v[228:231]
    v_mfma_f32_16x16x32_bf16 v[228:231], v[84:87], a[108:111], v[228:231]
    s_nop 7
    s_nop 1
    v_cvt_pk_bf16_f32 v232, v228, v229
    v_lshlrev_b32 v228, 16, v232
    v_and_b32 v229, 0xffff0000, v232
    v_cvt_pk_bf16_f32 v232, v230, v231
    v_lshlrev_b32 v230, 16, v232
    v_and_b32 v231, 0xffff0000, v232
    v_mul_f32 v233, v228, v228
    v_fma_f32 v233, v233, s14, v254
    v_mul_f32 v233, v233, v228
    v_exp_f32 v233, v233
    v_mul_f32 v234, v229, v229
    v_fma_f32 v234, v234, s14, v254
    v_mul_f32 v234, v234, v229
    v_exp_f32 v234, v234
    v_mul_f32 v235, v230, v230
    v_fma_f32 v235, v235, s14, v254
    v_mul_f32 v235, v235, v230
    v_exp_f32 v235, v235
    v_mul_f32 v236, v231, v231
    v_fma_f32 v236, v236, s14, v254
    v_mul_f32 v236, v236, v231
    v_exp_f32 v236, v236
    s_nop 0
    v_add_f32 v233, 1.0, v233
    v_rcp_f32 v233, v233
    v_add_f32 v234, 1.0, v234
    v_rcp_f32 v234, v234
    v_add_f32 v235, 1.0, v235
    v_rcp_f32 v235, v235
    v_add_f32 v236, 1.0, v236
    v_rcp_f32 v236, v236
    s_nop 0
    v_mul_f32 v228, v228, v233
    v_mul_f32 v229, v229, v234
    v_mul_f32 v230, v230, v235
    v_mul_f32 v231, v231, v236
    v_cvt_pk_bf16_f32 v202, v228, v229
    v_cvt_pk_bf16_f32 v203, v230, v231
    s_add_u32 s18, s19, 71680
    buffer_load_dwordx4 a[56:59], v252, s[36:39], s18 offen offset:0
    buffer_load_dwordx4 a[60:63], v252, s[36:39], s18 offen offset:1024
    buffer_load_dwordx4 a[64:67], v252, s[36:39], s18 offen offset:2048
    buffer_load_dwordx4 a[68:71], v252, s[36:39], s18 offen offset:3072
    s_add_u32 s18, s19, 75776
    buffer_load_dwordx4 a[72:75], v252, s[36:39], s18 offen offset:0
    buffer_load_dwordx4 a[76:79], v252, s[36:39], s18 offen offset:1024
    buffer_load_dwordx4 a[80:83], v252, s[36:39], s18 offen offset:2048
    buffer_load_dwordx4 a[84:87], v252, s[36:39], s18 offen offset:3072
    s_add_u32 s18, s19, 79872
    buffer_load_dwordx4 a[88:91], v252, s[36:39], s18 offen offset:0
    buffer_load_dwordx4 a[92:95], v252, s[36:39], s18 offen offset:1024
    buffer_load_dwordx4 a[96:99], v252, s[36:39], s18 offen offset:2048
    buffer_load_dwordx4 a[100:103], v252, s[36:39], s18 offen offset:3072
    s_add_u32 s18, s19, 83968
    buffer_load_dwordx4 a[104:107], v252, s[36:39], s18 offen offset:0
    buffer_load_dwordx4 a[108:111], v252, s[36:39], s18 offen offset:1024
    v_mov_b32 v228, 0
    v_mov_b32 v229, 0
    v_mov_b32 v230, 0
    v_mov_b32 v231, 0
    s_nop 1
    s_waitcnt vmcnt(42) lgkmcnt(0)
    v_mfma_f32_16x16x32_bf16 v[228:231], v[32:35], a[112:115], v[228:231]
    v_mfma_f32_16x16x32_bf16 v[228:231], v[36:39], a[116:119], v[228:231]
    v_mfma_f32_16x16x32_bf16 v[228:231], v[40:43], a[120:123], v[228:231]
    v_mfma_f32_16x16x32_bf16 v[228:231], v[44:47], a[124:127], v[228:231]
    v_mfma_f32_16x16x32_bf16 v[228:231], v[48:51], a[128:131], v[228:231]
    v_mfma_f32_16x16x32_bf16 v[228:231], v[52:55], a[132:135], v[228:231]
    v_mfma_f32_16x16x32_bf16 v[228:231], v[56:59], a[136:139], v[228:231]
    v_mfma_f32_16x16x32_bf16 v[228:231], v[60:63], a[140:143], v[228:231]
    v_mfma_f32_16x16x32_bf16 v[228:231], v[64:67], a[144:147], v[228:231]
    v_mfma_f32_16x16x32_bf16 v[228:231], v[68:71], a[148:151], v[228:231]
    v_mfma_f32_16x16x32_bf16 v[228:231], v[72:75], a[152:155], v[228:231]
    v_mfma_f32_16x16x32_bf16 v[228:231], v[76:79], a[156:159], v[228:231]
    v_mfma_f32_16x16x32_bf16 v[228:231], v[80:83], a[160:163], v[228:231]
    v_mfma_f32_16x16x32_bf16 v[228:231], v[84:87], a[164:167], v[228:231]
    s_nop 7
    s_nop 1
    v_cvt_pk_bf16_f32 v232, v228, v229
    v_lshlrev_b32 v228, 16, v232
    v_and_b32 v229, 0xffff0000, v232
    v_cvt_pk_bf16_f32 v232, v230, v231
    v_lshlrev_b32 v230, 16, v232
    v_and_b32 v231, 0xffff0000, v232
    v_mul_f32 v233, v228, v228
    v_fma_f32 v233, v233, s14, v254
    v_mul_f32 v233, v233, v228
    v_exp_f32 v233, v233
    v_mul_f32 v234, v229, v229
    v_fma_f32 v234, v234, s14, v254
    v_mul_f32 v234, v234, v229
    v_exp_f32 v234, v234
    v_mul_f32 v235, v230, v230
    v_fma_f32 v235, v235, s14, v254
    v_mul_f32 v235, v235, v230
    v_exp_f32 v235, v235
    v_mul_f32 v236, v231, v231
    v_fma_f32 v236, v236, s14, v254
    v_mul_f32 v236, v236, v231
    v_exp_f32 v236, v236
    s_nop 0
    v_add_f32 v233, 1.0, v233
    v_rcp_f32 v233, v233
    v_add_f32 v234, 1.0, v234
    v_rcp_f32 v234, v234
    v_add_f32 v235, 1.0, v235
    v_rcp_f32 v235, v235
    v_add_f32 v236, 1.0, v236
    v_rcp_f32 v236, v236
    s_nop 0
    v_mul_f32 v228, v228, v233
    v_mul_f32 v229, v229, v234
    v_mul_f32 v230, v230, v235
    v_mul_f32 v231, v231, v236
    v_cvt_pk_bf16_f32 v204, v228, v229
    v_cvt_pk_bf16_f32 v205, v230, v231
    s_add_u32 s18, s19, 86016
    buffer_load_dwordx4 a[112:115], v252, s[36:39], s18 offen offset:0
    buffer_load_dwordx4 a[116:119], v252, s[36:39], s18 offen offset:1024
    buffer_load_dwordx4 a[120:123], v252, s[36:39], s18 offen offset:2048
    buffer_load_dwordx4 a[124:127], v252, s[36:39], s18 offen offset:3072
    s_add_u32 s18, s19, 90112
    buffer_load_dwordx4 a[128:131], v252, s[36:39], s18 offen offset:0
    buffer_load_dwordx4 a[132:135], v252, s[36:39], s18 offen offset:1024
    buffer_load_dwordx4 a[136:139], v252, s[36:39], s18 offen offset:2048
    buffer_load_dwordx4 a[140:143], v252, s[36:39], s18 offen offset:3072
    s_add_u32 s18, s19, 94208
    buffer_load_dwordx4 a[144:147], v252, s[36:39], s18 offen offset:0
    buffer_load_dwordx4 a[148:151], v252, s[36:39], s18 offen offset:1024
    buffer_load_dwordx4 a[152:155], v252, s[36:39], s18 offen offset:2048
    buffer_load_dwordx4 a[156:159], v252, s[36:39], s18 offen offset:3072
    s_add_u32 s18, s19, 98304
    buffer_load_dwordx4 a[160:163], v252, s[36:39], s18 offen offset:0
    buffer_load_dwordx4 a[164:167], v252, s[36:39], s18 offen offset:1024
    v_mov_b32 v228, 0
    v_mov_b32 v229, 0
    v_mov_b32 v230, 0
    v_mov_b32 v231, 0
    s_nop 1
    s_waitcnt vmcnt(42) lgkmcnt(0)
    v_mfma_f32_16x16x32_bf16 v[228:231], v[32:35], a[168:171], v[228:231]
    v_mfma_f32_16x16x32_bf16 v[228:231], v[36:39], a[172:175], v[228:231]
    v_mfma_f32_16x16x32_bf16 v[228:231], v[40:43], a[176:179], v[228:231]
    v_mfma_f32_16x16x32_bf16 v[228:231], v[44:47], a[180:183], v[228:231]
    v_mfma_f32_16x16x32_bf16 v[228:231], v[48:51], a[184:187], v[228:231]
    v_mfma_f32_16x16x32_bf16 v[228:231], v[52:55], a[188:191], v[228:231]
    v_mfma_f32_16x16x32_bf16 v[228:231], v[56:59], a[192:195], v[228:231]
    v_mfma_f32_16x16x32_bf16 v[228:231], v[60:63], a[196:199], v[228:231]
    v_mfma_f32_16x16x32_bf16 v[228:231], v[64:67], a[200:203], v[228:231]
    v_mfma_f32_16x16x32_bf16 v[228:231], v[68:71], a[204:207], v[228:231]
    v_mfma_f32_16x16x32_bf16 v[228:231], v[72:75], a[208:211], v[228:231]
    v_mfma_f32_16x16x32_bf16 v[228:231], v[76:79], a[212:215], v[228:231]
    v_mfma_f32_16x16x32_bf16 v[228:231], v[80:83], a[216:219], v[228:231]
    v_mfma_f32_16x16x32_bf16 v[228:231], v[84:87], a[220:223], v[228:231]
    s_nop 7
    s_nop 1
    v_cvt_pk_bf16_f32 v232, v228, v229
    v_lshlrev_b32 v228, 16, v232
    v_and_b32 v229, 0xffff0000, v232
    v_cvt_pk_bf16_f32 v232, v230, v231
    v_lshlrev_b32 v230, 16, v232
    v_and_b32 v231, 0xffff0000, v232
    v_mul_f32 v233, v228, v228
    v_fma_f32 v233, v233, s14, v254
    v_mul_f32 v233, v233, v228
    v_exp_f32 v233, v233
    v_mul_f32 v234, v229, v229
    v_fma_f32 v234, v234, s14, v254
    v_mul_f32 v234, v234, v229
    v_exp_f32 v234, v234
    v_mul_f32 v235, v230, v230
    v_fma_f32 v235, v235, s14, v254
    v_mul_f32 v235, v235, v230
    v_exp_f32 v235, v235
    v_mul_f32 v236, v231, v231
    v_fma_f32 v236, v236, s14, v254
    v_mul_f32 v236, v236, v231
    v_exp_f32 v236, v236
    s_nop 0
    v_add_f32 v233, 1.0, v233
    v_rcp_f32 v233, v233
    v_add_f32 v234, 1.0, v234
    v_rcp_f32 v234, v234
    v_add_f32 v235, 1.0, v235
    v_rcp_f32 v235, v235
    v_add_f32 v236, 1.0, v236
    v_rcp_f32 v236, v236
    s_nop 0
    v_mul_f32 v228, v228, v233
    v_mul_f32 v229, v229, v234
    v_mul_f32 v230, v230, v235
    v_mul_f32 v231, v231, v236
    v_cvt_pk_bf16_f32 v206, v228, v229
    v_cvt_pk_bf16_f32 v207, v230, v231
    s_add_u32 s18, s19, 100352
    buffer_load_dwordx4 a[168:171], v252, s[36:39], s18 offen offset:0
    buffer_load_dwordx4 a[172:175], v252, s[36:39], s18 offen offset:1024
    buffer_load_dwordx4 a[176:179], v252, s[36:39], s18 offen offset:2048
    buffer_load_dwordx4 a[180:183], v252, s[36:39], s18 offen offset:3072
    s_add_u32 s18, s19, 104448
    buffer_load_dwordx4 a[184:187], v252, s[36:39], s18 offen offset:0
    buffer_load_dwordx4 a[188:191], v252, s[36:39], s18 offen offset:1024
    buffer_load_dwordx4 a[192:195], v252, s[36:39], s18 offen offset:2048
    buffer_load_dwordx4 a[196:199], v252, s[36:39], s18 offen offset:3072
    s_add_u32 s18, s19, 108544
    buffer_load_dwordx4 a[200:203], v252, s[36:39], s18 offen offset:0
    buffer_load_dwordx4 a[204:207], v252, s[36:39], s18 offen offset:1024
    buffer_load_dwordx4 a[208:211], v252, s[36:39], s18 offen offset:2048
    buffer_load_dwordx4 a[212:215], v252, s[36:39], s18 offen offset:3072
    s_add_u32 s18, s19, 112640
    buffer_load_dwordx4 a[216:219], v252, s[36:39], s18 offen offset:0
    buffer_load_dwordx4 a[220:223], v252, s[36:39], s18 offen offset:1024
    v_mov_b32 v228, 0
    v_mov_b32 v229, 0
    v_mov_b32 v230, 0
    v_mov_b32 v231, 0
    s_nop 1
    s_waitcnt vmcnt(42) lgkmcnt(0)
    v_mfma_f32_16x16x32_bf16 v[228:231], v[32:35], a[0:3], v[228:231]
    v_mfma_f32_16x16x32_bf16 v[228:231], v[36:39], a[4:7], v[228:231]
    v_mfma_f32_16x16x32_bf16 v[228:231], v[40:43], a[8:11], v[228:231]
    v_mfma_f32_16x16x32_bf16 v[228:231], v[44:47], a[12:15], v[228:231]
    v_mfma_f32_16x16x32_bf16 v[228:231], v[48:51], a[16:19], v[228:231]
    v_mfma_f32_16x16x32_bf16 v[228:231], v[52:55], a[20:23], v[228:231]
    v_mfma_f32_16x16x32_bf16 v[228:231], v[56:59], a[24:27], v[228:231]
    v_mfma_f32_16x16x32_bf16 v[228:231], v[60:63], a[28:31], v[228:231]
    v_mfma_f32_16x16x32_bf16 v[228:231], v[64:67], a[32:35], v[228:231]
    v_mfma_f32_16x16x32_bf16 v[228:231], v[68:71], a[36:39], v[228:231]
    v_mfma_f32_16x16x32_bf16 v[228:231], v[72:75], a[40:43], v[228:231]
    v_mfma_f32_16x16x32_bf16 v[228:231], v[76:79], a[44:47], v[228:231]
    v_mfma_f32_16x16x32_bf16 v[228:231], v[80:83], a[48:51], v[228:231]
    v_mfma_f32_16x16x32_bf16 v[228:231], v[84:87], a[52:55], v[228:231]
    s_nop 7
    s_nop 1
    v_cvt_pk_bf16_f32 v232, v228, v229
    v_lshlrev_b32 v228, 16, v232
    v_and_b32 v229, 0xffff0000, v232
    v_cvt_pk_bf16_f32 v232, v230, v231
    v_lshlrev_b32 v230, 16, v232
    v_and_b32 v231, 0xffff0000, v232
    v_mul_f32 v233, v228, v228
    v_fma_f32 v233, v233, s14, v254
    v_mul_f32 v233, v233, v228
    v_exp_f32 v233, v233
    v_mul_f32 v234, v229, v229
    v_fma_f32 v234, v234, s14, v254
    v_mul_f32 v234, v234, v229
    v_exp_f32 v234, v234
    v_mul_f32 v235, v230, v230
    v_fma_f32 v235, v235, s14, v254
    v_mul_f32 v235, v235, v230
    v_exp_f32 v235, v235
    v_mul_f32 v236, v231, v231
    v_fma_f32 v236, v236, s14, v254
    v_mul_f32 v236, v236, v231
    v_exp_f32 v236, v236
    s_nop 0
    v_add_f32 v233, 1.0, v233
    v_rcp_f32 v233, v233
    v_add_f32 v234, 1.0, v234
    v_rcp_f32 v234, v234
    v_add_f32 v235, 1.0, v235
    v_rcp_f32 v235, v235
    v_add_f32 v236, 1.0, v236
    v_rcp_f32 v236, v236
    s_nop 0
    v_mul_f32 v228, v228, v233
    v_mul_f32 v229, v229, v234
    v_mul_f32 v230, v230, v235
    v_mul_f32 v231, v231, v236
    v_cvt_pk_bf16_f32 v208, v228, v229
    v_cvt_pk_bf16_f32 v209, v230, v231
    s_add_u32 s18, s19, 114688
    buffer_load_dwordx4 a[0:3], v252, s[36:39], s18 offen offset:0
    buffer_load_dwordx4 a[4:7], v252, s[36:39], s18 offen offset:1024
    buffer_load_dwordx4 a[8:11], v252, s[36:39], s18 offen offset:2048
    buffer_load_dwordx4 a[12:15], v252, s[36:39], s18 offen offset:3072
    s_add_u32 s18, s19, 118784
    buffer_load_dwordx4 a[16:19], v252, s[36:39], s18 offen offset:0
    buffer_load_dwordx4 a[20:23], v252, s[36:39], s18 offen offset:1024
    buffer_load_dwordx4 a[24:27], v252, s[36:39], s18 offen offset:2048
    buffer_load_dwordx4 a[28:31], v252, s[36:39], s18 offen offset:3072
    s_add_u32 s18, s19, 122880
    buffer_load_dwordx4 a[32:35], v252, s[36:39], s18 offen offset:0
    buffer_load_dwordx4 a[36:39], v252, s[36:39], s18 offen offset:1024
    buffer_load_dwordx4 a[40:43], v252, s[36:39], s18 offen offset:2048
    buffer_load_dwordx4 a[44:47], v252, s[36:39], s18 offen offset:3072
    s_add_u32 s18, s19, 126976
    buffer_load_dwordx4 a[48:51], v252, s[36:39], s18 offen offset:0
    buffer_load_dwordx4 a[52:55], v252, s[36:39], s18 offen offset:1024
    v_mov_b32 v228, 0
    v_mov_b32 v229, 0
    v_mov_b32 v230, 0
    v_mov_b32 v231, 0
    s_nop 1
    s_waitcnt vmcnt(42) lgkmcnt(0)
    v_mfma_f32_16x16x32_bf16 v[228:231], v[32:35], a[56:59], v[228:231]
    v_mfma_f32_16x16x32_bf16 v[228:231], v[36:39], a[60:63], v[228:231]
    v_mfma_f32_16x16x32_bf16 v[228:231], v[40:43], a[64:67], v[228:231]
    v_mfma_f32_16x16x32_bf16 v[228:231], v[44:47], a[68:71], v[228:231]
    v_mfma_f32_16x16x32_bf16 v[228:231], v[48:51], a[72:75], v[228:231]
    v_mfma_f32_16x16x32_bf16 v[228:231], v[52:55], a[76:79], v[228:231]
    v_mfma_f32_16x16x32_bf16 v[228:231], v[56:59], a[80:83], v[228:231]
    v_mfma_f32_16x16x32_bf16 v[228:231], v[60:63], a[84:87], v[228:231]
    v_mfma_f32_16x16x32_bf16 v[228:231], v[64:67], a[88:91], v[228:231]
    v_mfma_f32_16x16x32_bf16 v[228:231], v[68:71], a[92:95], v[228:231]
    v_mfma_f32_16x16x32_bf16 v[228:231], v[72:75], a[96:99], v[228:231]
    v_mfma_f32_16x16x32_bf16 v[228:231], v[76:79], a[100:103], v[228:231]
    v_mfma_f32_16x16x32_bf16 v[228:231], v[80:83], a[104:107], v[228:231]
    v_mfma_f32_16x16x32_bf16 v[228:231], v[84:87], a[108:111], v[228:231]
    s_nop 7
    s_nop 1
    v_cvt_pk_bf16_f32 v232, v228, v229
    v_lshlrev_b32 v228, 16, v232
    v_and_b32 v229, 0xffff0000, v232
    v_cvt_pk_bf16_f32 v232, v230, v231
    v_lshlrev_b32 v230, 16, v232
    v_and_b32 v231, 0xffff0000, v232
    v_mul_f32 v233, v228, v228
    v_fma_f32 v233, v233, s14, v254
    v_mul_f32 v233, v233, v228
    v_exp_f32 v233, v233
    v_mul_f32 v234, v229, v229
    v_fma_f32 v234, v234, s14, v254
    v_mul_f32 v234, v234, v229
    v_exp_f32 v234, v234
    v_mul_f32 v235, v230, v230
    v_fma_f32 v235, v235, s14, v254
    v_mul_f32 v235, v235, v230
    v_exp_f32 v235, v235
    v_mul_f32 v236, v231, v231
    v_fma_f32 v236, v236, s14, v254
    v_mul_f32 v236, v236, v231
    v_exp_f32 v236, v236
    s_nop 0
    v_add_f32 v233, 1.0, v233
    v_rcp_f32 v233, v233
    v_add_f32 v234, 1.0, v234
    v_rcp_f32 v234, v234
    v_add_f32 v235, 1.0, v235
    v_rcp_f32 v235, v235
    v_add_f32 v236, 1.0, v236
    v_rcp_f32 v236, v236
    s_nop 0
    v_mul_f32 v228, v228, v233
    v_mul_f32 v229, v229, v234
    v_mul_f32 v230, v230, v235
    v_mul_f32 v231, v231, v236
    v_cvt_pk_bf16_f32 v210, v228, v229
    v_cvt_pk_bf16_f32 v211, v230, v231
    s_add_u32 s18, s19, 129024
    buffer_load_dwordx4 a[56:59], v252, s[36:39], s18 offen offset:0
    buffer_load_dwordx4 a[60:63], v252, s[36:39], s18 offen offset:1024
    buffer_load_dwordx4 a[64:67], v252, s[36:39], s18 offen offset:2048
    buffer_load_dwordx4 a[68:71], v252, s[36:39], s18 offen offset:3072
    s_add_u32 s18, s19, 133120
    buffer_load_dwordx4 a[72:75], v252, s[36:39], s18 offen offset:0
    buffer_load_dwordx4 a[76:79], v252, s[36:39], s18 offen offset:1024
    buffer_load_dwordx4 a[80:83], v252, s[36:39], s18 offen offset:2048
    buffer_load_dwordx4 a[84:87], v252, s[36:39], s18 offen offset:3072
    s_add_u32 s18, s19, 137216
    buffer_load_dwordx4 a[88:91], v252, s[36:39], s18 offen offset:0
    buffer_load_dwordx4 a[92:95], v252, s[36:39], s18 offen offset:1024
    buffer_load_dwordx4 a[96:99], v252, s[36:39], s18 offen offset:2048
    buffer_load_dwordx4 a[100:103], v252, s[36:39], s18 offen offset:3072
    s_add_u32 s18, s19, 141312
    buffer_load_dwordx4 a[104:107], v252, s[36:39], s18 offen offset:0
    buffer_load_dwordx4 a[108:111], v252, s[36:39], s18 offen offset:1024
    v_mov_b32 v228, 0
    v_mov_b32 v229, 0
    v_mov_b32 v230, 0
    v_mov_b32 v231, 0
    s_nop 1
    s_waitcnt vmcnt(42) lgkmcnt(0)
    v_mfma_f32_16x16x32_bf16 v[228:231], v[32:35], a[112:115], v[228:231]
    v_mfma_f32_16x16x32_bf16 v[228:231], v[36:39], a[116:119], v[228:231]
    v_mfma_f32_16x16x32_bf16 v[228:231], v[40:43], a[120:123], v[228:231]
    v_mfma_f32_16x16x32_bf16 v[228:231], v[44:47], a[124:127], v[228:231]
    v_mfma_f32_16x16x32_bf16 v[228:231], v[48:51], a[128:131], v[228:231]
    v_mfma_f32_16x16x32_bf16 v[228:231], v[52:55], a[132:135], v[228:231]
    v_mfma_f32_16x16x32_bf16 v[228:231], v[56:59], a[136:139], v[228:231]
    v_mfma_f32_16x16x32_bf16 v[228:231], v[60:63], a[140:143], v[228:231]
    v_mfma_f32_16x16x32_bf16 v[228:231], v[64:67], a[144:147], v[228:231]
    v_mfma_f32_16x16x32_bf16 v[228:231], v[68:71], a[148:151], v[228:231]
    v_mfma_f32_16x16x32_bf16 v[228:231], v[72:75], a[152:155], v[228:231]
    v_mfma_f32_16x16x32_bf16 v[228:231], v[76:79], a[156:159], v[228:231]
    v_mfma_f32_16x16x32_bf16 v[228:231], v[80:83], a[160:163], v[228:231]
    v_mfma_f32_16x16x32_bf16 v[228:231], v[84:87], a[164:167], v[228:231]
    s_nop 7
    s_nop 1
    v_cvt_pk_bf16_f32 v232, v228, v229
    v_lshlrev_b32 v228, 16, v232
    v_and_b32 v229, 0xffff0000, v232
    v_cvt_pk_bf16_f32 v232, v230, v231
    v_lshlrev_b32 v230, 16, v232
    v_and_b32 v231, 0xffff0000, v232
    v_mul_f32 v233, v228, v228
    v_fma_f32 v233, v233, s14, v254
    v_mul_f32 v233, v233, v228
    v_exp_f32 v233, v233
    v_mul_f32 v234, v229, v229
    v_fma_f32 v234, v234, s14, v254
    v_mul_f32 v234, v234, v229
    v_exp_f32 v234, v234
    v_mul_f32 v235, v230, v230
    v_fma_f32 v235, v235, s14, v254
    v_mul_f32 v235, v235, v230
    v_exp_f32 v235, v235
    v_mul_f32 v236, v231, v231
    v_fma_f32 v236, v236, s14, v254
    v_mul_f32 v236, v236, v231
    v_exp_f32 v236, v236
    s_nop 0
    v_add_f32 v233, 1.0, v233
    v_rcp_f32 v233, v233
    v_add_f32 v234, 1.0, v234
    v_rcp_f32 v234, v234
    v_add_f32 v235, 1.0, v235
    v_rcp_f32 v235, v235
    v_add_f32 v236, 1.0, v236
    v_rcp_f32 v236, v236
    s_nop 0
    v_mul_f32 v228, v228, v233
    v_mul_f32 v229, v229, v234
    v_mul_f32 v230, v230, v235
    v_mul_f32 v231, v231, v236
    v_cvt_pk_bf16_f32 v212, v228, v229
    v_cvt_pk_bf16_f32 v213, v230, v231
    s_add_u32 s18, s19, 143360
    buffer_load_dwordx4 a[112:115], v252, s[36:39], s18 offen offset:0
    buffer_load_dwordx4 a[116:119], v252, s[36:39], s18 offen offset:1024
    buffer_load_dwordx4 a[120:123], v252, s[36:39], s18 offen offset:2048
    buffer_load_dwordx4 a[124:127], v252, s[36:39], s18 offen offset:3072
    s_add_u32 s18, s19, 147456
    buffer_load_dwordx4 a[128:131], v252, s[36:39], s18 offen offset:0
    buffer_load_dwordx4 a[132:135], v252, s[36:39], s18 offen offset:1024
    buffer_load_dwordx4 a[136:139], v252, s[36:39], s18 offen offset:2048
    buffer_load_dwordx4 a[140:143], v252, s[36:39], s18 offen offset:3072
    s_add_u32 s18, s19, 151552
    buffer_load_dwordx4 a[144:147], v252, s[36:39], s18 offen offset:0
    buffer_load_dwordx4 a[148:151], v252, s[36:39], s18 offen offset:1024
    buffer_load_dwordx4 a[152:155], v252, s[36:39], s18 offen offset:2048
    buffer_load_dwordx4 a[156:159], v252, s[36:39], s18 offen offset:3072
    s_add_u32 s18, s19, 155648
    buffer_load_dwordx4 a[160:163], v252, s[36:39], s18 offen offset:0
    buffer_load_dwordx4 a[164:167], v252, s[36:39], s18 offen offset:1024
    v_mov_b32 v228, 0
    v_mov_b32 v229, 0
    v_mov_b32 v230, 0
    v_mov_b32 v231, 0
    s_nop 1
    s_waitcnt vmcnt(42) lgkmcnt(0)
    v_mfma_f32_16x16x32_bf16 v[228:231], v[32:35], a[168:171], v[228:231]
    v_mfma_f32_16x16x32_bf16 v[228:231], v[36:39], a[172:175], v[228:231]
    v_mfma_f32_16x16x32_bf16 v[228:231], v[40:43], a[176:179], v[228:231]
    v_mfma_f32_16x16x32_bf16 v[228:231], v[44:47], a[180:183], v[228:231]
    v_mfma_f32_16x16x32_bf16 v[228:231], v[48:51], a[184:187], v[228:231]
    v_mfma_f32_16x16x32_bf16 v[228:231], v[52:55], a[188:191], v[228:231]
    v_mfma_f32_16x16x32_bf16 v[228:231], v[56:59], a[192:195], v[228:231]
    v_mfma_f32_16x16x32_bf16 v[228:231], v[60:63], a[196:199], v[228:231]
    v_mfma_f32_16x16x32_bf16 v[228:231], v[64:67], a[200:203], v[228:231]
    v_mfma_f32_16x16x32_bf16 v[228:231], v[68:71], a[204:207], v[228:231]
    v_mfma_f32_16x16x32_bf16 v[228:231], v[72:75], a[208:211], v[228:231]
    v_mfma_f32_16x16x32_bf16 v[228:231], v[76:79], a[212:215], v[228:231]
    v_mfma_f32_16x16x32_bf16 v[228:231], v[80:83], a[216:219], v[228:231]
    v_mfma_f32_16x16x32_bf16 v[228:231], v[84:87], a[220:223], v[228:231]
    s_nop 7
    s_nop 1
    v_cvt_pk_bf16_f32 v232, v228, v229
    v_lshlrev_b32 v228, 16, v232
    v_and_b32 v229, 0xffff0000, v232
    v_cvt_pk_bf16_f32 v232, v230, v231
    v_lshlrev_b32 v230, 16, v232
    v_and_b32 v231, 0xffff0000, v232
    v_mul_f32 v233, v228, v228
    v_fma_f32 v233, v233, s14, v254
    v_mul_f32 v233, v233, v228
    v_exp_f32 v233, v233
    v_mul_f32 v234, v229, v229
    v_fma_f32 v234, v234, s14, v254
    v_mul_f32 v234, v234, v229
    v_exp_f32 v234, v234
    v_mul_f32 v235, v230, v230
    v_fma_f32 v235, v235, s14, v254
    v_mul_f32 v235, v235, v230
    v_exp_f32 v235, v235
    v_mul_f32 v236, v231, v231
    v_fma_f32 v236, v236, s14, v254
    v_mul_f32 v236, v236, v231
    v_exp_f32 v236, v236
    s_nop 0
    v_add_f32 v233, 1.0, v233
    v_rcp_f32 v233, v233
    v_add_f32 v234, 1.0, v234
    v_rcp_f32 v234, v234
    v_add_f32 v235, 1.0, v235
    v_rcp_f32 v235, v235
    v_add_f32 v236, 1.0, v236
    v_rcp_f32 v236, v236
    s_nop 0
    v_mul_f32 v228, v228, v233
    v_mul_f32 v229, v229, v234
    v_mul_f32 v230, v230, v235
    v_mul_f32 v231, v231, v236
    v_cvt_pk_bf16_f32 v214, v228, v229
    v_cvt_pk_bf16_f32 v215, v230, v231
    s_add_u32 s18, s19, 157696
    buffer_load_dwordx4 a[168:171], v252, s[36:39], s18 offen offset:0
    buffer_load_dwordx4 a[172:175], v252, s[36:39], s18 offen offset:1024
    buffer_load_dwordx4 a[176:179], v252, s[36:39], s18 offen offset:2048
    buffer_load_dwordx4 a[180:183], v252, s[36:39], s18 offen offset:3072
    s_add_u32 s18, s19, 161792
    buffer_load_dwordx4 a[184:187], v252, s[36:39], s18 offen offset:0
    buffer_load_dwordx4 a[188:191], v252, s[36:39], s18 offen offset:1024
    buffer_load_dwordx4 a[192:195], v252, s[36:39], s18 offen offset:2048
    buffer_load_dwordx4 a[196:199], v252, s[36:39], s18 offen offset:3072
    s_add_u32 s18, s19, 165888
    buffer_load_dwordx4 a[200:203], v252, s[36:39], s18 offen offset:0
    buffer_load_dwordx4 a[204:207], v252, s[36:39], s18 offen offset:1024
    buffer_load_dwordx4 a[208:211], v252, s[36:39], s18 offen offset:2048
    buffer_load_dwordx4 a[212:215], v252, s[36:39], s18 offen offset:3072
    s_add_u32 s18, s19, 169984
    buffer_load_dwordx4 a[216:219], v252, s[36:39], s18 offen offset:0
    buffer_load_dwordx4 a[220:223], v252, s[36:39], s18 offen offset:1024
    v_mov_b32 v228, 0
    v_mov_b32 v229, 0
    v_mov_b32 v230, 0
    v_mov_b32 v231, 0
    s_nop 1
    s_waitcnt vmcnt(42) lgkmcnt(0)
    v_mfma_f32_16x16x32_bf16 v[228:231], v[32:35], a[0:3], v[228:231]
    v_mfma_f32_16x16x32_bf16 v[228:231], v[36:39], a[4:7], v[228:231]
    v_mfma_f32_16x16x32_bf16 v[228:231], v[40:43], a[8:11], v[228:231]
    v_mfma_f32_16x16x32_bf16 v[228:231], v[44:47], a[12:15], v[228:231]
    v_mfma_f32_16x16x32_bf16 v[228:231], v[48:51], a[16:19], v[228:231]
    v_mfma_f32_16x16x32_bf16 v[228:231], v[52:55], a[20:23], v[228:231]
    v_mfma_f32_16x16x32_bf16 v[228:231], v[56:59], a[24:27], v[228:231]
    v_mfma_f32_16x16x32_bf16 v[228:231], v[60:63], a[28:31], v[228:231]
    v_mfma_f32_16x16x32_bf16 v[228:231], v[64:67], a[32:35], v[228:231]
    v_mfma_f32_16x16x32_bf16 v[228:231], v[68:71], a[36:39], v[228:231]
    v_mfma_f32_16x16x32_bf16 v[228:231], v[72:75], a[40:43], v[228:231]
    v_mfma_f32_16x16x32_bf16 v[228:231], v[76:79], a[44:47], v[228:231]
    v_mfma_f32_16x16x32_bf16 v[228:231], v[80:83], a[48:51], v[228:231]
    v_mfma_f32_16x16x32_bf16 v[228:231], v[84:87], a[52:55], v[228:231]
    s_nop 7
    s_nop 1
    v_cvt_pk_bf16_f32 v232, v228, v229
    v_lshlrev_b32 v228, 16, v232
    v_and_b32 v229, 0xffff0000, v232
    v_cvt_pk_bf16_f32 v232, v230, v231
    v_lshlrev_b32 v230, 16, v232
    v_and_b32 v231, 0xffff0000, v232
    v_mul_f32 v233, v228, v228
    v_fma_f32 v233, v233, s14, v254
    v_mul_f32 v233, v233, v228
    v_exp_f32 v233, v233
    v_mul_f32 v234, v229, v229
    v_fma_f32 v234, v234, s14, v254
    v_mul_f32 v234, v234, v229
    v_exp_f32 v234, v234
    v_mul_f32 v235, v230, v230
    v_fma_f32 v235, v235, s14, v254
    v_mul_f32 v235, v235, v230
    v_exp_f32 v235, v235
    v_mul_f32 v236, v231, v231
    v_fma_f32 v236, v236, s14, v254
    v_mul_f32 v236, v236, v231
    v_exp_f32 v236, v236
    s_nop 0
    v_add_f32 v233, 1.0, v233
    v_rcp_f32 v233, v233
    v_add_f32 v234, 1.0, v234
    v_rcp_f32 v234, v234
    v_add_f32 v235, 1.0, v235
    v_rcp_f32 v235, v235
    v_add_f32 v236, 1.0, v236
    v_rcp_f32 v236, v236
    s_nop 0
    v_mul_f32 v228, v228, v233
    v_mul_f32 v229, v229, v234
    v_mul_f32 v230, v230, v235
    v_mul_f32 v231, v231, v236
    v_cvt_pk_bf16_f32 v216, v228, v229
    v_cvt_pk_bf16_f32 v217, v230, v231
    s_add_u32 s18, s19, 172032
    buffer_load_dwordx4 a[0:3], v252, s[36:39], s18 offen offset:0
    buffer_load_dwordx4 a[4:7], v252, s[36:39], s18 offen offset:1024
    buffer_load_dwordx4 a[8:11], v252, s[36:39], s18 offen offset:2048
    buffer_load_dwordx4 a[12:15], v252, s[36:39], s18 offen offset:3072
    s_add_u32 s18, s19, 176128
    buffer_load_dwordx4 a[16:19], v252, s[36:39], s18 offen offset:0
    buffer_load_dwordx4 a[20:23], v252, s[36:39], s18 offen offset:1024
    buffer_load_dwordx4 a[24:27], v252, s[36:39], s18 offen offset:2048
    buffer_load_dwordx4 a[28:31], v252, s[36:39], s18 offen offset:3072
    s_add_u32 s18, s19, 180224
    buffer_load_dwordx4 a[32:35], v252, s[36:39], s18 offen offset:0
    buffer_load_dwordx4 a[36:39], v252, s[36:39], s18 offen offset:1024
    buffer_load_dwordx4 a[40:43], v252, s[36:39], s18 offen offset:2048
    buffer_load_dwordx4 a[44:47], v252, s[36:39], s18 offen offset:3072
    s_add_u32 s18, s19, 184320
    buffer_load_dwordx4 a[48:51], v252, s[36:39], s18 offen offset:0
    buffer_load_dwordx4 a[52:55], v252, s[36:39], s18 offen offset:1024
    v_mov_b32 v228, 0
    v_mov_b32 v229, 0
    v_mov_b32 v230, 0
    v_mov_b32 v231, 0
    s_nop 1
    s_waitcnt vmcnt(42) lgkmcnt(0)
    v_mfma_f32_16x16x32_bf16 v[228:231], v[32:35], a[56:59], v[228:231]
    v_mfma_f32_16x16x32_bf16 v[228:231], v[36:39], a[60:63], v[228:231]
    v_mfma_f32_16x16x32_bf16 v[228:231], v[40:43], a[64:67], v[228:231]
    v_mfma_f32_16x16x32_bf16 v[228:231], v[44:47], a[68:71], v[228:231]
    v_mfma_f32_16x16x32_bf16 v[228:231], v[48:51], a[72:75], v[228:231]
    v_mfma_f32_16x16x32_bf16 v[228:231], v[52:55], a[76:79], v[228:231]
    v_mfma_f32_16x16x32_bf16 v[228:231], v[56:59], a[80:83], v[228:231]
    v_mfma_f32_16x16x32_bf16 v[228:231], v[60:63], a[84:87], v[228:231]
    v_mfma_f32_16x16x32_bf16 v[228:231], v[64:67], a[88:91], v[228:231]
    v_mfma_f32_16x16x32_bf16 v[228:231], v[68:71], a[92:95], v[228:231]
    v_mfma_f32_16x16x32_bf16 v[228:231], v[72:75], a[96:99], v[228:231]
    v_mfma_f32_16x16x32_bf16 v[228:231], v[76:79], a[100:103], v[228:231]
    v_mfma_f32_16x16x32_bf16 v[228:231], v[80:83], a[104:107], v[228:231]
    v_mfma_f32_16x16x32_bf16 v[228:231], v[84:87], a[108:111], v[228:231]
    s_nop 7
    s_nop 1
    v_cvt_pk_bf16_f32 v232, v228, v229
    v_lshlrev_b32 v228, 16, v232
    v_and_b32 v229, 0xffff0000, v232
    v_cvt_pk_bf16_f32 v232, v230, v231
    v_lshlrev_b32 v230, 16, v232
    v_and_b32 v231, 0xffff0000, v232
    v_mul_f32 v233, v228, v228
    v_fma_f32 v233, v233, s14, v254
    v_mul_f32 v233, v233, v228
    v_exp_f32 v233, v233
    v_mul_f32 v234, v229, v229
    v_fma_f32 v234, v234, s14, v254
    v_mul_f32 v234, v234, v229
    v_exp_f32 v234, v234
    v_mul_f32 v235, v230, v230
    v_fma_f32 v235, v235, s14, v254
    v_mul_f32 v235, v235, v230
    v_exp_f32 v235, v235
    v_mul_f32 v236, v231, v231
    v_fma_f32 v236, v236, s14, v254
    v_mul_f32 v236, v236, v231
    v_exp_f32 v236, v236
    s_nop 0
    v_add_f32 v233, 1.0, v233
    v_rcp_f32 v233, v233
    v_add_f32 v234, 1.0, v234
    v_rcp_f32 v234, v234
    v_add_f32 v235, 1.0, v235
    v_rcp_f32 v235, v235
    v_add_f32 v236, 1.0, v236
    v_rcp_f32 v236, v236
    s_nop 0
    v_mul_f32 v228, v228, v233
    v_mul_f32 v229, v229, v234
    v_mul_f32 v230, v230, v235
    v_mul_f32 v231, v231, v236
    v_cvt_pk_bf16_f32 v218, v228, v229
    v_cvt_pk_bf16_f32 v219, v230, v231
    s_add_u32 s18, s19, 186368
    buffer_load_dwordx4 a[56:59], v252, s[36:39], s18 offen offset:0
    buffer_load_dwordx4 a[60:63], v252, s[36:39], s18 offen offset:1024
    buffer_load_dwordx4 a[64:67], v252, s[36:39], s18 offen offset:2048
    buffer_load_dwordx4 a[68:71], v252, s[36:39], s18 offen offset:3072
    s_add_u32 s18, s19, 190464
    buffer_load_dwordx4 a[72:75], v252, s[36:39], s18 offen offset:0
    buffer_load_dwordx4 a[76:79], v252, s[36:39], s18 offen offset:1024
    buffer_load_dwordx4 a[80:83], v252, s[36:39], s18 offen offset:2048
    buffer_load_dwordx4 a[84:87], v252, s[36:39], s18 offen offset:3072
    s_add_u32 s18, s19, 194560
    buffer_load_dwordx4 a[88:91], v252, s[36:39], s18 offen offset:0
    buffer_load_dwordx4 a[92:95], v252, s[36:39], s18 offen offset:1024
    buffer_load_dwordx4 a[96:99], v252, s[36:39], s18 offen offset:2048
    buffer_load_dwordx4 a[100:103], v252, s[36:39], s18 offen offset:3072
    s_add_u32 s18, s19, 198656
    buffer_load_dwordx4 a[104:107], v252, s[36:39], s18 offen offset:0
    buffer_load_dwordx4 a[108:111], v252, s[36:39], s18 offen offset:1024
    v_mov_b32 v228, 0
    v_mov_b32 v229, 0
    v_mov_b32 v230, 0
    v_mov_b32 v231, 0
    s_nop 1
    s_waitcnt vmcnt(42) lgkmcnt(0)
    v_mfma_f32_16x16x32_bf16 v[228:231], v[32:35], a[112:115], v[228:231]
    v_mfma_f32_16x16x32_bf16 v[228:231], v[36:39], a[116:119], v[228:231]
    v_mfma_f32_16x16x32_bf16 v[228:231], v[40:43], a[120:123], v[228:231]
    v_mfma_f32_16x16x32_bf16 v[228:231], v[44:47], a[124:127], v[228:231]
    v_mfma_f32_16x16x32_bf16 v[228:231], v[48:51], a[128:131], v[228:231]
    v_mfma_f32_16x16x32_bf16 v[228:231], v[52:55], a[132:135], v[228:231]
    v_mfma_f32_16x16x32_bf16 v[228:231], v[56:59], a[136:139], v[228:231]
    v_mfma_f32_16x16x32_bf16 v[228:231], v[60:63], a[140:143], v[228:231]
    v_mfma_f32_16x16x32_bf16 v[228:231], v[64:67], a[144:147], v[228:231]
    v_mfma_f32_16x16x32_bf16 v[228:231], v[68:71], a[148:151], v[228:231]
    v_mfma_f32_16x16x32_bf16 v[228:231], v[72:75], a[152:155], v[228:231]
    v_mfma_f32_16x16x32_bf16 v[228:231], v[76:79], a[156:159], v[228:231]
    v_mfma_f32_16x16x32_bf16 v[228:231], v[80:83], a[160:163], v[228:231]
    v_mfma_f32_16x16x32_bf16 v[228:231], v[84:87], a[164:167], v[228:231]
    s_nop 7
    s_nop 1
    v_cvt_pk_bf16_f32 v232, v228, v229
    v_lshlrev_b32 v228, 16, v232
    v_and_b32 v229, 0xffff0000, v232
    v_cvt_pk_bf16_f32 v232, v230, v231
    v_lshlrev_b32 v230, 16, v232
    v_and_b32 v231, 0xffff0000, v232
    v_mul_f32 v233, v228, v228
    v_fma_f32 v233, v233, s14, v254
    v_mul_f32 v233, v233, v228
    v_exp_f32 v233, v233
    v_mul_f32 v234, v229, v229
    v_fma_f32 v234, v234, s14, v254
    v_mul_f32 v234, v234, v229
    v_exp_f32 v234, v234
    v_mul_f32 v235, v230, v230
    v_fma_f32 v235, v235, s14, v254
    v_mul_f32 v235, v235, v230
    v_exp_f32 v235, v235
    v_mul_f32 v236, v231, v231
    v_fma_f32 v236, v236, s14, v254
    v_mul_f32 v236, v236, v231
    v_exp_f32 v236, v236
    s_nop 0
    v_add_f32 v233, 1.0, v233
    v_rcp_f32 v233, v233
    v_add_f32 v234, 1.0, v234
    v_rcp_f32 v234, v234
    v_add_f32 v235, 1.0, v235
    v_rcp_f32 v235, v235
    v_add_f32 v236, 1.0, v236
    v_rcp_f32 v236, v236
    s_nop 0
    v_mul_f32 v228, v228, v233
    v_mul_f32 v229, v229, v234
    v_mul_f32 v230, v230, v235
    v_mul_f32 v231, v231, v236
    v_cvt_pk_bf16_f32 v220, v228, v229
    v_cvt_pk_bf16_f32 v221, v230, v231
    v_mov_b32 v228, 0
    v_mov_b32 v229, 0
    v_mov_b32 v230, 0
    v_mov_b32 v231, 0
    s_nop 1
    s_waitcnt vmcnt(28) lgkmcnt(0)
    v_mfma_f32_16x16x32_bf16 v[228:231], v[32:35], a[168:171], v[228:231]
    v_mfma_f32_16x16x32_bf16 v[228:231], v[36:39], a[172:175], v[228:231]
    v_mfma_f32_16x16x32_bf16 v[228:231], v[40:43], a[176:179], v[228:231]
    v_mfma_f32_16x16x32_bf16 v[228:231], v[44:47], a[180:183], v[228:231]
    v_mfma_f32_16x16x32_bf16 v[228:231], v[48:51], a[184:187], v[228:231]
    v_mfma_f32_16x16x32_bf16 v[228:231], v[52:55], a[188:191], v[228:231]
    v_mfma_f32_16x16x32_bf16 v[228:231], v[56:59], a[192:195], v[228:231]
    v_mfma_f32_16x16x32_bf16 v[228:231], v[60:63], a[196:199], v[228:231]
    v_mfma_f32_16x16x32_bf16 v[228:231], v[64:67], a[200:203], v[228:231]
    v_mfma_f32_16x16x32_bf16 v[228:231], v[68:71], a[204:207], v[228:231]
    v_mfma_f32_16x16x32_bf16 v[228:231], v[72:75], a[208:211], v[228:231]
    v_mfma_f32_16x16x32_bf16 v[228:231], v[76:79], a[212:215], v[228:231]
    v_mfma_f32_16x16x32_bf16 v[228:231], v[80:83], a[216:219], v[228:231]
    v_mfma_f32_16x16x32_bf16 v[228:231], v[84:87], a[220:223], v[228:231]
    s_nop 7
    s_nop 1
    v_cvt_pk_bf16_f32 v232, v228, v229
    v_lshlrev_b32 v228, 16, v232
    v_and_b32 v229, 0xffff0000, v232
    v_cvt_pk_bf16_f32 v232, v230, v231
    v_lshlrev_b32 v230, 16, v232
    v_and_b32 v231, 0xffff0000, v232
    v_mul_f32 v233, v228, v228
    v_fma_f32 v233, v233, s14, v254
    v_mul_f32 v233, v233, v228
    v_exp_f32 v233, v233
    v_mul_f32 v234, v229, v229
    v_fma_f32 v234, v234, s14, v254
    v_mul_f32 v234, v234, v229
    v_exp_f32 v234, v234
    v_mul_f32 v235, v230, v230
    v_fma_f32 v235, v235, s14, v254
    v_mul_f32 v235, v235, v230
    v_exp_f32 v235, v235
    v_mul_f32 v236, v231, v231
    v_fma_f32 v236, v236, s14, v254
    v_mul_f32 v236, v236, v231
    v_exp_f32 v236, v236
    s_nop 0
    v_add_f32 v233, 1.0, v233
    v_rcp_f32 v233, v233
    v_add_f32 v234, 1.0, v234
    v_rcp_f32 v234, v234
    v_add_f32 v235, 1.0, v235
    v_rcp_f32 v235, v235
    v_add_f32 v236, 1.0, v236
    v_rcp_f32 v236, v236
    s_nop 0
    v_mul_f32 v228, v228, v233
    v_mul_f32 v229, v229, v234
    v_mul_f32 v230, v230, v235
    v_mul_f32 v231, v231, v236
    v_cvt_pk_bf16_f32 v222, v228, v229
    v_cvt_pk_bf16_f32 v223, v230, v231
    v_mov_b32 v228, 0
    v_mov_b32 v229, 0
    v_mov_b32 v230, 0
    v_mov_b32 v231, 0
    s_nop 1
    s_waitcnt vmcnt(14) lgkmcnt(0)
    v_mfma_f32_16x16x32_bf16 v[228:231], v[32:35], a[0:3], v[228:231]
    v_mfma_f32_16x16x32_bf16 v[228:231], v[36:39], a[4:7], v[228:231]
    v_mfma_f32_16x16x32_bf16 v[228:231], v[40:43], a[8:11], v[228:231]
    v_mfma_f32_16x16x32_bf16 v[228:231], v[44:47], a[12:15], v[228:231]
    v_mfma_f32_16x16x32_bf16 v[228:231], v[48:51], a[16:19], v[228:231]
    v_mfma_f32_16x16x32_bf16 v[228:231], v[52:55], a[20:23], v[228:231]
    v_mfma_f32_16x16x32_bf16 v[228:231], v[56:59], a[24:27], v[228:231]
    v_mfma_f32_16x16x32_bf16 v[228:231], v[60:63], a[28:31], v[228:231]
    v_mfma_f32_16x16x32_bf16 v[228:231], v[64:67], a[32:35], v[228:231]
    v_mfma_f32_16x16x32_bf16 v[228:231], v[68:71], a[36:39], v[228:231]
    v_mfma_f32_16x16x32_bf16 v[228:231], v[72:75], a[40:43], v[228:231]
    v_mfma_f32_16x16x32_bf16 v[228:231], v[76:79], a[44:47], v[228:231]
    v_mfma_f32_16x16x32_bf16 v[228:231], v[80:83], a[48:51], v[228:231]
    v_mfma_f32_16x16x32_bf16 v[228:231], v[84:87], a[52:55], v[228:231]
    s_nop 7
    s_nop 1
    v_cvt_pk_bf16_f32 v232, v228, v229
    v_lshlrev_b32 v228, 16, v232
    v_and_b32 v229, 0xffff0000, v232
    v_cvt_pk_bf16_f32 v232, v230, v231
    v_lshlrev_b32 v230, 16, v232
    v_and_b32 v231, 0xffff0000, v232
    v_mul_f32 v233, v228, v228
    v_fma_f32 v233, v233, s14, v254
    v_mul_f32 v233, v233, v228
    v_exp_f32 v233, v233
    v_mul_f32 v234, v229, v229
    v_fma_f32 v234, v234, s14, v254
    v_mul_f32 v234, v234, v229
    v_exp_f32 v234, v234
    v_mul_f32 v235, v230, v230
    v_fma_f32 v235, v235, s14, v254
    v_mul_f32 v235, v235, v230
    v_exp_f32 v235, v235
    v_mul_f32 v236, v231, v231
    v_fma_f32 v236, v236, s14, v254
    v_mul_f32 v236, v236, v231
    v_exp_f32 v236, v236
    s_nop 0
    v_add_f32 v233, 1.0, v233
    v_rcp_f32 v233, v233
    v_add_f32 v234, 1.0, v234
    v_rcp_f32 v234, v234
    v_add_f32 v235, 1.0, v235
    v_rcp_f32 v235, v235
    v_add_f32 v236, 1.0, v236
    v_rcp_f32 v236, v236
    s_nop 0
    v_mul_f32 v228, v228, v233
    v_mul_f32 v229, v229, v234
    v_mul_f32 v230, v230, v235
    v_mul_f32 v231, v231, v236
    v_cvt_pk_bf16_f32 v224, v228, v229
    v_cvt_pk_bf16_f32 v225, v230, v231
    v_mov_b32 v228, 0
    v_mov_b32 v229, 0
    v_mov_b32 v230, 0
    v_mov_b32 v231, 0
    s_nop 1
    s_waitcnt vmcnt(0) lgkmcnt(0)
    v_mfma_f32_16x16x32_bf16 v[228:231], v[32:35], a[56:59], v[228:231]
    v_mfma_f32_16x16x32_bf16 v[228:231], v[36:39], a[60:63], v[228:231]
    v_mfma_f32_16x16x32_bf16 v[228:231], v[40:43], a[64:67], v[228:231]
    v_mfma_f32_16x16x32_bf16 v[228:231], v[44:47], a[68:71], v[228:231]
    v_mfma_f32_16x16x32_bf16 v[228:231], v[48:51], a[72:75], v[228:231]
    v_mfma_f32_16x16x32_bf16 v[228:231], v[52:55], a[76:79], v[228:231]
    v_mfma_f32_16x16x32_bf16 v[228:231], v[56:59], a[80:83], v[228:231]
    v_mfma_f32_16x16x32_bf16 v[228:231], v[60:63], a[84:87], v[228:231]
    v_mfma_f32_16x16x32_bf16 v[228:231], v[64:67], a[88:91], v[228:231]
    v_mfma_f32_16x16x32_bf16 v[228:231], v[68:71], a[92:95], v[228:231]
    v_mfma_f32_16x16x32_bf16 v[228:231], v[72:75], a[96:99], v[228:231]
    v_mfma_f32_16x16x32_bf16 v[228:231], v[76:79], a[100:103], v[228:231]
    v_mfma_f32_16x16x32_bf16 v[228:231], v[80:83], a[104:107], v[228:231]
    v_mfma_f32_16x16x32_bf16 v[228:231], v[84:87], a[108:111], v[228:231]
    s_nop 7
    s_nop 1
    v_cvt_pk_bf16_f32 v232, v228, v229
    v_lshlrev_b32 v228, 16, v232
    v_and_b32 v229, 0xffff0000, v232
    v_cvt_pk_bf16_f32 v232, v230, v231
    v_lshlrev_b32 v230, 16, v232
    v_and_b32 v231, 0xffff0000, v232
    v_mul_f32 v233, v228, v228
    v_fma_f32 v233, v233, s14, v254
    v_mul_f32 v233, v233, v228
    v_exp_f32 v233, v233
    v_mul_f32 v234, v229, v229
    v_fma_f32 v234, v234, s14, v254
    v_mul_f32 v234, v234, v229
    v_exp_f32 v234, v234
    v_mul_f32 v235, v230, v230
    v_fma_f32 v235, v235, s14, v254
    v_mul_f32 v235, v235, v230
    v_exp_f32 v235, v235
    v_mul_f32 v236, v231, v231
    v_fma_f32 v236, v236, s14, v254
    v_mul_f32 v236, v236, v231
    v_exp_f32 v236, v236
    s_nop 0
    v_add_f32 v233, 1.0, v233
    v_rcp_f32 v233, v233
    v_add_f32 v234, 1.0, v234
    v_rcp_f32 v234, v234
    v_add_f32 v235, 1.0, v235
    v_rcp_f32 v235, v235
    v_add_f32 v236, 1.0, v236
    v_rcp_f32 v236, v236
    s_nop 0
    v_mul_f32 v228, v228, v233
    v_mul_f32 v229, v229, v234
    v_mul_f32 v230, v230, v235
    v_mul_f32 v231, v231, v236
    v_cvt_pk_bf16_f32 v226, v228, v229
    v_cvt_pk_bf16_f32 v227, v230, v231
    v_lshlrev_b32 v88, 16, v200
    v_and_b32 v89, 0xffff0000, v200
    v_lshlrev_b32 v90, 16, v201
    v_and_b32 v91, 0xffff0000, v201
    v_lshlrev_b32 v92, 16, v202
    v_and_b32 v93, 0xffff0000, v202
    v_lshlrev_b32 v94, 16, v203
    v_and_b32 v95, 0xffff0000, v203
    v_lshlrev_b32 v96, 16, v204
    v_and_b32 v97, 0xffff0000, v204
    v_lshlrev_b32 v98, 16, v205
    v_and_b32 v99, 0xffff0000, v205
    v_lshlrev_b32 v100, 16, v206
    v_and_b32 v101, 0xffff0000, v206
    v_lshlrev_b32 v102, 16, v207
    v_and_b32 v103, 0xffff0000, v207
    v_lshlrev_b32 v104, 16, v208
    v_and_b32 v105, 0xffff0000, v208
    v_lshlrev_b32 v106, 16, v209
    v_and_b32 v107, 0xffff0000, v209
    v_lshlrev_b32 v108, 16, v210
    v_and_b32 v109, 0xffff0000, v210
    v_lshlrev_b32 v110, 16, v211
    v_and_b32 v111, 0xffff0000, v211
    v_lshlrev_b32 v112, 16, v212
    v_and_b32 v113, 0xffff0000, v212
    v_lshlrev_b32 v114, 16, v213
    v_and_b32 v115, 0xffff0000, v213
    v_lshlrev_b32 v116, 16, v214
    v_and_b32 v117, 0xffff0000, v214
    v_lshlrev_b32 v118, 16, v215
    v_and_b32 v119, 0xffff0000, v215
    v_lshlrev_b32 v120, 16, v216
    v_and_b32 v121, 0xffff0000, v216
    v_lshlrev_b32 v122, 16, v217
    v_and_b32 v123, 0xffff0000, v217
    v_lshlrev_b32 v124, 16, v218
    v_and_b32 v125, 0xffff0000, v218
    v_lshlrev_b32 v126, 16, v219
    v_and_b32 v127, 0xffff0000, v219
    v_lshlrev_b32 v128, 16, v220
    v_and_b32 v129, 0xffff0000, v220
    v_lshlrev_b32 v130, 16, v221
    v_and_b32 v131, 0xffff0000, v221
    v_lshlrev_b32 v132, 16, v222
    v_and_b32 v133, 0xffff0000, v222
    v_lshlrev_b32 v134, 16, v223
    v_and_b32 v135, 0xffff0000, v223
    v_lshlrev_b32 v136, 16, v224
    v_and_b32 v137, 0xffff0000, v224
    v_lshlrev_b32 v138, 16, v225
    v_and_b32 v139, 0xffff0000, v225
    v_lshlrev_b32 v140, 16, v226
    v_and_b32 v141, 0xffff0000, v226
    v_lshlrev_b32 v142, 16, v227
    v_and_b32 v143, 0xffff0000, v227
    v_mov_b32 v228, v88
    v_add_f32 v228, v228, v92
    v_add_f32 v228, v228, v96
    v_add_f32 v228, v228, v100
    v_add_f32 v228, v228, v104
    v_add_f32 v228, v228, v108
    v_add_f32 v228, v228, v112
    v_add_f32 v228, v228, v116
    v_add_f32 v228, v228, v120
    v_add_f32 v228, v228, v124
    v_add_f32 v228, v228, v128
    v_add_f32 v228, v228, v132
    v_add_f32 v228, v228, v136
    v_add_f32 v228, v228, v140
    v_mov_b32 v229, v89
    v_add_f32 v229, v229, v93
    v_add_f32 v229, v229, v97
    v_add_f32 v229, v229, v101
    v_add_f32 v229, v229, v105
    v_add_f32 v229, v229, v109
    v_add_f32 v229, v229, v113
    v_add_f32 v229, v229, v117
    v_add_f32 v229, v229, v121
    v_add_f32 v229, v229, v125
    v_add_f32 v229, v229, v129
    v_add_f32 v229, v229, v133
    v_add_f32 v229, v229, v137
    v_add_f32 v229, v229, v141
    v_mov_b32 v230, v90
    v_add_f32 v230, v230, v94
    v_add_f32 v230, v230, v98
    v_add_f32 v230, v230, v102
    v_add_f32 v230, v230, v106
    v_add_f32 v230, v230, v110
    v_add_f32 v230, v230, v114
    v_add_f32 v230, v230, v118
    v_add_f32 v230, v230, v122
    v_add_f32 v230, v230, v126
    v_add_f32 v230, v230, v130
    v_add_f32 v230, v230, v134
    v_add_f32 v230, v230, v138
    v_add_f32 v230, v230, v142
    v_mov_b32 v231, v91
    v_add_f32 v231, v231, v95
    v_add_f32 v231, v231, v99
    v_add_f32 v231, v231, v103
    v_add_f32 v231, v231, v107
    v_add_f32 v231, v231, v111
    v_add_f32 v231, v231, v115
    v_add_f32 v231, v231, v119
    v_add_f32 v231, v231, v123
    v_add_f32 v231, v231, v127
    v_add_f32 v231, v231, v131
    v_add_f32 v231, v231, v135
    v_add_f32 v231, v231, v139
    v_add_f32 v231, v231, v143
    s_nop 1
    v_add_f32_dpp v236, v228, v228 row_ror:8 row_mask:0xf bank_mask:0xf
    v_mov_b32 v228, v236
    s_nop 1
    v_add_f32_dpp v236, v228, v228 row_ror:4 row_mask:0xf bank_mask:0xf
    v_mov_b32 v228, v236
    s_nop 1
    v_add_f32_dpp v236, v228, v228 row_ror:2 row_mask:0xf bank_mask:0xf
    v_mov_b32 v228, v236
    s_nop 1
    v_add_f32_dpp v236, v228, v228 row_ror:1 row_mask:0xf bank_mask:0xf
    v_mov_b32 v228, v236
    s_nop 1
    v_mov_b32_dpp v228, v236 row_newbcast:0 row_mask:0xf bank_mask:0xf
    s_nop 1
    v_add_f32_dpp v236, v229, v229 row_ror:8 row_mask:0xf bank_mask:0xf
    v_mov_b32 v229, v236
    s_nop 1
    v_add_f32_dpp v236, v229, v229 row_ror:4 row_mask:0xf bank_mask:0xf
    v_mov_b32 v229, v236
    s_nop 1
    v_add_f32_dpp v236, v229, v229 row_ror:2 row_mask:0xf bank_mask:0xf
    v_mov_b32 v229, v236
    s_nop 1
    v_add_f32_dpp v236, v229, v229 row_ror:1 row_mask:0xf bank_mask:0xf
    v_mov_b32 v229, v236
    s_nop 1
    v_mov_b32_dpp v229, v236 row_newbcast:0 row_mask:0xf bank_mask:0xf
    s_nop 1
    v_add_f32_dpp v236, v230, v230 row_ror:8 row_mask:0xf bank_mask:0xf
    v_mov_b32 v230, v236
    s_nop 1
    v_add_f32_dpp v236, v230, v230 row_ror:4 row_mask:0xf bank_mask:0xf
    v_mov_b32 v230, v236
    s_nop 1
    v_add_f32_dpp v236, v230, v230 row_ror:2 row_mask:0xf bank_mask:0xf
    v_mov_b32 v230, v236
    s_nop 1
    v_add_f32_dpp v236, v230, v230 row_ror:1 row_mask:0xf bank_mask:0xf
    v_mov_b32 v230, v236
    s_nop 1
    v_mov_b32_dpp v230, v236 row_newbcast:0 row_mask:0xf bank_mask:0xf
    s_nop 1
    v_add_f32_dpp v236, v231, v231 row_ror:8 row_mask:0xf bank_mask:0xf
    v_mov_b32 v231, v236
    s_nop 1
    v_add_f32_dpp v236, v231, v231 row_ror:4 row_mask:0xf bank_mask:0xf
    v_mov_b32 v231, v236
    s_nop 1
    v_add_f32_dpp v236, v231, v231 row_ror:2 row_mask:0xf bank_mask:0xf
    v_mov_b32 v231, v236
    s_nop 1
    v_add_f32_dpp v236, v231, v231 row_ror:1 row_mask:0xf bank_mask:0xf
    v_mov_b32 v231, v236
    s_nop 1
    v_mov_b32_dpp v231, v236 row_newbcast:0 row_mask:0xf bank_mask:0xf
    v_lshlrev_b32 v9, 6, v3
    v_lshlrev_b32 v10, 4, v2
    v_add_u32 v9, v9, v10
    v_cmp_eq_u32 vcc, 0, v1
    s_and_saveexec_b64 s[50:51], vcc
    ds_write_b128 v9, v[228:231] offset:29504
    s_or_b64 exec, exec, s[50:51]
    s_waitcnt lgkmcnt(0)
    s_barrier
    ds_read_b128 v[240:243], v10 offset:29504
    ds_read_b128 v[244:247], v10 offset:29568
    ds_read_b128 v[248:251], v10 offset:29632
    ds_read_b128 v[252:255], v10 offset:29696
    s_waitcnt lgkmcnt(0)
    v_add_f32 v228, v240, v244
    v_add_f32 v228, v228, v248
    v_add_f32 v228, v228, v252
    v_add_f32 v229, v241, v245
    v_add_f32 v229, v229, v249
    v_add_f32 v229, v229, v253
    v_add_f32 v230, v242, v246
    v_add_f32 v230, v230, v250
    v_add_f32 v230, v230, v254
    v_add_f32 v231, v243, v247
    v_add_f32 v231, v231, v251
    v_add_f32 v231, v231, v255
    v_mul_f32 v144, 0x3a924925, v228
    v_mov_b32 v228, 0
    v_sub_f32 v236, v88, v144
    v_fmac_f32 v228, v236, v236
    v_sub_f32 v236, v92, v144
    v_fmac_f32 v228, v236, v236
    v_sub_f32 v236, v96, v144
    v_fmac_f32 v228, v236, v236
    v_sub_f32 v236, v100, v144
    v_fmac_f32 v228, v236, v236
    v_sub_f32 v236, v104, v144
    v_fmac_f32 v228, v236, v236
    v_sub_f32 v236, v108, v144
    v_fmac_f32 v228, v236, v236
    v_sub_f32 v236, v112, v144
    v_fmac_f32 v228, v236, v236
    v_sub_f32 v236, v116, v144
    v_fmac_f32 v228, v236, v236
    v_sub_f32 v236, v120, v144
    v_fmac_f32 v228, v236, v236
    v_sub_f32 v236, v124, v144
    v_fmac_f32 v228, v236, v236
    v_sub_f32 v236, v128, v144
    v_fmac_f32 v228, v236, v236
    v_sub_f32 v236, v132, v144
    v_fmac_f32 v228, v236, v236
    v_sub_f32 v236, v136, v144
    v_fmac_f32 v228, v236, v236
    v_sub_f32 v236, v140, v144
    v_fmac_f32 v228, v236, v236
    v_mul_f32 v145, 0x3a924925, v229
    v_mov_b32 v229, 0
    v_sub_f32 v236, v89, v145
    v_fmac_f32 v229, v236, v236
    v_sub_f32 v236, v93, v145
    v_fmac_f32 v229, v236, v236
    v_sub_f32 v236, v97, v145
    v_fmac_f32 v229, v236, v236
    v_sub_f32 v236, v101, v145
    v_fmac_f32 v229, v236, v236
    v_sub_f32 v236, v105, v145
    v_fmac_f32 v229, v236, v236
    v_sub_f32 v236, v109, v145
    v_fmac_f32 v229, v236, v236
    v_sub_f32 v236, v113, v145
    v_fmac_f32 v229, v236, v236
    v_sub_f32 v236, v117, v145
    v_fmac_f32 v229, v236, v236
    v_sub_f32 v236, v121, v145
    v_fmac_f32 v229, v236, v236
    v_sub_f32 v236, v125, v145
    v_fmac_f32 v229, v236, v236
    v_sub_f32 v236, v129, v145
    v_fmac_f32 v229, v236, v236
    v_sub_f32 v236, v133, v145
    v_fmac_f32 v229, v236, v236
    v_sub_f32 v236, v137, v145
    v_fmac_f32 v229, v236, v236
    v_sub_f32 v236, v141, v145
    v_fmac_f32 v229, v236, v236
    v_mul_f32 v146, 0x3a924925, v230
    v_mov_b32 v230, 0
    v_sub_f32 v236, v90, v146
    v_fmac_f32 v230, v236, v236
    v_sub_f32 v236, v94, v146
    v_fmac_f32 v230, v236, v236
    v_sub_f32 v236, v98, v146
    v_fmac_f32 v230, v236, v236
    v_sub_f32 v236, v102, v146
    v_fmac_f32 v230, v236, v236
    v_sub_f32 v236, v106, v146
    v_fmac_f32 v230, v236, v236
    v_sub_f32 v236, v110, v146
    v_fmac_f32 v230, v236, v236
    v_sub_f32 v236, v114, v146
    v_fmac_f32 v230, v236, v236
    v_sub_f32 v236, v118, v146
    v_fmac_f32 v230, v236, v236
    v_sub_f32 v236, v122, v146
    v_fmac_f32 v230, v236, v236
    v_sub_f32 v236, v126, v146
    v_fmac_f32 v230, v236, v236
    v_sub_f32 v236, v130, v146
    v_fmac_f32 v230, v236, v236
    v_sub_f32 v236, v134, v146
    v_fmac_f32 v230, v236, v236
    v_sub_f32 v236, v138, v146
    v_fmac_f32 v230, v236, v236
    v_sub_f32 v236, v142, v146
    v_fmac_f32 v230, v236, v236
    v_mul_f32 v147, 0x3a924925, v231
    v_mov_b32 v231, 0
    v_sub_f32 v236, v91, v147
    v_fmac_f32 v231, v236, v236
    v_sub_f32 v236, v95, v147
    v_fmac_f32 v231, v236, v236
    v_sub_f32 v236, v99, v147
    v_fmac_f32 v231, v236, v236
    v_sub_f32 v236, v103, v147
    v_fmac_f32 v231, v236, v236
    v_sub_f32 v236, v107, v147
    v_fmac_f32 v231, v236, v236
    v_sub_f32 v236, v111, v147
    v_fmac_f32 v231, v236, v236
    v_sub_f32 v236, v115, v147
    v_fmac_f32 v231, v236, v236
    v_sub_f32 v236, v119, v147
    v_fmac_f32 v231, v236, v236
    v_sub_f32 v236, v123, v147
    v_fmac_f32 v231, v236, v236
    v_sub_f32 v236, v127, v147
    v_fmac_f32 v231, v236, v236
    v_sub_f32 v236, v131, v147
    v_fmac_f32 v231, v236, v236
    v_sub_f32 v236, v135, v147
    v_fmac_f32 v231, v236, v236
    v_sub_f32 v236, v139, v147
    v_fmac_f32 v231, v236, v236
    v_sub_f32 v236, v143, v147
    v_fmac_f32 v231, v236, v236
    s_nop 1
    v_add_f32_dpp v236, v228, v228 row_ror:8 row_mask:0xf bank_mask:0xf
    v_mov_b32 v228, v236
    s_nop 1
    v_add_f32_dpp v236, v228, v228 row_ror:4 row_mask:0xf bank_mask:0xf
    v_mov_b32 v228, v236
    s_nop 1
    v_add_f32_dpp v236, v228, v228 row_ror:2 row_mask:0xf bank_mask:0xf
    v_mov_b32 v228, v236
    s_nop 1
    v_add_f32_dpp v236, v228, v228 row_ror:1 row_mask:0xf bank_mask:0xf
    v_mov_b32 v228, v236
    s_nop 1
    v_mov_b32_dpp v228, v236 row_newbcast:0 row_mask:0xf bank_mask:0xf
    s_nop 1
    v_add_f32_dpp v236, v229, v229 row_ror:8 row_mask:0xf bank_mask:0xf
    v_mov_b32 v229, v236
    s_nop 1
    v_add_f32_dpp v236, v229, v229 row_ror:4 row_mask:0xf bank_mask:0xf
    v_mov_b32 v229, v236
    s_nop 1
    v_add_f32_dpp v236, v229, v229 row_ror:2 row_mask:0xf bank_mask:0xf
    v_mov_b32 v229, v236
    s_nop 1
    v_add_f32_dpp v236, v229, v229 row_ror:1 row_mask:0xf bank_mask:0xf
    v_mov_b32 v229, v236
    s_nop 1
    v_mov_b32_dpp v229, v236 row_newbcast:0 row_mask:0xf bank_mask:0xf
    s_nop 1
    v_add_f32_dpp v236, v230, v230 row_ror:8 row_mask:0xf bank_mask:0xf
    v_mov_b32 v230, v236
    s_nop 1
    v_add_f32_dpp v236, v230, v230 row_ror:4 row_mask:0xf bank_mask:0xf
    v_mov_b32 v230, v236
    s_nop 1
    v_add_f32_dpp v236, v230, v230 row_ror:2 row_mask:0xf bank_mask:0xf
    v_mov_b32 v230, v236
    s_nop 1
    v_add_f32_dpp v236, v230, v230 row_ror:1 row_mask:0xf bank_mask:0xf
    v_mov_b32 v230, v236
    s_nop 1
    v_mov_b32_dpp v230, v236 row_newbcast:0 row_mask:0xf bank_mask:0xf
    s_nop 1
    v_add_f32_dpp v236, v231, v231 row_ror:8 row_mask:0xf bank_mask:0xf
    v_mov_b32 v231, v236
    s_nop 1
    v_add_f32_dpp v236, v231, v231 row_ror:4 row_mask:0xf bank_mask:0xf
    v_mov_b32 v231, v236
    s_nop 1
    v_add_f32_dpp v236, v231, v231 row_ror:2 row_mask:0xf bank_mask:0xf
    v_mov_b32 v231, v236
    s_nop 1
    v_add_f32_dpp v236, v231, v231 row_ror:1 row_mask:0xf bank_mask:0xf
    v_mov_b32 v231, v236
    s_nop 1
    v_mov_b32_dpp v231, v236 row_newbcast:0 row_mask:0xf bank_mask:0xf
    v_lshlrev_b32 v9, 6, v3
    v_lshlrev_b32 v10, 4, v2
    v_add_u32 v9, v9, v10
    v_cmp_eq_u32 vcc, 0, v1
    s_and_saveexec_b64 s[50:51], vcc
    ds_write_b128 v9, v[228:231] offset:29760
    s_or_b64 exec, exec, s[50:51]
    s_waitcnt lgkmcnt(0)
    s_barrier
    ds_read_b128 v[240:243], v10 offset:29760
    ds_read_b128 v[244:247], v10 offset:29824
    ds_read_b128 v[248:251], v10 offset:29888
    ds_read_b128 v[252:255], v10 offset:29952
    s_waitcnt lgkmcnt(0)
    v_add_f32 v228, v240, v244
    v_add_f32 v228, v228, v248
    v_add_f32 v228, v228, v252
    v_add_f32 v229, v241, v245
    v_add_f32 v229, v229, v249
    v_add_f32 v229, v229, v253
    v_add_f32 v230, v242, v246
    v_add_f32 v230, v230, v250
    v_add_f32 v230, v230, v254
    v_add_f32 v231, v243, v247
    v_add_f32 v231, v231, v251
    v_add_f32 v231, v231, v255
    v_mul_f32 v148, 0x3a924925, v228
    v_cvt_pk_bf16_f32 v144, v144, v144
    v_lshlrev_b32 v144, 16, v144
    v_cvt_pk_bf16_f32 v148, v148, v148
    v_lshlrev_b32 v148, 16, v148
    v_add_f32 v148, 0x3727c5ac, v148
    v_cvt_pk_bf16_f32 v148, v148, v148
    v_lshlrev_b32 v148, 16, v148
    v_sqrt_f32 v148, v148
    s_nop 0
    v_cvt_pk_bf16_f32 v148, v148, v148
    v_lshlrev_b32 v148, 16, v148
    v_rcp_f32 v152, v148
    v_mul_f32 v149, 0x3a924925, v229
    v_cvt_pk_bf16_f32 v145, v145, v145
    v_lshlrev_b32 v145, 16, v145
    v_cvt_pk_bf16_f32 v149, v149, v149
    v_lshlrev_b32 v149, 16, v149
    v_add_f32 v149, 0x3727c5ac, v149
    v_cvt_pk_bf16_f32 v149, v149, v149
    v_lshlrev_b32 v149, 16, v149
    v_sqrt_f32 v149, v149
    s_nop 0
    v_cvt_pk_bf16_f32 v149, v149, v149
    v_lshlrev_b32 v149, 16, v149
    v_rcp_f32 v153, v149
    v_mul_f32 v150, 0x3a924925, v230
    v_cvt_pk_bf16_f32 v146, v146, v146
    v_lshlrev_b32 v146, 16, v146
    v_cvt_pk_bf16_f32 v150, v150, v150
    v_lshlrev_b32 v150, 16, v150
    v_add_f32 v150, 0x3727c5ac, v150
    v_cvt_pk_bf16_f32 v150, v150, v150
    v_lshlrev_b32 v150, 16, v150
    v_sqrt_f32 v150, v150
    s_nop 0
    v_cvt_pk_bf16_f32 v150, v150, v150
    v_lshlrev_b32 v150, 16, v150
    v_rcp_f32 v154, v150
    v_mul_f32 v151, 0x3a924925, v231
    v_cvt_pk_bf16_f32 v147, v147, v147
    v_lshlrev_b32 v147, 16, v147
    v_cvt_pk_bf16_f32 v151, v151, v151
    v_lshlrev_b32 v151, 16, v151
    v_add_f32 v151, 0x3727c5ac, v151
    v_cvt_pk_bf16_f32 v151, v151, v151
    v_lshlrev_b32 v151, 16, v151
    v_sqrt_f32 v151, v151
    s_nop 0
    v_cvt_pk_bf16_f32 v151, v151, v151
    v_lshlrev_b32 v151, 16, v151
    v_rcp_f32 v155, v151
    s_nop 0
    v_mul_u32_u24 v8, 224, v3
    v_add_u32 v8, v8, v1
    v_lshlrev_b32 v8, 12, v8
    v_lshlrev_b32 v9, 3, v2
    v_add_u32 v8, v8, v9
    v_add_u32 v8, s13, v8
    v_subrev_u32 v8, s13, v8
    s_lshl_b32 s16, s12, 1
    v_add_u32 v8, s16, v8
    v_sub_f32 v88, v88, v144
    v_sub_f32 v89, v89, v145
    v_sub_f32 v90, v90, v146
    v_sub_f32 v91, v91, v147
    v_cvt_pk_bf16_f32 v236, v88, v89
    v_lshlrev_b32 v88, 16, v236
    v_and_b32 v89, 0xffff0000, v236
    v_cvt_pk_bf16_f32 v236, v90, v91
    v_lshlrev_b32 v90, 16, v236
    v_and_b32 v91, 0xffff0000, v236
    v_mul_f32 v232, v88, v152
    v_mul_f32 v233, v89, v153
    v_mul_f32 v234, v90, v154
    v_mul_f32 v235, v91, v155
    v_fma_f32 v88, -v232, v148, v88
    v_fma_f32 v89, -v233, v149, v89
    v_fma_f32 v90, -v234, v150, v90
    v_fma_f32 v91, -v235, v151, v91
    v_fma_f32 v88, v88, v152, v232
    v_fma_f32 v89, v89, v153, v233
    v_fma_f32 v90, v90, v154, v234
    v_fma_f32 v91, v91, v155, v235
    v_cvt_pk_bf16_f32 v236, v88, v89
    v_cvt_pk_bf16_f32 v237, v90, v91
    buffer_store_dwordx2 v[236:237], v8, s[44:47], 0 offen
    v_add_u32 v8, 65536, v8
    s_nop 0
    v_sub_f32 v92, v92, v144
    v_sub_f32 v93, v93, v145
    v_sub_f32 v94, v94, v146
    v_sub_f32 v95, v95, v147
    v_cvt_pk_bf16_f32 v236, v92, v93
    v_lshlrev_b32 v92, 16, v236
    v_and_b32 v93, 0xffff0000, v236
    v_cvt_pk_bf16_f32 v236, v94, v95
    v_lshlrev_b32 v94, 16, v236
    v_and_b32 v95, 0xffff0000, v236
    v_mul_f32 v232, v92, v152
    v_mul_f32 v233, v93, v153
    v_mul_f32 v234, v94, v154
    v_mul_f32 v235, v95, v155
    v_fma_f32 v92, -v232, v148, v92
    v_fma_f32 v93, -v233, v149, v93
    v_fma_f32 v94, -v234, v150, v94
    v_fma_f32 v95, -v235, v151, v95
    v_fma_f32 v92, v92, v152, v232
    v_fma_f32 v93, v93, v153, v233
    v_fma_f32 v94, v94, v154, v234
    v_fma_f32 v95, v95, v155, v235
    v_cvt_pk_bf16_f32 v236, v92, v93
    v_cvt_pk_bf16_f32 v237, v94, v95
    buffer_store_dwordx2 v[236:237], v8, s[44:47], 0 offen
    v_add_u32 v8, 65536, v8
    s_nop 0
    v_sub_f32 v96, v96, v144
    v_sub_f32 v97, v97, v145
    v_sub_f32 v98, v98, v146
    v_sub_f32 v99, v99, v147
    v_cvt_pk_bf16_f32 v236, v96, v97
    v_lshlrev_b32 v96, 16, v236
    v_and_b32 v97, 0xffff0000, v236
    v_cvt_pk_bf16_f32 v236, v98, v99
    v_lshlrev_b32 v98, 16, v236
    v_and_b32 v99, 0xffff0000, v236
    v_mul_f32 v232, v96, v152
    v_mul_f32 v233, v97, v153
    v_mul_f32 v234, v98, v154
    v_mul_f32 v235, v99, v155
    v_fma_f32 v96, -v232, v148, v96
    v_fma_f32 v97, -v233, v149, v97
    v_fma_f32 v98, -v234, v150, v98
    v_fma_f32 v99, -v235, v151, v99
    v_fma_f32 v96, v96, v152, v232
    v_fma_f32 v97, v97, v153, v233
    v_fma_f32 v98, v98, v154, v234
    v_fma_f32 v99, v99, v155, v235
    v_cvt_pk_bf16_f32 v236, v96, v97
    v_cvt_pk_bf16_f32 v237, v98, v99
    buffer_store_dwordx2 v[236:237], v8, s[44:47], 0 offen
    v_add_u32 v8, 65536, v8
    s_nop 0
    v_sub_f32 v100, v100, v144
    v_sub_f32 v101, v101, v145
    v_sub_f32 v102, v102, v146
    v_sub_f32 v103, v103, v147
    v_cvt_pk_bf16_f32 v236, v100, v101
    v_lshlrev_b32 v100, 16, v236
    v_and_b32 v101, 0xffff0000, v236
    v_cvt_pk_bf16_f32 v236, v102, v103
    v_lshlrev_b32 v102, 16, v236
    v_and_b32 v103, 0xffff0000, v236
    v_mul_f32 v232, v100, v152
    v_mul_f32 v233, v101, v153
    v_mul_f32 v234, v102, v154
    v_mul_f32 v235, v103, v155
    v_fma_f32 v100, -v232, v148, v100
    v_fma_f32 v101, -v233, v149, v101
    v_fma_f32 v102, -v234, v150, v102
    v_fma_f32 v103, -v235, v151, v103
    v_fma_f32 v100, v100, v152, v232
    v_fma_f32 v101, v101, v153, v233
    v_fma_f32 v102, v102, v154, v234
    v_fma_f32 v103, v103, v155, v235
    v_cvt_pk_bf16_f32 v236, v100, v101
    v_cvt_pk_bf16_f32 v237, v102, v103
    buffer_store_dwordx2 v[236:237], v8, s[44:47], 0 offen
    v_add_u32 v8, 65536, v8
    s_nop 0
    v_sub_f32 v104, v104, v144
    v_sub_f32 v105, v105, v145
    v_sub_f32 v106, v106, v146
    v_sub_f32 v107, v107, v147
    v_cvt_pk_bf16_f32 v236, v104, v105
    v_lshlrev_b32 v104, 16, v236
    v_and_b32 v105, 0xffff0000, v236
    v_cvt_pk_bf16_f32 v236, v106, v107
    v_lshlrev_b32 v106, 16, v236
    v_and_b32 v107, 0xffff0000, v236
    v_mul_f32 v232, v104, v152
    v_mul_f32 v233, v105, v153
    v_mul_f32 v234, v106, v154
    v_mul_f32 v235, v107, v155
    v_fma_f32 v104, -v232, v148, v104
    v_fma_f32 v105, -v233, v149, v105
    v_fma_f32 v106, -v234, v150, v106
    v_fma_f32 v107, -v235, v151, v107
    v_fma_f32 v104, v104, v152, v232
    v_fma_f32 v105, v105, v153, v233
    v_fma_f32 v106, v106, v154, v234
    v_fma_f32 v107, v107, v155, v235
    v_cvt_pk_bf16_f32 v236, v104, v105
    v_cvt_pk_bf16_f32 v237, v106, v107
    buffer_store_dwordx2 v[236:237], v8, s[44:47], 0 offen
    v_add_u32 v8, 65536, v8
    s_nop 0
    v_sub_f32 v108, v108, v144
    v_sub_f32 v109, v109, v145
    v_sub_f32 v110, v110, v146
    v_sub_f32 v111, v111, v147
    v_cvt_pk_bf16_f32 v236, v108, v109
    v_lshlrev_b32 v108, 16, v236
    v_and_b32 v109, 0xffff0000, v236
    v_cvt_pk_bf16_f32 v236, v110, v111
    v_lshlrev_b32 v110, 16, v236
    v_and_b32 v111, 0xffff0000, v236
    v_mul_f32 v232, v108, v152
    v_mul_f32 v233, v109, v153
    v_mul_f32 v234, v110, v154
    v_mul_f32 v235, v111, v155
    v_fma_f32 v108, -v232, v148, v108
    v_fma_f32 v109, -v233, v149, v109
    v_fma_f32 v110, -v234, v150, v110
    v_fma_f32 v111, -v235, v151, v111
    v_fma_f32 v108, v108, v152, v232
    v_fma_f32 v109, v109, v153, v233
    v_fma_f32 v110, v110, v154, v234
    v_fma_f32 v111, v111, v155, v235
    v_cvt_pk_bf16_f32 v236, v108, v109
    v_cvt_pk_bf16_f32 v237, v110, v111
    buffer_store_dwordx2 v[236:237], v8, s[44:47], 0 offen
    v_add_u32 v8, 65536, v8
    s_nop 0
    v_sub_f32 v112, v112, v144
    v_sub_f32 v113, v113, v145
    v_sub_f32 v114, v114, v146
    v_sub_f32 v115, v115, v147
    v_cvt_pk_bf16_f32 v236, v112, v113
    v_lshlrev_b32 v112, 16, v236
    v_and_b32 v113, 0xffff0000, v236
    v_cvt_pk_bf16_f32 v236, v114, v115
    v_lshlrev_b32 v114, 16, v236
    v_and_b32 v115, 0xffff0000, v236
    v_mul_f32 v232, v112, v152
    v_mul_f32 v233, v113, v153
    v_mul_f32 v234, v114, v154
    v_mul_f32 v235, v115, v155
    v_fma_f32 v112, -v232, v148, v112
    v_fma_f32 v113, -v233, v149, v113
    v_fma_f32 v114, -v234, v150, v114
    v_fma_f32 v115, -v235, v151, v115
    v_fma_f32 v112, v112, v152, v232
    v_fma_f32 v113, v113, v153, v233
    v_fma_f32 v114, v114, v154, v234
    v_fma_f32 v115, v115, v155, v235
    v_cvt_pk_bf16_f32 v236, v112, v113
    v_cvt_pk_bf16_f32 v237, v114, v115
    buffer_store_dwordx2 v[236:237], v8, s[44:47], 0 offen
    v_add_u32 v8, 65536, v8
    s_nop 0
    v_sub_f32 v116, v116, v144
    v_sub_f32 v117, v117, v145
    v_sub_f32 v118, v118, v146
    v_sub_f32 v119, v119, v147
    v_cvt_pk_bf16_f32 v236, v116, v117
    v_lshlrev_b32 v116, 16, v236
    v_and_b32 v117, 0xffff0000, v236
    v_cvt_pk_bf16_f32 v236, v118, v119
    v_lshlrev_b32 v118, 16, v236
    v_and_b32 v119, 0xffff0000, v236
    v_mul_f32 v232, v116, v152
    v_mul_f32 v233, v117, v153
    v_mul_f32 v234, v118, v154
    v_mul_f32 v235, v119, v155
    v_fma_f32 v116, -v232, v148, v116
    v_fma_f32 v117, -v233, v149, v117
    v_fma_f32 v118, -v234, v150, v118
    v_fma_f32 v119, -v235, v151, v119
    v_fma_f32 v116, v116, v152, v232
    v_fma_f32 v117, v117, v153, v233
    v_fma_f32 v118, v118, v154, v234
    v_fma_f32 v119, v119, v155, v235
    v_cvt_pk_bf16_f32 v236, v116, v117
    v_cvt_pk_bf16_f32 v237, v118, v119
    buffer_store_dwordx2 v[236:237], v8, s[44:47], 0 offen
    v_add_u32 v8, 65536, v8
    s_nop 0
    v_sub_f32 v120, v120, v144
    v_sub_f32 v121, v121, v145
    v_sub_f32 v122, v122, v146
    v_sub_f32 v123, v123, v147
    v_cvt_pk_bf16_f32 v236, v120, v121
    v_lshlrev_b32 v120, 16, v236
    v_and_b32 v121, 0xffff0000, v236
    v_cvt_pk_bf16_f32 v236, v122, v123
    v_lshlrev_b32 v122, 16, v236
    v_and_b32 v123, 0xffff0000, v236
    v_mul_f32 v232, v120, v152
    v_mul_f32 v233, v121, v153
    v_mul_f32 v234, v122, v154
    v_mul_f32 v235, v123, v155
    v_fma_f32 v120, -v232, v148, v120
    v_fma_f32 v121, -v233, v149, v121
    v_fma_f32 v122, -v234, v150, v122
    v_fma_f32 v123, -v235, v151, v123
    v_fma_f32 v120, v120, v152, v232
    v_fma_f32 v121, v121, v153, v233
    v_fma_f32 v122, v122, v154, v234
    v_fma_f32 v123, v123, v155, v235
    v_cvt_pk_bf16_f32 v236, v120, v121
    v_cvt_pk_bf16_f32 v237, v122, v123
    buffer_store_dwordx2 v[236:237], v8, s[44:47], 0 offen
    v_add_u32 v8, 65536, v8
    s_nop 0
    v_sub_f32 v124, v124, v144
    v_sub_f32 v125, v125, v145
    v_sub_f32 v126, v126, v146
    v_sub_f32 v127, v127, v147
    v_cvt_pk_bf16_f32 v236, v124, v125
    v_lshlrev_b32 v124, 16, v236
    v_and_b32 v125, 0xffff0000, v236
    v_cvt_pk_bf16_f32 v236, v126, v127
    v_lshlrev_b32 v126, 16, v236
    v_and_b32 v127, 0xffff0000, v236
    v_mul_f32 v232, v124, v152
    v_mul_f32 v233, v125, v153
    v_mul_f32 v234, v126, v154
    v_mul_f32 v235, v127, v155
    v_fma_f32 v124, -v232, v148, v124
    v_fma_f32 v125, -v233, v149, v125
    v_fma_f32 v126, -v234, v150, v126
    v_fma_f32 v127, -v235, v151, v127
    v_fma_f32 v124, v124, v152, v232
    v_fma_f32 v125, v125, v153, v233
    v_fma_f32 v126, v126, v154, v234
    v_fma_f32 v127, v127, v155, v235
    v_cvt_pk_bf16_f32 v236, v124, v125
    v_cvt_pk_bf16_f32 v237, v126, v127
    buffer_store_dwordx2 v[236:237], v8, s[44:47], 0 offen
    v_add_u32 v8, 65536, v8
    s_nop 0
    v_sub_f32 v128, v128, v144
    v_sub_f32 v129, v129, v145
    v_sub_f32 v130, v130, v146
    v_sub_f32 v131, v131, v147
    v_cvt_pk_bf16_f32 v236, v128, v129
    v_lshlrev_b32 v128, 16, v236
    v_and_b32 v129, 0xffff0000, v236
    v_cvt_pk_bf16_f32 v236, v130, v131
    v_lshlrev_b32 v130, 16, v236
    v_and_b32 v131, 0xffff0000, v236
    v_mul_f32 v232, v128, v152
    v_mul_f32 v233, v129, v153
    v_mul_f32 v234, v130, v154
    v_mul_f32 v235, v131, v155
    v_fma_f32 v128, -v232, v148, v128
    v_fma_f32 v129, -v233, v149, v129
    v_fma_f32 v130, -v234, v150, v130
    v_fma_f32 v131, -v235, v151, v131
    v_fma_f32 v128, v128, v152, v232
    v_fma_f32 v129, v129, v153, v233
    v_fma_f32 v130, v130, v154, v234
    v_fma_f32 v131, v131, v155, v235
    v_cvt_pk_bf16_f32 v236, v128, v129
    v_cvt_pk_bf16_f32 v237, v130, v131
    buffer_store_dwordx2 v[236:237], v8, s[44:47], 0 offen
    v_add_u32 v8, 65536, v8
    s_nop 0
    v_sub_f32 v132, v132, v144
    v_sub_f32 v133, v133, v145
    v_sub_f32 v134, v134, v146
    v_sub_f32 v135, v135, v147
    v_cvt_pk_bf16_f32 v236, v132, v133
    v_lshlrev_b32 v132, 16, v236
    v_and_b32 v133, 0xffff0000, v236
    v_cvt_pk_bf16_f32 v236, v134, v135
    v_lshlrev_b32 v134, 16, v236
    v_and_b32 v135, 0xffff0000, v236
    v_mul_f32 v232, v132, v152
    v_mul_f32 v233, v133, v153
    v_mul_f32 v234, v134, v154
    v_mul_f32 v235, v135, v155
    v_fma_f32 v132, -v232, v148, v132
    v_fma_f32 v133, -v233, v149, v133
    v_fma_f32 v134, -v234, v150, v134
    v_fma_f32 v135, -v235, v151, v135
    v_fma_f32 v132, v132, v152, v232
    v_fma_f32 v133, v133, v153, v233
    v_fma_f32 v134, v134, v154, v234
    v_fma_f32 v135, v135, v155, v235
    v_cvt_pk_bf16_f32 v236, v132, v133
    v_cvt_pk_bf16_f32 v237, v134, v135
    buffer_store_dwordx2 v[236:237], v8, s[44:47], 0 offen
    v_add_u32 v8, 65536, v8
    s_nop 0
    v_sub_f32 v136, v136, v144
    v_sub_f32 v137, v137, v145
    v_sub_f32 v138, v138, v146
    v_sub_f32 v139, v139, v147
    v_cvt_pk_bf16_f32 v236, v136, v137
    v_lshlrev_b32 v136, 16, v236
    v_and_b32 v137, 0xffff0000, v236
    v_cvt_pk_bf16_f32 v236, v138, v139
    v_lshlrev_b32 v138, 16, v236
    v_and_b32 v139, 0xffff0000, v236
    v_mul_f32 v232, v136, v152
    v_mul_f32 v233, v137, v153
    v_mul_f32 v234, v138, v154
    v_mul_f32 v235, v139, v155
    v_fma_f32 v136, -v232, v148, v136
    v_fma_f32 v137, -v233, v149, v137
    v_fma_f32 v138, -v234, v150, v138
    v_fma_f32 v139, -v235, v151, v139
    v_fma_f32 v136, v136, v152, v232
    v_fma_f32 v137, v137, v153, v233
    v_fma_f32 v138, v138, v154, v234
    v_fma_f32 v139, v139, v155, v235
    v_cvt_pk_bf16_f32 v236, v136, v137
    v_cvt_pk_bf16_f32 v237, v138, v139
    buffer_store_dwordx2 v[236:237], v8, s[44:47], 0 offen
    v_add_u32 v8, 65536, v8
    s_nop 0
    v_sub_f32 v140, v140, v144
    v_sub_f32 v141, v141, v145
    v_sub_f32 v142, v142, v146
    v_sub_f32 v143, v143, v147
    v_cvt_pk_bf16_f32 v236, v140, v141
    v_lshlrev_b32 v140, 16, v236
    v_and_b32 v141, 0xffff0000, v236
    v_cvt_pk_bf16_f32 v236, v142, v143
    v_lshlrev_b32 v142, 16, v236
    v_and_b32 v143, 0xffff0000, v236
    v_mul_f32 v232, v140, v152
    v_mul_f32 v233, v141, v153
    v_mul_f32 v234, v142, v154
    v_mul_f32 v235, v143, v155
    v_fma_f32 v140, -v232, v148, v140
    v_fma_f32 v141, -v233, v149, v141
    v_fma_f32 v142, -v234, v150, v142
    v_fma_f32 v143, -v235, v151, v143
    v_fma_f32 v140, v140, v152, v232
    v_fma_f32 v141, v141, v153, v233
    v_fma_f32 v142, v142, v154, v234
    v_fma_f32 v143, v143, v155, v235
    v_cvt_pk_bf16_f32 v236, v140, v141
    v_cvt_pk_bf16_f32 v237, v142, v143
    buffer_store_dwordx2 v[236:237], v8, s[44:47], 0 offen
    s_nop 0
K2_end_8:
    s_endpgm
.globl spat_kernel
.p2align 8
.type spat_kernel,@function
spat_kernel:
    s_cmp_ge_u32 s2, 224
    s_cbranch_scc1 K3_end_15
    s_load_dwordx2 s[4:5], s[0:1], 64
    s_load_dwordx2 s[6:7], s[0:1], 72
    s_load_dwordx2 s[8:9], s[0:1], 120
    s_waitcnt lgkmcnt(0)
    s_add_u32 s20, s8, 14745600
    s_addc_u32 s21, s9, 0
    s_mov_b32 s22, 3670016
    s_mov_b32 s23, 0x00020000
    s_mov_b32 s24, s4
    s_mov_b32 s25, s5
    s_mov_b32 s26, 8388608
    s_mov_b32 s27, 0x00020000
    s_mov_b32 s28, s6
    s_mov_b32 s29, s7
    s_mov_b32 s30, 4096
    s_mov_b32 s31, 0x00020000
    s_add_u32 s32, s8, 10551296
    s_addc_u32 s33, s9, 0
    s_mov_b32 s34, 3670016
    s_mov_b32 s35, 0x00020000
    s_add_u32 s36, s8, 18939904
    s_addc_u32 s37, s9, 0
    s_mov_b32 s38, 3670016
    s_mov_b32 s39, 0x00020000
    s_lshr_b32 s14, s2, 3
    s_mul_hi_u32 s10, s14, 0x24924925
    s_mul_i32 s11, s10, 7
    s_sub_u32 s11, s14, s11
    s_and_b32 s14, s2, 7
    s_lshl_b32 s14, s14, 2
    s_add_u32 s10, s10, s14
    s_mul_i32 s60, s11, 524288
    s_mul_i32 s61, s10, 262144
    v_lshrrev_b32 v1, 3, v0
    v_and_b32 v2, 7, v0
    v_mul_u32_u24 v3, 4096, v1
    v_lshlrev_b32 v4, 4, v2
    v_add_u32 v3, v3, v4
    v_mul_u32_u24 v5, 4096, v1
    v_add_u32 v5, v5, v4
    v_xor_b32 v6, v2, v1
    v_and_b32 v6, 7, v6
    v_lshlrev_b32 v6, 4, v6
    v_lshlrev_b32 v7, 7, v1
    v_add_u32 v6, v6, v7
    v_add_u32 v19, 16384, v6
    v_and_b32 v8, 15, v0
    v_lshrrev_b32 v9, 4, v0
    v_and_b32 v9, 3, v9
    v_lshrrev_b32 v10, 6, v0
    v_lshrrev_b32 v11, 1, v10
    v_and_b32 v12, 1, v10
    v_and_b32 v13, 7, v8
    v_xor_b32 v13, v13, v9
    v_lshlrev_b32 v13, 4, v13
    v_mul_u32_u24 v14, 8192, v11
    v_lshlrev_b32 v15, 7, v8
    v_add_u32 v14, v14, v15
    v_add_u32 v14, v14, v13
    v_xor_b32 v16, 64, v14
    v_mul_u32_u24 v17, 4096, v12
    v_add_u32 v17, v17, v15
    v_add_u32 v17, v17, v13
    v_add_u32 v17, 16384, v17
    v_xor_b32 v18, 64, v17
    v_mov_b32 v128, 0
    v_mov_b32 v129, 0
    v_mov_b32 v130, 0
    v_mov_b32 v131, 0
    v_mov_b32 v132, 0
    v_mov_b32 v133, 0
    v_mov_b32 v134, 0
    v_mov_b32 v135, 0
    v_mov_b32 v136, 0
    v_mov_b32 v137, 0
    v_mov_b32 v138, 0
    v_mov_b32 v139, 0
    v_mov_b32 v140, 0
    v_mov_b32 v141, 0
    v_mov_b32 v142, 0
    v_mov_b32 v143, 0
    v_mov_b32 v144, 0
    v_mov_b32 v145, 0
    v_mov_b32 v146, 0
    v_mov_b32 v147, 0
    v_mov_b32 v148, 0
    v_mov_b32 v149, 0
    v_mov_b32 v150, 0
    v_mov_b32 v151, 0
    v_mov_b32 v152, 0
    v_mov_b32 v153, 0
    v_mov_b32 v154, 0
    v_mov_b32 v155, 0
    v_mov_b32 v156, 0
    v_mov_b32 v157, 0
    v_mov_b32 v158, 0
    v_mov_b32 v159, 0
    buffer_load_dwordx4 a[0:3], v3, s[20:23], s60 offen
    v_add_u32 v3, 131072, v3
    buffer_load_dwordx4 a[4:7], v3, s[20:23], s60 offen
    v_add_u32 v3, 131072, v3
    buffer_load_dwordx4 a[8:11], v3, s[20:23], s60 offen
    v_add_u32 v3, 131072, v3
    buffer_load_dwordx4 a[12:15], v3, s[20:23], s60 offen
    v_subrev_u32 v3, 393216, v3
    buffer_load_dwordx4 a[16:19], v5, s[24:27], s61 offen
    v_add_u32 v5, 131072, v5
    buffer_load_dwordx4 a[20:23], v5, s[24:27], s61 offen
    v_subrev_u32 v5, 131072, v5
    s_add_u32 s60, s60, 128
    s_add_u32 s61, s61, 128
    buffer_load_dwordx4 a[24:27], v3, s[20:23], s60 offen
    v_add_u32 v3, 131072, v3
    buffer_load_dwordx4 a[28:31], v3, s[20:23], s60 offen
    v_add_u32 v3, 131072, v3
    buffer_load_dwordx4 a[32:35], v3, s[20:23], s60 offen
    v_add_u32 v3, 131072, v3
    buffer_load_dwordx4 a[36:39], v3, s[20:23], s60 offen
    v_subrev_u32 v3, 393216, v3
    buffer_load_dwordx4 a[40:43], v5, s[24:27], s61 offen
    v_add_u32 v5, 131072, v5
    buffer_load_dwordx4 a[44:47], v5, s[24:27], s61 offen
    v_subrev_u32 v5, 131072, v5
    s_add_u32 s60, s60, 128
    s_add_u32 s61, s61, 128
    buffer_load_dwordx4 a[48:51], v3, s[20:23], s60 offen
    v_add_u32 v3, 131072, v3
    buffer_load_dwordx4 a[52:55], v3, s[20:23], s60 offen
    v_add_u32 v3, 131072, v3
    buffer_load_dwordx4 a[56:59], v3, s[20:23], s60 offen
    v_add_u32 v3, 131072, v3
    buffer_load_dwordx4 a[60:63], v3, s[20:23], s60 offen
    v_subrev_u32 v3, 393216, v3
    buffer_load_dwordx4 a[64:67], v5, s[24:27], s61 offen
    v_add_u32 v5, 131072, v5
    buffer_load_dwordx4 a[68:71], v5, s[24:27], s61 offen
    v_subrev_u32 v5, 131072, v5
    s_add_u32 s60, s60, 128
    s_add_u32 s61, s61, 128
    buffer_load_dwordx4 a[72:75], v3, s[20:23], s60 offen
    v_add_u32 v3, 131072, v3
    buffer_load_dwordx4 a[76:79], v3, s[20:23], s60 offen
    v_add_u32 v3, 131072, v3
    buffer_load_dwordx4 a[80:83], v3, s[20:23], s60 offen
    v_add_u32 v3, 131072, v3
    buffer_load_dwordx4 a[84:87], v3, s[20:23], s60 offen
    v_subrev_u32 v3, 393216, v3
    buffer_load_dwordx4 a[88:91], v5, s[24:27], s61 offen
    v_add_u32 v5, 131072, v5
    buffer_load_dwordx4 a[92:95], v5, s[24:27], s61 offen
    v_subrev_u32 v5, 131072, v5
    s_add_u32 s60, s60, 128
    s_add_u32 s61, s61, 128
    s_waitcnt vmcnt(12)
    ds_write_b128 v6, a[0:3] offset:0
    ds_write_b128 v6, a[4:7] offset:4096
    ds_write_b128 v6, a[8:11] offset:8192
    ds_write_b128 v6, a[12:15] offset:12288
    ds_write_b128 v19, a[16:19] offset:0
    ds_write_b128 v19, a[20:23] offset:4096
    ds_write_b128 v6, a[24:27] offset:24576
    ds_write_b128 v6, a[28:31] offset:28672
    ds_write_b128 v6, a[32:35] offset:32768
    ds_write_b128 v6, a[36:39] offset:36864
    ds_write_b128 v19, a[40:43] offset:24576
    ds_write_b128 v19, a[44:47] offset:28672
    s_waitcnt lgkmcnt(0)
    s_barrier
    ds_read_b128 v[32:35], v14 offset:0
    ds_read_b128 v[36:39], v14 offset:2048
    ds_read_b128 v[40:43], v14 offset:4096
    ds_read_b128 v[44:47], v14 offset:6144
    ds_read_b128 v[64:67], v17 offset:0
    ds_read_b128 v[68:71], v17 offset:2048
    ds_read_b128 v[48:51], v16 offset:0
    ds_read_b128 v[52:55], v16 offset:2048
    ds_read_b128 v[56:59], v16 offset:4096
    ds_read_b128 v[60:63], v16 offset:6144
    ds_read_b128 v[72:75], v18 offset:0
    ds_read_b128 v[76:79], v18 offset:2048
    buffer_load_dwordx4 a[0:3], v3, s[20:23], s60 offen
    v_add_u32 v3, 131072, v3
    buffer_load_dwordx4 a[4:7], v3, s[20:23], s60 offen
    v_add_u32 v3, 131072, v3
    buffer_load_dwordx4 a[8:11], v3, s[20:23], s60 offen
    v_add_u32 v3, 131072, v3
    buffer_load_dwordx4 a[12:15], v3, s[20:23], s60 offen
    v_subrev_u32 v3, 393216, v3
    buffer_load_dwordx4 a[16:19], v5, s[24:27], s61 offen
    v_add_u32 v5, 131072, v5
    buffer_load_dwordx4 a[20:23], v5, s[24:27], s61 offen
    v_subrev_u32 v5, 131072, v5
    s_add_u32 s60, s60, 128
    s_add_u32 s61, s61, 128
    s_waitcnt vmcnt(12) lgkmcnt(6)
    ds_write_b128 v6, a[48:51] offset:49152
    ds_write_b128 v6, a[52:55] offset:53248
    ds_write_b128 v6, a[56:59] offset:57344
    ds_write_b128 v6, a[60:63] offset:61440
    ds_write_b128 v19, a[64:67] offset:49152
    ds_write_b128 v19, a[68:71] offset:53248
    v_mfma_f32_16x16x32_bf16 v[128:131], v[32:35], v[64:67], v[128:131]
    v_mfma_f32_16x16x32_bf16 v[132:135], v[32:35], v[68:71], v[132:135]
    v_mfma_f32_16x16x32_bf16 v[136:139], v[36:39], v[64:67], v[136:139]
    v_mfma_f32_16x16x32_bf16 v[140:143], v[36:39], v[68:71], v[140:143]
    v_mfma_f32_16x16x32_bf16 v[144:147], v[40:43], v[64:67], v[144:147]
    v_mfma_f32_16x16x32_bf16 v[148:151], v[40:43], v[68:71], v[148:151]
    v_mfma_f32_16x16x32_bf16 v[152:155], v[44:47], v[64:67], v[152:155]
    v_mfma_f32_16x16x32_bf16 v[156:159], v[44:47], v[68:71], v[156:159]
    ds_read_b128 v[32:35], v14 offset:24576
    ds_read_b128 v[36:39], v14 offset:26624
    ds_read_b128 v[40:43], v14 offset:28672
    ds_read_b128 v[44:47], v14 offset:30720
    ds_read_b128 v[64:67], v17 offset:24576
    ds_read_b128 v[68:71], v17 offset:26624
    s_waitcnt lgkmcnt(12)
    v_mfma_f32_16x16x32_bf16 v[128:131], v[48:51], v[72:75], v[128:131]
    v_mfma_f32_16x16x32_bf16 v[132:135], v[48:51], v[76:79], v[132:135]
    v_mfma_f32_16x16x32_bf16 v[136:139], v[52:55], v[72:75], v[136:139]
    v_mfma_f32_16x16x32_bf16 v[140:143], v[52:55], v[76:79], v[140:143]
    v_mfma_f32_16x16x32_bf16 v[144:147], v[56:59], v[72:75], v[144:147]
    v_mfma_f32_16x16x32_bf16 v[148:151], v[56:59], v[76:79], v[148:151]
    v_mfma_f32_16x16x32_bf16 v[152:155], v[60:63], v[72:75], v[152:155]
    v_mfma_f32_16x16x32_bf16 v[156:159], v[60:63], v[76:79], v[156:159]
    s_waitcnt lgkmcnt(6)
    s_barrier
    ds_read_b128 v[48:51], v16 offset:24576
    ds_read_b128 v[52:55], v16 offset:26624
    ds_read_b128 v[56:59], v16 offset:28672
    ds_read_b128 v[60:63], v16 offset:30720
    ds_read_b128 v[72:75], v18 offset:24576
    ds_read_b128 v[76:79], v18 offset:26624
    buffer_load_dwordx4 a[24:27], v3, s[20:23], s60 offen
    v_add_u32 v3, 131072, v3
    buffer_load_dwordx4 a[28:31], v3, s[20:23], s60 offen
    v_add_u32 v3, 131072, v3
    buffer_load_dwordx4 a[32:35], v3, s[20:23], s60 offen
    v_add_u32 v3, 131072, v3
    buffer_load_dwordx4 a[36:39], v3, s[20:23], s60 offen
    v_subrev_u32 v3, 393216, v3
    buffer_load_dwordx4 a[40:43], v5, s[24:27], s61 offen
    v_add_u32 v5, 131072, v5
    buffer_load_dwordx4 a[44:47], v5, s[24:27], s61 offen
    v_subrev_u32 v5, 131072, v5
    s_add_u32 s60, s60, 128
    s_add_u32 s61, s61, 128
    s_waitcnt vmcnt(12) lgkmcnt(6)
    ds_write_b128 v6, a[72:75] offset:0
    ds_write_b128 v6, a[76:79] offset:4096
    ds_write_b128 v6, a[80:83] offset:8192
    ds_write_b128 v6, a[84:87] offset:12288
    ds_write_b128 v19, a[88:91] offset:0
    ds_write_b128 v19, a[92:95] offset:4096
    v_mfma_f32_16x16x32_bf16 v[128:131], v[32:35], v[64:67], v[128:131]
    v_mfma_f32_16x16x32_bf16 v[132:135], v[32:35], v[68:71], v[132:135]
    v_mfma_f32_16x16x32_bf16 v[136:139], v[36:39], v[64:67], v[136:139]
    v_mfma_f32_16x16x32_bf16 v[140:143], v[36:39], v[68:71], v[140:143]
    v_mfma_f32_16x16x32_bf16 v[144:147], v[40:43], v[64:67], v[144:147]
    v_mfma_f32_16x16x32_bf16 v[148:151], v[40:43], v[68:71], v[148:151]
    v_mfma_f32_16x16x32_bf16 v[152:155], v[44:47], v[64:67], v[152:155]
    v_mfma_f32_16x16x32_bf16 v[156:159], v[44:47], v[68:71], v[156:159]
    ds_read_b128 v[32:35], v14 offset:49152
    ds_read_b128 v[36:39], v14 offset:51200
    ds_read_b128 v[40:43], v14 offset:53248
    ds_read_b128 v[44:47], v14 offset:55296
    ds_read_b128 v[64:67], v17 offset:49152
    ds_read_b128 v[68:71], v17 offset:51200
    s_waitcnt lgkmcnt(12)
    v_mfma_f32_16x16x32_bf16 v[128:131], v[48:51], v[72:75], v[128:131]
    v_mfma_f32_16x16x32_bf16 v[132:135], v[48:51], v[76:79], v[132:135]
    v_mfma_f32_16x16x32_bf16 v[136:139], v[52:55], v[72:75], v[136:139]
    v_mfma_f32_16x16x32_bf16 v[140:143], v[52:55], v[76:79], v[140:143]
    v_mfma_f32_16x16x32_bf16 v[144:147], v[56:59], v[72:75], v[144:147]
    v_mfma_f32_16x16x32_bf16 v[148:151], v[56:59], v[76:79], v[148:151]
    v_mfma_f32_16x16x32_bf16 v[152:155], v[60:63], v[72:75], v[152:155]
    v_mfma_f32_16x16x32_bf16 v[156:159], v[60:63], v[76:79], v[156:159]
    s_waitcnt lgkmcnt(6)
    s_barrier
    ds_read_b128 v[48:51], v16 offset:49152
    ds_read_b128 v[52:55], v16 offset:51200
    ds_read_b128 v[56:59], v16 offset:53248
    ds_read_b128 v[60:63], v16 offset:55296
    ds_read_b128 v[72:75], v18 offset:49152
    ds_read_b128 v[76:79], v18 offset:51200
    buffer_load_dwordx4 a[48:51], v3, s[20:23], s60 offen
    v_add_u32 v3, 131072, v3
    buffer_load_dwordx4 a[52:55], v3, s[20:23], s60 offen
    v_add_u32 v3, 131072, v3
    buffer_load_dwordx4 a[56:59], v3, s[20:23], s60 offen
    v_add_u32 v3, 131072, v3
    buffer_load_dwordx4 a[60:63], v3, s[20:23], s60 offen
    v_subrev_u32 v3, 393216, v3
    buffer_load_dwordx4 a[64:67], v5, s[24:27], s61 offen
    v_add_u32 v5, 131072, v5
    buffer_load_dwordx4 a[68:71], v5, s[24:27], s61 offen
    v_subrev_u32 v5, 131072, v5
    s_add_u32 s60, s60, 128
    s_add_u32 s61, s61, 128
    s_waitcnt vmcnt(12) lgkmcnt(6)
    ds_write_b128 v6, a[0:3] offset:24576
    ds_write_b128 v6, a[4:7] offset:28672
    ds_write_b128 v6, a[8:11] offset:32768
    ds_write_b128 v6, a[12:15] offset:36864
    ds_write_b128 v19, a[16:19] offset:24576
    ds_write_b128 v19, a[20:23] offset:28672
    v_mfma_f32_16x16x32_bf16 v[128:131], v[32:35], v[64:67], v[128:131]
    v_mfma_f32_16x16x32_bf16 v[132:135], v[32:35], v[68:71], v[132:135]
    v_mfma_f32_16x16x32_bf16 v[136:139], v[36:39], v[64:67], v[136:139]
    v_mfma_f32_16x16x32_bf16 v[140:143], v[36:39], v[68:71], v[140:143]
    v_mfma_f32_16x16x32_bf16 v[144:147], v[40:43], v[64:67], v[144:147]
    v_mfma_f32_16x16x32_bf16 v[148:151], v[40:43], v[68:71], v[148:151]
    v_mfma_f32_16x16x32_bf16 v[152:155], v[44:47], v[64:67], v[152:155]
    v_mfma_f32_16x16x32_bf16 v[156:159], v[44:47], v[68:71], v[156:159]
    ds_read_b128 v[32:35], v14 offset:0
    ds_read_b128 v[36:39], v14 offset:2048
    ds_read_b128 v[40:43], v14 offset:4096
    ds_read_b128 v[44:47], v14 offset:6144
    ds_read_b128 v[64:67], v17 offset:0
    ds_read_b128 v[68:71], v17 offset:2048
    s_waitcnt lgkmcnt(12)
    v_mfma_f32_16x16x32_bf16 v[128:131], v[48:51], v[72:75], v[128:131]
    v_mfma_f32_16x16x32_bf16 v[132:135], v[48:51], v[76:79], v[132:135]
    v_mfma_f32_16x16x32_bf16 v[136:139], v[52:55], v[72:75], v[136:139]
    v_mfma_f32_16x16x32_bf16 v[140:143], v[52:55], v[76:79], v[140:143]
    v_mfma_f32_16x16x32_bf16 v[144:147], v[56:59], v[72:75], v[144:147]
    v_mfma_f32_16x16x32_bf16 v[148:151], v[56:59], v[76:79], v[148:151]
    v_mfma_f32_16x16x32_bf16 v[152:155], v[60:63], v[72:75], v[152:155]
    v_mfma_f32_16x16x32_bf16 v[156:159], v[60:63], v[76:79], v[156:159]
    s_waitcnt lgkmcnt(6)
    s_barrier
    ds_read_b128 v[48:51], v16 offset:0
    ds_read_b128 v[52:55], v16 offset:2048
    ds_read_b128 v[56:59], v16 offset:4096
    ds_read_b128 v[60:63], v16 offset:6144
    ds_read_b128 v[72:75], v18 offset:0
    ds_read_b128 v[76:79], v18 offset:2048
    buffer_load_dwordx4 a[72:75], v3, s[20:23], s60 offen
    v_add_u32 v3, 131072, v3
    buffer_load_dwordx4 a[76:79], v3, s[20:23], s60 offen
    v_add_u32 v3, 131072, v3
    buffer_load_dwordx4 a[80:83], v3, s[20:23], s60 offen
    v_add_u32 v3, 131072, v3
    buffer_load_dwordx4 a[84:87], v3, s[20:23], s60 offen
    v_subrev_u32 v3, 393216, v3
    buffer_load_dwordx4 a[88:91], v5, s[24:27], s61 offen
    v_add_u32 v5, 131072, v5
    buffer_load_dwordx4 a[92:95], v5, s[24:27], s61 offen
    v_subrev_u32 v5, 131072, v5
    s_add_u32 s60, s60, 128
    s_add_u32 s61, s61, 128
    s_waitcnt vmcnt(12) lgkmcnt(6)
    ds_write_b128 v6, a[24:27] offset:49152
    ds_write_b128 v6, a[28:31] offset:53248
    ds_write_b128 v6, a[32:35] offset:57344
    ds_write_b128 v6, a[36:39] offset:61440
    ds_write_b128 v19, a[40:43] offset:49152
    ds_write_b128 v19, a[44:47] offset:53248
    v_mfma_f32_16x16x32_bf16 v[128:131], v[32:35], v[64:67], v[128:131]
    v_mfma_f32_16x16x32_bf16 v[132:135], v[32:35], v[68:71], v[132:135]
    v_mfma_f32_16x16x32_bf16 v[136:139], v[36:39], v[64:67], v[136:139]
    v_mfma_f32_16x16x32_bf16 v[140:143], v[36:39], v[68:71], v[140:143]
    v_mfma_f32_16x16x32_bf16 v[144:147], v[40:43], v[64:67], v[144:147]
    v_mfma_f32_16x16x32_bf16 v[148:151], v[40:43], v[68:71], v[148:151]
    v_mfma_f32_16x16x32_bf16 v[152:155], v[44:47], v[64:67], v[152:155]
    v_mfma_f32_16x16x32_bf16 v[156:159], v[44:47], v[68:71], v[156:159]
    ds_read_b128 v[32:35], v14 offset:24576
    ds_read_b128 v[36:39], v14 offset:26624
    ds_read_b128 v[40:43], v14 offset:28672
    ds_read_b128 v[44:47], v14 offset:30720
    ds_read_b128 v[64:67], v17 offset:24576
    ds_read_b128 v[68:71], v17 offset:26624
    s_waitcnt lgkmcnt(12)
    v_mfma_f32_16x16x32_bf16 v[128:131], v[48:51], v[72:75], v[128:131]
    v_mfma_f32_16x16x32_bf16 v[132:135], v[48:51], v[76:79], v[132:135]
    v_mfma_f32_16x16x32_bf16 v[136:139], v[52:55], v[72:75], v[136:139]
    v_mfma_f32_16x16x32_bf16 v[140:143], v[52:55], v[76:79], v[140:143]
    v_mfma_f32_16x16x32_bf16 v[144:147], v[56:59], v[72:75], v[144:147]
    v_mfma_f32_16x16x32_bf16 v[148:151], v[56:59], v[76:79], v[148:151]
    v_mfma_f32_16x16x32_bf16 v[152:155], v[60:63], v[72:75], v[152:155]
    v_mfma_f32_16x16x32_bf16 v[156:159], v[60:63], v[76:79], v[156:159]
    s_waitcnt lgkmcnt(6)
    s_barrier
    ds_read_b128 v[48:51], v16 offset:24576
    ds_read_b128 v[52:55], v16 offset:26624
    ds_read_b128 v[56:59], v16 offset:28672
    ds_read_b128 v[60:63], v16 offset:30720
    ds_read_b128 v[72:75], v18 offset:24576
    ds_read_b128 v[76:79], v18 offset:26624
    buffer_load_dwordx4 a[0:3], v3, s[20:23], s60 offen
    v_add_u32 v3, 131072, v3
    buffer_load_dwordx4 a[4:7], v3, s[20:23], s60 offen
    v_add_u32 v3, 131072, v3
    buffer_load_dwordx4 a[8:11], v3, s[20:23], s60 offen
    v_add_u32 v3, 131072, v3
    buffer_load_dwordx4 a[12:15], v3, s[20:23], s60 offen
    v_subrev_u32 v3, 393216, v3
    buffer_load_dwordx4 a[16:19], v5, s[24:27], s61 offen
    v_add_u32 v5, 131072, v5
    buffer_load_dwordx4 a[20:23], v5, s[24:27], s61 offen
    v_subrev_u32 v5, 131072, v5
    s_add_u32 s60, s60, 128
    s_add_u32 s61, s61, 128
    s_waitcnt vmcnt(12) lgkmcnt(6)
    ds_write_b128 v6, a[48:51] offset:0
    ds_write_b128 v6, a[52:55] offset:4096
    ds_write_b128 v6, a[56:59] offset:8192
    ds_write_b128 v6, a[60:63] offset:12288
    ds_write_b128 v19, a[64:67] offset:0
    ds_write_b128 v19, a[68:71] offset:4096
    v_mfma_f32_16x16x32_bf16 v[128:131], v[32:35], v[64:67], v[128:131]
    v_mfma_f32_16x16x32_bf16 v[132:135], v[32:35], v[68:71], v[132:135]
    v_mfma_f32_16x16x32_bf16 v[136:139], v[36:39], v[64:67], v[136:139]
    v_mfma_f32_16x16x32_bf16 v[140:143], v[36:39], v[68:71], v[140:143]
    v_mfma_f32_16x16x32_bf16 v[144:147], v[40:43], v[64:67], v[144:147]
    v_mfma_f32_16x16x32_bf16 v[148:151], v[40:43], v[68:71], v[148:151]
    v_mfma_f32_16x16x32_bf16 v[152:155], v[44:47], v[64:67], v[152:155]
    v_mfma_f32_16x16x32_bf16 v[156:159], v[44:47], v[68:71], v[156:159]
    ds_read_b128 v[32:35], v14 offset:49152
    ds_read_b128 v[36:39], v14 offset:51200
    ds_read_b128 v[40:43], v14 offset:53248
    ds_read_b128 v[44:47], v14 offset:55296
    ds_read_b128 v[64:67], v17 offset:49152
    ds_read_b128 v[68:71], v17 offset:51200
    s_waitcnt lgkmcnt(12)
    v_mfma_f32_16x16x32_bf16 v[128:131], v[48:51], v[72:75], v[128:131]
    v_mfma_f32_16x16x32_bf16 v[132:135], v[48:51], v[76:79], v[132:135]
    v_mfma_f32_16x16x32_bf16 v[136:139], v[52:55], v[72:75], v[136:139]
    v_mfma_f32_16x16x32_bf16 v[140:143], v[52:55], v[76:79], v[140:143]
    v_mfma_f32_16x16x32_bf16 v[144:147], v[56:59], v[72:75], v[144:147]
    v_mfma_f32_16x16x32_bf16 v[148:151], v[56:59], v[76:79], v[148:151]
    v_mfma_f32_16x16x32_bf16 v[152:155], v[60:63], v[72:75], v[152:155]
    v_mfma_f32_16x16x32_bf16 v[156:159], v[60:63], v[76:79], v[156:159]
    s_waitcnt lgkmcnt(6)
    s_barrier
    ds_read_b128 v[48:51], v16 offset:49152
    ds_read_b128 v[52:55], v16 offset:51200
    ds_read_b128 v[56:59], v16 offset:53248
    ds_read_b128 v[60:63], v16 offset:55296
    ds_read_b128 v[72:75], v18 offset:49152
    ds_read_b128 v[76:79], v18 offset:51200
    buffer_load_dwordx4 a[24:27], v3, s[20:23], s60 offen
    v_add_u32 v3, 131072, v3
    buffer_load_dwordx4 a[28:31], v3, s[20:23], s60 offen
    v_add_u32 v3, 131072, v3
    buffer_load_dwordx4 a[32:35], v3, s[20:23], s60 offen
    v_add_u32 v3, 131072, v3
    buffer_load_dwordx4 a[36:39], v3, s[20:23], s60 offen
    v_subrev_u32 v3, 393216, v3
    buffer_load_dwordx4 a[40:43], v5, s[24:27], s61 offen
    v_add_u32 v5, 131072, v5
    buffer_load_dwordx4 a[44:47], v5, s[24:27], s61 offen
    v_subrev_u32 v5, 131072, v5
    s_add_u32 s60, s60, 128
    s_add_u32 s61, s61, 128
    s_waitcnt vmcnt(12) lgkmcnt(6)
    ds_write_b128 v6, a[72:75] offset:24576
    ds_write_b128 v6, a[76:79] offset:28672
    ds_write_b128 v6, a[80:83] offset:32768
    ds_write_b128 v6, a[84:87] offset:36864
    ds_write_b128 v19, a[88:91] offset:24576
    ds_write_b128 v19, a[92:95] offset:28672
    v_mfma_f32_16x16x32_bf16 v[128:131], v[32:35], v[64:67], v[128:131]
    v_mfma_f32_16x16x32_bf16 v[132:135], v[32:35], v[68:71], v[132:135]
    v_mfma_f32_16x16x32_bf16 v[136:139], v[36:39], v[64:67], v[136:139]
    v_mfma_f32_16x16x32_bf16 v[140:143], v[36:39], v[68:71], v[140:143]
    v_mfma_f32_16x16x32_bf16 v[144:147], v[40:43], v[64:67], v[144:147]
    v_mfma_f32_16x16x32_bf16 v[148:151], v[40:43], v[68:71], v[148:151]
    v_mfma_f32_16x16x32_bf16 v[152:155], v[44:47], v[64:67], v[152:155]
    v_mfma_f32_16x16x32_bf16 v[156:159], v[44:47], v[68:71], v[156:159]
    ds_read_b128 v[32:35], v14 offset:0
    ds_read_b128 v[36:39], v14 offset:2048
    ds_read_b128 v[40:43], v14 offset:4096
    ds_read_b128 v[44:47], v14 offset:6144
    ds_read_b128 v[64:67], v17 offset:0
    ds_read_b128 v[68:71], v17 offset:2048
    s_waitcnt lgkmcnt(12)
    v_mfma_f32_16x16x32_bf16 v[128:131], v[48:51], v[72:75], v[128:131]
    v_mfma_f32_16x16x32_bf16 v[132:135], v[48:51], v[76:79], v[132:135]
    v_mfma_f32_16x16x32_bf16 v[136:139], v[52:55], v[72:75], v[136:139]
    v_mfma_f32_16x16x32_bf16 v[140:143], v[52:55], v[76:79], v[140:143]
    v_mfma_f32_16x16x32_bf16 v[144:147], v[56:59], v[72:75], v[144:147]
    v_mfma_f32_16x16x32_bf16 v[148:151], v[56:59], v[76:79], v[148:151]
    v_mfma_f32_16x16x32_bf16 v[152:155], v[60:63], v[72:75], v[152:155]
    v_mfma_f32_16x16x32_bf16 v[156:159], v[60:63], v[76:79], v[156:159]
    s_waitcnt lgkmcnt(6)
    s_barrier
    ds_read_b128 v[48:51], v16 offset:0
    ds_read_b128 v[52:55], v16 offset:2048
    ds_read_b128 v[56:59], v16 offset:4096
    ds_read_b128 v[60:63], v16 offset:6144
    ds_read_b128 v[72:75], v18 offset:0
    ds_read_b128 v[76:79], v18 offset:2048
    buffer_load_dwordx4 a[48:51], v3, s[20:23], s60 offen
    v_add_u32 v3, 131072, v3
    buffer_load_dwordx4 a[52:55], v3, s[20:23], s60 offen
    v_add_u32 v3, 131072, v3
    buffer_load_dwordx4 a[56:59], v3, s[20:23], s60 offen
    v_add_u32 v3, 131072, v3
    buffer_load_dwordx4 a[60:63], v3, s[20:23], s60 offen
    v_subrev_u32 v3, 393216, v3
    buffer_load_dwordx4 a[64:67], v5, s[24:27], s61 offen
    v_add_u32 v5, 131072, v5
    buffer_load_dwordx4 a[68:71], v5, s[24:27], s61 offen
    v_subrev_u32 v5, 131072, v5
    s_add_u32 s60, s60, 128
    s_add_u32 s61, s61, 128
    s_waitcnt vmcnt(12) lgkmcnt(6)
    ds_write_b128 v6, a[0:3] offset:49152
    ds_write_b128 v6, a[4:7] offset:53248
    ds_write_b128 v6, a[8:11] offset:57344
    ds_write_b128 v6, a[12:15] offset:61440
    ds_write_b128 v19, a[16:19] offset:49152
    ds_write_b128 v19, a[20:23] offset:53248
    v_mfma_f32_16x16x32_bf16 v[128:131], v[32:35], v[64:67], v[128:131]
    v_mfma_f32_16x16x32_bf16 v[132:135], v[32:35], v[68:71], v[132:135]
    v_mfma_f32_16x16x32_bf16 v[136:139], v[36:39], v[64:67], v[136:139]
    v_mfma_f32_16x16x32_bf16 v[140:143], v[36:39], v[68:71], v[140:143]
    v_mfma_f32_16x16x32_bf16 v[144:147], v[40:43], v[64:67], v[144:147]
    v_mfma_f32_16x16x32_bf16 v[148:151], v[40:43], v[68:71], v[148:151]
    v_mfma_f32_16x16x32_bf16 v[152:155], v[44:47], v[64:67], v[152:155]
    v_mfma_f32_16x16x32_bf16 v[156:159], v[44:47], v[68:71], v[156:159]
    ds_read_b128 v[32:35], v14 offset:24576
    ds_read_b128 v[36:39], v14 offset:26624
    ds_read_b128 v[40:43], v14 offset:28672
    ds_read_b128 v[44:47], v14 offset:30720
    ds_read_b128 v[64:67], v17 offset:24576
    ds_read_b128 v[68:71], v17 offset:26624
    s_waitcnt lgkmcnt(12)
    v_mfma_f32_16x16x32_bf16 v[128:131], v[48:51], v[72:75], v[128:131]
    v_mfma_f32_16x16x32_bf16 v[132:135], v[48:51], v[76:79], v[132:135]
    v_mfma_f32_16x16x32_bf16 v[136:139], v[52:55], v[72:75], v[136:139]
    v_mfma_f32_16x16x32_bf16 v[140:143], v[52:55], v[76:79], v[140:143]
    v_mfma_f32_16x16x32_bf16 v[144:147], v[56:59], v[72:75], v[144:147]
    v_mfma_f32_16x16x32_bf16 v[148:151], v[56:59], v[76:79], v[148:151]
    v_mfma_f32_16x16x32_bf16 v[152:155], v[60:63], v[72:75], v[152:155]
    v_mfma_f32_16x16x32_bf16 v[156:159], v[60:63], v[76:79], v[156:159]
    s_waitcnt lgkmcnt(6)
    s_barrier
    ds_read_b128 v[48:51], v16 offset:24576
    ds_read_b128 v[52:55], v16 offset:26624
    ds_read_b128 v[56:59], v16 offset:28672
    ds_read_b128 v[60:63], v16 offset:30720
    ds_read_b128 v[72:75], v18 offset:24576
    ds_read_b128 v[76:79], v18 offset:26624
    buffer_load_dwordx4 a[72:75], v3, s[20:23], s60 offen
    v_add_u32 v3, 131072, v3
    buffer_load_dwordx4 a[76:79], v3, s[20:23], s60 offen
    v_add_u32 v3, 131072, v3
    buffer_load_dwordx4 a[80:83], v3, s[20:23], s60 offen
    v_add_u32 v3, 131072, v3
    buffer_load_dwordx4 a[84:87], v3, s[20:23], s60 offen
    v_subrev_u32 v3, 393216, v3
    buffer_load_dwordx4 a[88:91], v5, s[24:27], s61 offen
    v_add_u32 v5, 131072, v5
    buffer_load_dwordx4 a[92:95], v5, s[24:27], s61 offen
    v_subrev_u32 v5, 131072, v5
    s_add_u32 s60, s60, 128
    s_add_u32 s61, s61, 128
    s_waitcnt vmcnt(12) lgkmcnt(6)
    ds_write_b128 v6, a[24:27] offset:0
    ds_write_b128 v6, a[28:31] offset:4096
    ds_write_b128 v6, a[32:35] offset:8192
    ds_write_b128 v6, a[36:39] offset:12288
    ds_write_b128 v19, a[40:43] offset:0
    ds_write_b128 v19, a[44:47] offset:4096
    v_mfma_f32_16x16x32_bf16 v[128:131], v[32:35], v[64:67], v[128:131]
    v_mfma_f32_16x16x32_bf16 v[132:135], v[32:35], v[68:71], v[132:135]
    v_mfma_f32_16x16x32_bf16 v[136:139], v[36:39], v[64:67], v[136:139]
    v_mfma_f32_16x16x32_bf16 v[140:143], v[36:39], v[68:71], v[140:143]
    v_mfma_f32_16x16x32_bf16 v[144:147], v[40:43], v[64:67], v[144:147]
    v_mfma_f32_16x16x32_bf16 v[148:151], v[40:43], v[68:71], v[148:151]
    v_mfma_f32_16x16x32_bf16 v[152:155], v[44:47], v[64:67], v[152:155]
    v_mfma_f32_16x16x32_bf16 v[156:159], v[44:47], v[68:71], v[156:159]
    ds_read_b128 v[32:35], v14 offset:49152
    ds_read_b128 v[36:39], v14 offset:51200
    ds_read_b128 v[40:43], v14 offset:53248
    ds_read_b128 v[44:47], v14 offset:55296
    ds_read_b128 v[64:67], v17 offset:49152
    ds_read_b128 v[68:71], v17 offset:51200
    s_waitcnt lgkmcnt(12)
    v_mfma_f32_16x16x32_bf16 v[128:131], v[48:51], v[72:75], v[128:131]
    v_mfma_f32_16x16x32_bf16 v[132:135], v[48:51], v[76:79], v[132:135]
    v_mfma_f32_16x16x32_bf16 v[136:139], v[52:55], v[72:75], v[136:139]
    v_mfma_f32_16x16x32_bf16 v[140:143], v[52:55], v[76:79], v[140:143]
    v_mfma_f32_16x16x32_bf16 v[144:147], v[56:59], v[72:75], v[144:147]
    v_mfma_f32_16x16x32_bf16 v[148:151], v[56:59], v[76:79], v[148:151]
    v_mfma_f32_16x16x32_bf16 v[152:155], v[60:63], v[72:75], v[152:155]
    v_mfma_f32_16x16x32_bf16 v[156:159], v[60:63], v[76:79], v[156:159]
    s_waitcnt lgkmcnt(6)
    s_barrier
    ds_read_b128 v[48:51], v16 offset:49152
    ds_read_b128 v[52:55], v16 offset:51200
    ds_read_b128 v[56:59], v16 offset:53248
    ds_read_b128 v[60:63], v16 offset:55296
    ds_read_b128 v[72:75], v18 offset:49152
    ds_read_b128 v[76:79], v18 offset:51200
    buffer_load_dwordx4 a[0:3], v3, s[20:23], s60 offen
    v_add_u32 v3, 131072, v3
    buffer_load_dwordx4 a[4:7], v3, s[20:23], s60 offen
    v_add_u32 v3, 131072, v3
    buffer_load_dwordx4 a[8:11], v3, s[20:23], s60 offen
    v_add_u32 v3, 131072, v3
    buffer_load_dwordx4 a[12:15], v3, s[20:23], s60 offen
    v_subrev_u32 v3, 393216, v3
    buffer_load_dwordx4 a[16:19], v5, s[24:27], s61 offen
    v_add_u32 v5, 131072, v5
    buffer_load_dwordx4 a[20:23], v5, s[24:27], s61 offen
    v_subrev_u32 v5, 131072, v5
    s_add_u32 s60, s60, 128
    s_add_u32 s61, s61, 128
    s_waitcnt vmcnt(12) lgkmcnt(6)
    ds_write_b128 v6, a[48:51] offset:24576
    ds_write_b128 v6, a[52:55] offset:28672
    ds_write_b128 v6, a[56:59] offset:32768
    ds_write_b128 v6, a[60:63] offset:36864
    ds_write_b128 v19, a[64:67] offset:24576
    ds_write_b128 v19, a[68:71] offset:28672
    v_mfma_f32_16x16x32_bf16 v[128:131], v[32:35], v[64:67], v[128:131]
    v_mfma_f32_16x16x32_bf16 v[132:135], v[32:35], v[68:71], v[132:135]
    v_mfma_f32_16x16x32_bf16 v[136:139], v[36:39], v[64:67], v[136:139]
    v_mfma_f32_16x16x32_bf16 v[140:143], v[36:39], v[68:71], v[140:143]
    v_mfma_f32_16x16x32_bf16 v[144:147], v[40:43], v[64:67], v[144:147]
    v_mfma_f32_16x16x32_bf16 v[148:151], v[40:43], v[68:71], v[148:151]
    v_mfma_f32_16x16x32_bf16 v[152:155], v[44:47], v[64:67], v[152:155]
    v_mfma_f32_16x16x32_bf16 v[156:159], v[44:47], v[68:71], v[156:159]
    ds_read_b128 v[32:35], v14 offset:0
    ds_read_b128 v[36:39], v14 offset:2048
    ds_read_b128 v[40:43], v14 offset:4096
    ds_read_b128 v[44:47], v14 offset:6144
    ds_read_b128 v[64:67], v17 offset:0
    ds_read_b128 v[68:71], v17 offset:2048
    s_waitcnt lgkmcnt(12)
    v_mfma_f32_16x16x32_bf16 v[128:131], v[48:51], v[72:75], v[128:131]
    v_mfma_f32_16x16x32_bf16 v[132:135], v[48:51], v[76:79], v[132:135]
    v_mfma_f32_16x16x32_bf16 v[136:139], v[52:55], v[72:75], v[136:139]
    v_mfma_f32_16x16x32_bf16 v[140:143], v[52:55], v[76:79], v[140:143]
    v_mfma_f32_16x16x32_bf16 v[144:147], v[56:59], v[72:75], v[144:147]
    v_mfma_f32_16x16x32_bf16 v[148:151], v[56:59], v[76:79], v[148:151]
    v_mfma_f32_16x16x32_bf16 v[152:155], v[60:63], v[72:75], v[152:155]
    v_mfma_f32_16x16x32_bf16 v[156:159], v[60:63], v[76:79], v[156:159]
    s_waitcnt lgkmcnt(6)
    s_barrier
    ds_read_b128 v[48:51], v16 offset:0
    ds_read_b128 v[52:55], v16 offset:2048
    ds_read_b128 v[56:59], v16 offset:4096
    ds_read_b128 v[60:63], v16 offset:6144
    ds_read_b128 v[72:75], v18 offset:0
    ds_read_b128 v[76:79], v18 offset:2048
    buffer_load_dwordx4 a[24:27], v3, s[20:23], s60 offen
    v_add_u32 v3, 131072, v3
    buffer_load_dwordx4 a[28:31], v3, s[20:23], s60 offen
    v_add_u32 v3, 131072, v3
    buffer_load_dwordx4 a[32:35], v3, s[20:23], s60 offen
    v_add_u32 v3, 131072, v3
    buffer_load_dwordx4 a[36:39], v3, s[20:23], s60 offen
    v_subrev_u32 v3, 393216, v3
    buffer_load_dwordx4 a[40:43], v5, s[24:27], s61 offen
    v_add_u32 v5, 131072, v5
    buffer_load_dwordx4 a[44:47], v5, s[24:27], s61 offen
    v_subrev_u32 v5, 131072, v5
    s_add_u32 s60, s60, 128
    s_add_u32 s61, s61, 128
    s_waitcnt vmcnt(12) lgkmcnt(6)
    ds_write_b128 v6, a[72:75] offset:49152
    ds_write_b128 v6, a[76:79] offset:53248
    ds_write_b128 v6, a[80:83] offset:57344
    ds_write_b128 v6, a[84:87] offset:61440
    ds_write_b128 v19, a[88:91] offset:49152
    ds_write_b128 v19, a[92:95] offset:53248
    v_mfma_f32_16x16x32_bf16 v[128:131], v[32:35], v[64:67], v[128:131]
    v_mfma_f32_16x16x32_bf16 v[132:135], v[32:35], v[68:71], v[132:135]
    v_mfma_f32_16x16x32_bf16 v[136:139], v[36:39], v[64:67], v[136:139]
    v_mfma_f32_16x16x32_bf16 v[140:143], v[36:39], v[68:71], v[140:143]
    v_mfma_f32_16x16x32_bf16 v[144:147], v[40:43], v[64:67], v[144:147]
    v_mfma_f32_16x16x32_bf16 v[148:151], v[40:43], v[68:71], v[148:151]
    v_mfma_f32_16x16x32_bf16 v[152:155], v[44:47], v[64:67], v[152:155]
    v_mfma_f32_16x16x32_bf16 v[156:159], v[44:47], v[68:71], v[156:159]
    ds_read_b128 v[32:35], v14 offset:24576
    ds_read_b128 v[36:39], v14 offset:26624
    ds_read_b128 v[40:43], v14 offset:28672
    ds_read_b128 v[44:47], v14 offset:30720
    ds_read_b128 v[64:67], v17 offset:24576
    ds_read_b128 v[68:71], v17 offset:26624
    s_waitcnt lgkmcnt(12)
    v_mfma_f32_16x16x32_bf16 v[128:131], v[48:51], v[72:75], v[128:131]
    v_mfma_f32_16x16x32_bf16 v[132:135], v[48:51], v[76:79], v[132:135]
    v_mfma_f32_16x16x32_bf16 v[136:139], v[52:55], v[72:75], v[136:139]
    v_mfma_f32_16x16x32_bf16 v[140:143], v[52:55], v[76:79], v[140:143]
    v_mfma_f32_16x16x32_bf16 v[144:147], v[56:59], v[72:75], v[144:147]
    v_mfma_f32_16x16x32_bf16 v[148:151], v[56:59], v[76:79], v[148:151]
    v_mfma_f32_16x16x32_bf16 v[152:155], v[60:63], v[72:75], v[152:155]
    v_mfma_f32_16x16x32_bf16 v[156:159], v[60:63], v[76:79], v[156:159]
    s_waitcnt lgkmcnt(6)
    s_barrier
    ds_read_b128 v[48:51], v16 offset:24576
    ds_read_b128 v[52:55], v16 offset:26624
    ds_read_b128 v[56:59], v16 offset:28672
    ds_read_b128 v[60:63], v16 offset:30720
    ds_read_b128 v[72:75], v18 offset:24576
    ds_read_b128 v[76:79], v18 offset:26624
    buffer_load_dwordx4 a[48:51], v3, s[20:23], s60 offen
    v_add_u32 v3, 131072, v3
    buffer_load_dwordx4 a[52:55], v3, s[20:23], s60 offen
    v_add_u32 v3, 131072, v3
    buffer_load_dwordx4 a[56:59], v3, s[20:23], s60 offen
    v_add_u32 v3, 131072, v3
    buffer_load_dwordx4 a[60:63], v3, s[20:23], s60 offen
    v_subrev_u32 v3, 393216, v3
    buffer_load_dwordx4 a[64:67], v5, s[24:27], s61 offen
    v_add_u32 v5, 131072, v5
    buffer_load_dwordx4 a[68:71], v5, s[24:27], s61 offen
    v_subrev_u32 v5, 131072, v5
    s_add_u32 s60, s60, 128
    s_add_u32 s61, s61, 128
    s_waitcnt vmcnt(12) lgkmcnt(6)
    ds_write_b128 v6, a[0:3] offset:0
    ds_write_b128 v6, a[4:7] offset:4096
    ds_write_b128 v6, a[8:11] offset:8192
    ds_write_b128 v6, a[12:15] offset:12288
    ds_write_b128 v19, a[16:19] offset:0
    ds_write_b128 v19, a[20:23] offset:4096
    v_mfma_f32_16x16x32_bf16 v[128:131], v[32:35], v[64:67], v[128:131]
    v_mfma_f32_16x16x32_bf16 v[132:135], v[32:35], v[68:71], v[132:135]
    v_mfma_f32_16x16x32_bf16 v[136:139], v[36:39], v[64:67], v[136:139]
    v_mfma_f32_16x16x32_bf16 v[140:143], v[36:39], v[68:71], v[140:143]
    v_mfma_f32_16x16x32_bf16 v[144:147], v[40:43], v[64:67], v[144:147]
    v_mfma_f32_16x16x32_bf16 v[148:151], v[40:43], v[68:71], v[148:151]
    v_mfma_f32_16x16x32_bf16 v[152:155], v[44:47], v[64:67], v[152:155]
    v_mfma_f32_16x16x32_bf16 v[156:159], v[44:47], v[68:71], v[156:159]
    ds_read_b128 v[32:35], v14 offset:49152
    ds_read_b128 v[36:39], v14 offset:51200
    ds_read_b128 v[40:43], v14 offset:53248
    ds_read_b128 v[44:47], v14 offset:55296
    ds_read_b128 v[64:67], v17 offset:49152
    ds_read_b128 v[68:71], v17 offset:51200
    s_waitcnt lgkmcnt(12)
    v_mfma_f32_16x16x32_bf16 v[128:131], v[48:51], v[72:75], v[128:131]
    v_mfma_f32_16x16x32_bf16 v[132:135], v[48:51], v[76:79], v[132:135]
    v_mfma_f32_16x16x32_bf16 v[136:139], v[52:55], v[72:75], v[136:139]
    v_mfma_f32_16x16x32_bf16 v[140:143], v[52:55], v[76:79], v[140:143]
    v_mfma_f32_16x16x32_bf16 v[144:147], v[56:59], v[72:75], v[144:147]
    v_mfma_f32_16x16x32_bf16 v[148:151], v[56:59], v[76:79], v[148:151]
    v_mfma_f32_16x16x32_bf16 v[152:155], v[60:63], v[72:75], v[152:155]
    v_mfma_f32_16x16x32_bf16 v[156:159], v[60:63], v[76:79], v[156:159]
    s_waitcnt lgkmcnt(6)
    s_barrier
    ds_read_b128 v[48:51], v16 offset:49152
    ds_read_b128 v[52:55], v16 offset:51200
    ds_read_b128 v[56:59], v16 offset:53248
    ds_read_b128 v[60:63], v16 offset:55296
    ds_read_b128 v[72:75], v18 offset:49152
    ds_read_b128 v[76:79], v18 offset:51200
    buffer_load_dwordx4 a[72:75], v3, s[20:23], s60 offen
    v_add_u32 v3, 131072, v3
    buffer_load_dwordx4 a[76:79], v3, s[20:23], s60 offen
    v_add_u32 v3, 131072, v3
    buffer_load_dwordx4 a[80:83], v3, s[20:23], s60 offen
    v_add_u32 v3, 131072, v3
    buffer_load_dwordx4 a[84:87], v3, s[20:23], s60 offen
    v_subrev_u32 v3, 393216, v3
    buffer_load_dwordx4 a[88:91], v5, s[24:27], s61 offen
    v_add_u32 v5, 131072, v5
    buffer_load_dwordx4 a[92:95], v5, s[24:27], s61 offen
    v_subrev_u32 v5, 131072, v5
    s_add_u32 s60, s60, 128
    s_add_u32 s61, s61, 128
    s_waitcnt vmcnt(12) lgkmcnt(6)
    ds_write_b128 v6, a[24:27] offset:24576
    ds_write_b128 v6, a[28:31] offset:28672
    ds_write_b128 v6, a[32:35] offset:32768
    ds_write_b128 v6, a[36:39] offset:36864
    ds_write_b128 v19, a[40:43] offset:24576
    ds_write_b128 v19, a[44:47] offset:28672
    v_mfma_f32_16x16x32_bf16 v[128:131], v[32:35], v[64:67], v[128:131]
    v_mfma_f32_16x16x32_bf16 v[132:135], v[32:35], v[68:71], v[132:135]
    v_mfma_f32_16x16x32_bf16 v[136:139], v[36:39], v[64:67], v[136:139]
    v_mfma_f32_16x16x32_bf16 v[140:143], v[36:39], v[68:71], v[140:143]
    v_mfma_f32_16x16x32_bf16 v[144:147], v[40:43], v[64:67], v[144:147]
    v_mfma_f32_16x16x32_bf16 v[148:151], v[40:43], v[68:71], v[148:151]
    v_mfma_f32_16x16x32_bf16 v[152:155], v[44:47], v[64:67], v[152:155]
    v_mfma_f32_16x16x32_bf16 v[156:159], v[44:47], v[68:71], v[156:159]
    ds_read_b128 v[32:35], v14 offset:0
    ds_read_b128 v[36:39], v14 offset:2048
    ds_read_b128 v[40:43], v14 offset:4096
    ds_read_b128 v[44:47], v14 offset:6144
    ds_read_b128 v[64:67], v17 offset:0
    ds_read_b128 v[68:71], v17 offset:2048
    s_waitcnt lgkmcnt(12)
    v_mfma_f32_16x16x32_bf16 v[128:131], v[48:51], v[72:75], v[128:131]
    v_mfma_f32_16x16x32_bf16 v[132:135], v[48:51], v[76:79], v[132:135]
    v_mfma_f32_16x16x32_bf16 v[136:139], v[52:55], v[72:75], v[136:139]
    v_mfma_f32_16x16x32_bf16 v[140:143], v[52:55], v[76:79], v[140:143]
    v_mfma_f32_16x16x32_bf16 v[144:147], v[56:59], v[72:75], v[144:147]
    v_mfma_f32_16x16x32_bf16 v[148:151], v[56:59], v[76:79], v[148:151]
    v_mfma_f32_16x16x32_bf16 v[152:155], v[60:63], v[72:75], v[152:155]
    v_mfma_f32_16x16x32_bf16 v[156:159], v[60:63], v[76:79], v[156:159]
    s_waitcnt lgkmcnt(6)
    s_barrier
    ds_read_b128 v[48:51], v16 offset:0
    ds_read_b128 v[52:55], v16 offset:2048
    ds_read_b128 v[56:59], v16 offset:4096
    ds_read_b128 v[60:63], v16 offset:6144
    ds_read_b128 v[72:75], v18 offset:0
    ds_read_b128 v[76:79], v18 offset:2048
    buffer_load_dwordx4 a[0:3], v3, s[20:23], s60 offen
    v_add_u32 v3, 131072, v3
    buffer_load_dwordx4 a[4:7], v3, s[20:23], s60 offen
    v_add_u32 v3, 131072, v3
    buffer_load_dwordx4 a[8:11], v3, s[20:23], s60 offen
    v_add_u32 v3, 131072, v3
    buffer_load_dwordx4 a[12:15], v3, s[20:23], s60 offen
    v_subrev_u32 v3, 393216, v3
    buffer_load_dwordx4 a[16:19], v5, s[24:27], s61 offen
    v_add_u32 v5, 131072, v5
    buffer_load_dwordx4 a[20:23], v5, s[24:27], s61 offen
    v_subrev_u32 v5, 131072, v5
    s_add_u32 s60, s60, 128
    s_add_u32 s61, s61, 128
    s_waitcnt vmcnt(12) lgkmcnt(6)
    ds_write_b128 v6, a[48:51] offset:49152
    ds_write_b128 v6, a[52:55] offset:53248
    ds_write_b128 v6, a[56:59] offset:57344
    ds_write_b128 v6, a[60:63] offset:61440
    ds_write_b128 v19, a[64:67] offset:49152
    ds_write_b128 v19, a[68:71] offset:53248
    v_mfma_f32_16x16x32_bf16 v[128:131], v[32:35], v[64:67], v[128:131]
    v_mfma_f32_16x16x32_bf16 v[132:135], v[32:35], v[68:71], v[132:135]
    v_mfma_f32_16x16x32_bf16 v[136:139], v[36:39], v[64:67], v[136:139]
    v_mfma_f32_16x16x32_bf16 v[140:143], v[36:39], v[68:71], v[140:143]
    v_mfma_f32_16x16x32_bf16 v[144:147], v[40:43], v[64:67], v[144:147]
    v_mfma_f32_16x16x32_bf16 v[148:151], v[40:43], v[68:71], v[148:151]
    v_mfma_f32_16x16x32_bf16 v[152:155], v[44:47], v[64:67], v[152:155]
    v_mfma_f32_16x16x32_bf16 v[156:159], v[44:47], v[68:71], v[156:159]
    ds_read_b128 v[32:35], v14 offset:24576
    ds_read_b128 v[36:39], v14 offset:26624
    ds_read_b128 v[40:43], v14 offset:28672
    ds_read_b128 v[44:47], v14 offset:30720
    ds_read_b128 v[64:67], v17 offset:24576
    ds_read_b128 v[68:71], v17 offset:26624
    s_waitcnt lgkmcnt(12)
    v_mfma_f32_16x16x32_bf16 v[128:131], v[48:51], v[72:75], v[128:131]
    v_mfma_f32_16x16x32_bf16 v[132:135], v[48:51], v[76:79], v[132:135]
    v_mfma_f32_16x16x32_bf16 v[136:139], v[52:55], v[72:75], v[136:139]
    v_mfma_f32_16x16x32_bf16 v[140:143], v[52:55], v[76:79], v[140:143]
    v_mfma_f32_16x16x32_bf16 v[144:147], v[56:59], v[72:75], v[144:147]
    v_mfma_f32_16x16x32_bf16 v[148:151], v[56:59], v[76:79], v[148:151]
    v_mfma_f32_16x16x32_bf16 v[152:155], v[60:63], v[72:75], v[152:155]
    v_mfma_f32_16x16x32_bf16 v[156:159], v[60:63], v[76:79], v[156:159]
    s_waitcnt lgkmcnt(6)
    s_barrier
    ds_read_b128 v[48:51], v16 offset:24576
    ds_read_b128 v[52:55], v16 offset:26624
    ds_read_b128 v[56:59], v16 offset:28672
    ds_read_b128 v[60:63], v16 offset:30720
    ds_read_b128 v[72:75], v18 offset:24576
    ds_read_b128 v[76:79], v18 offset:26624
    buffer_load_dwordx4 a[24:27], v3, s[20:23], s60 offen
    v_add_u32 v3, 131072, v3
    buffer_load_dwordx4 a[28:31], v3, s[20:23], s60 offen
    v_add_u32 v3, 131072, v3
    buffer_load_dwordx4 a[32:35], v3, s[20:23], s60 offen
    v_add_u32 v3, 131072, v3
    buffer_load_dwordx4 a[36:39], v3, s[20:23], s60 offen
    v_subrev_u32 v3, 393216, v3
    buffer_load_dwordx4 a[40:43], v5, s[24:27], s61 offen
    v_add_u32 v5, 131072, v5
    buffer_load_dwordx4 a[44:47], v5, s[24:27], s61 offen
    v_subrev_u32 v5, 131072, v5
    s_add_u32 s60, s60, 128
    s_add_u32 s61, s61, 128
    s_waitcnt vmcnt(12) lgkmcnt(6)
    ds_write_b128 v6, a[72:75] offset:0
    ds_write_b128 v6, a[76:79] offset:4096
    ds_write_b128 v6, a[80:83] offset:8192
    ds_write_b128 v6, a[84:87] offset:12288
    ds_write_b128 v19, a[88:91] offset:0
    ds_write_b128 v19, a[92:95] offset:4096
    v_mfma_f32_16x16x32_bf16 v[128:131], v[32:35], v[64:67], v[128:131]
    v_mfma_f32_16x16x32_bf16 v[132:135], v[32:35], v[68:71], v[132:135]
    v_mfma_f32_16x16x32_bf16 v[136:139], v[36:39], v[64:67], v[136:139]
    v_mfma_f32_16x16x32_bf16 v[140:143], v[36:39], v[68:71], v[140:143]
    v_mfma_f32_16x16x32_bf16 v[144:147], v[40:43], v[64:67], v[144:147]
    v_mfma_f32_16x16x32_bf16 v[148:151], v[40:43], v[68:71], v[148:151]
    v_mfma_f32_16x16x32_bf16 v[152:155], v[44:47], v[64:67], v[152:155]
    v_mfma_f32_16x16x32_bf16 v[156:159], v[44:47], v[68:71], v[156:159]
    ds_read_b128 v[32:35], v14 offset:49152
    ds_read_b128 v[36:39], v14 offset:51200
    ds_read_b128 v[40:43], v14 offset:53248
    ds_read_b128 v[44:47], v14 offset:55296
    ds_read_b128 v[64:67], v17 offset:49152
    ds_read_b128 v[68:71], v17 offset:51200
    s_waitcnt lgkmcnt(12)
    v_mfma_f32_16x16x32_bf16 v[128:131], v[48:51], v[72:75], v[128:131]
    v_mfma_f32_16x16x32_bf16 v[132:135], v[48:51], v[76:79], v[132:135]
    v_mfma_f32_16x16x32_bf16 v[136:139], v[52:55], v[72:75], v[136:139]
    v_mfma_f32_16x16x32_bf16 v[140:143], v[52:55], v[76:79], v[140:143]
    v_mfma_f32_16x16x32_bf16 v[144:147], v[56:59], v[72:75], v[144:147]
    v_mfma_f32_16x16x32_bf16 v[148:151], v[56:59], v[76:79], v[148:151]
    v_mfma_f32_16x16x32_bf16 v[152:155], v[60:63], v[72:75], v[152:155]
    v_mfma_f32_16x16x32_bf16 v[156:159], v[60:63], v[76:79], v[156:159]
    s_waitcnt lgkmcnt(6)
    s_barrier
    ds_read_b128 v[48:51], v16 offset:49152
    ds_read_b128 v[52:55], v16 offset:51200
    ds_read_b128 v[56:59], v16 offset:53248
    ds_read_b128 v[60:63], v16 offset:55296
    ds_read_b128 v[72:75], v18 offset:49152
    ds_read_b128 v[76:79], v18 offset:51200
    buffer_load_dwordx4 a[48:51], v3, s[20:23], s60 offen
    v_add_u32 v3, 131072, v3
    buffer_load_dwordx4 a[52:55], v3, s[20:23], s60 offen
    v_add_u32 v3, 131072, v3
    buffer_load_dwordx4 a[56:59], v3, s[20:23], s60 offen
    v_add_u32 v3, 131072, v3
    buffer_load_dwordx4 a[60:63], v3, s[20:23], s60 offen
    v_subrev_u32 v3, 393216, v3
    buffer_load_dwordx4 a[64:67], v5, s[24:27], s61 offen
    v_add_u32 v5, 131072, v5
    buffer_load_dwordx4 a[68:71], v5, s[24:27], s61 offen
    v_subrev_u32 v5, 131072, v5
    s_add_u32 s60, s60, 128
    s_add_u32 s61, s61, 128
    s_waitcnt vmcnt(12) lgkmcnt(6)
    ds_write_b128 v6, a[0:3] offset:24576
    ds_write_b128 v6, a[4:7] offset:28672
    ds_write_b128 v6, a[8:11] offset:32768
    ds_write_b128 v6, a[12:15] offset:36864
    ds_write_b128 v19, a[16:19] offset:24576
    ds_write_b128 v19, a[20:23] offset:28672
    v_mfma_f32_16x16x32_bf16 v[128:131], v[32:35], v[64:67], v[128:131]
    v_mfma_f32_16x16x32_bf16 v[132:135], v[32:35], v[68:71], v[132:135]
    v_mfma_f32_16x16x32_bf16 v[136:139], v[36:39], v[64:67], v[136:139]
    v_mfma_f32_16x16x32_bf16 v[140:143], v[36:39], v[68:71], v[140:143]
    v_mfma_f32_16x16x32_bf16 v[144:147], v[40:43], v[64:67], v[144:147]
    v_mfma_f32_16x16x32_bf16 v[148:151], v[40:43], v[68:71], v[148:151]
    v_mfma_f32_16x16x32_bf16 v[152:155], v[44:47], v[64:67], v[152:155]
    v_mfma_f32_16x16x32_bf16 v[156:159], v[44:47], v[68:71], v[156:159]
    ds_read_b128 v[32:35], v14 offset:0
    ds_read_b128 v[36:39], v14 offset:2048
    ds_read_b128 v[40:43], v14 offset:4096
    ds_read_b128 v[44:47], v14 offset:6144
    ds_read_b128 v[64:67], v17 offset:0
    ds_read_b128 v[68:71], v17 offset:2048
    s_waitcnt lgkmcnt(12)
    v_mfma_f32_16x16x32_bf16 v[128:131], v[48:51], v[72:75], v[128:131]
    v_mfma_f32_16x16x32_bf16 v[132:135], v[48:51], v[76:79], v[132:135]
    v_mfma_f32_16x16x32_bf16 v[136:139], v[52:55], v[72:75], v[136:139]
    v_mfma_f32_16x16x32_bf16 v[140:143], v[52:55], v[76:79], v[140:143]
    v_mfma_f32_16x16x32_bf16 v[144:147], v[56:59], v[72:75], v[144:147]
    v_mfma_f32_16x16x32_bf16 v[148:151], v[56:59], v[76:79], v[148:151]
    v_mfma_f32_16x16x32_bf16 v[152:155], v[60:63], v[72:75], v[152:155]
    v_mfma_f32_16x16x32_bf16 v[156:159], v[60:63], v[76:79], v[156:159]
    s_waitcnt lgkmcnt(6)
    s_barrier
    ds_read_b128 v[48:51], v16 offset:0
    ds_read_b128 v[52:55], v16 offset:2048
    ds_read_b128 v[56:59], v16 offset:4096
    ds_read_b128 v[60:63], v16 offset:6144
    ds_read_b128 v[72:75], v18 offset:0
    ds_read_b128 v[76:79], v18 offset:2048
    buffer_load_dwordx4 a[72:75], v3, s[20:23], s60 offen
    v_add_u32 v3, 131072, v3
    buffer_load_dwordx4 a[76:79], v3, s[20:23], s60 offen
    v_add_u32 v3, 131072, v3
    buffer_load_dwordx4 a[80:83], v3, s[20:23], s60 offen
    v_add_u32 v3, 131072, v3
    buffer_load_dwordx4 a[84:87], v3, s[20:23], s60 offen
    v_subrev_u32 v3, 393216, v3
    buffer_load_dwordx4 a[88:91], v5, s[24:27], s61 offen
    v_add_u32 v5, 131072, v5
    buffer_load_dwordx4 a[92:95], v5, s[24:27], s61 offen
    v_subrev_u32 v5, 131072, v5
    s_add_u32 s60, s60, 128
    s_add_u32 s61, s61, 128
    s_waitcnt vmcnt(12) lgkmcnt(6)
    ds_write_b128 v6, a[24:27] offset:49152
    ds_write_b128 v6, a[28:31] offset:53248
    ds_write_b128 v6, a[32:35] offset:57344
    ds_write_b128 v6, a[36:39] offset:61440
    ds_write_b128 v19, a[40:43] offset:49152
    ds_write_b128 v19, a[44:47] offset:53248
    v_mfma_f32_16x16x32_bf16 v[128:131], v[32:35], v[64:67], v[128:131]
    v_mfma_f32_16x16x32_bf16 v[132:135], v[32:35], v[68:71], v[132:135]
    v_mfma_f32_16x16x32_bf16 v[136:139], v[36:39], v[64:67], v[136:139]
    v_mfma_f32_16x16x32_bf16 v[140:143], v[36:39], v[68:71], v[140:143]
    v_mfma_f32_16x16x32_bf16 v[144:147], v[40:43], v[64:67], v[144:147]
    v_mfma_f32_16x16x32_bf16 v[148:151], v[40:43], v[68:71], v[148:151]
    v_mfma_f32_16x16x32_bf16 v[152:155], v[44:47], v[64:67], v[152:155]
    v_mfma_f32_16x16x32_bf16 v[156:159], v[44:47], v[68:71], v[156:159]
    ds_read_b128 v[32:35], v14 offset:24576
    ds_read_b128 v[36:39], v14 offset:26624
    ds_read_b128 v[40:43], v14 offset:28672
    ds_read_b128 v[44:47], v14 offset:30720
    ds_read_b128 v[64:67], v17 offset:24576
    ds_read_b128 v[68:71], v17 offset:26624
    s_waitcnt lgkmcnt(12)
    v_mfma_f32_16x16x32_bf16 v[128:131], v[48:51], v[72:75], v[128:131]
    v_mfma_f32_16x16x32_bf16 v[132:135], v[48:51], v[76:79], v[132:135]
    v_mfma_f32_16x16x32_bf16 v[136:139], v[52:55], v[72:75], v[136:139]
    v_mfma_f32_16x16x32_bf16 v[140:143], v[52:55], v[76:79], v[140:143]
    v_mfma_f32_16x16x32_bf16 v[144:147], v[56:59], v[72:75], v[144:147]
    v_mfma_f32_16x16x32_bf16 v[148:151], v[56:59], v[76:79], v[148:151]
    v_mfma_f32_16x16x32_bf16 v[152:155], v[60:63], v[72:75], v[152:155]
    v_mfma_f32_16x16x32_bf16 v[156:159], v[60:63], v[76:79], v[156:159]
    s_waitcnt lgkmcnt(6)
    s_barrier
    ds_read_b128 v[48:51], v16 offset:24576
    ds_read_b128 v[52:55], v16 offset:26624
    ds_read_b128 v[56:59], v16 offset:28672
    ds_read_b128 v[60:63], v16 offset:30720
    ds_read_b128 v[72:75], v18 offset:24576
    ds_read_b128 v[76:79], v18 offset:26624
    buffer_load_dwordx4 a[0:3], v3, s[20:23], s60 offen
    v_add_u32 v3, 131072, v3
    buffer_load_dwordx4 a[4:7], v3, s[20:23], s60 offen
    v_add_u32 v3, 131072, v3
    buffer_load_dwordx4 a[8:11], v3, s[20:23], s60 offen
    v_add_u32 v3, 131072, v3
    buffer_load_dwordx4 a[12:15], v3, s[20:23], s60 offen
    v_subrev_u32 v3, 393216, v3
    buffer_load_dwordx4 a[16:19], v5, s[24:27], s61 offen
    v_add_u32 v5, 131072, v5
    buffer_load_dwordx4 a[20:23], v5, s[24:27], s61 offen
    v_subrev_u32 v5, 131072, v5
    s_add_u32 s60, s60, 128
    s_add_u32 s61, s61, 128
    s_waitcnt vmcnt(12) lgkmcnt(6)
    ds_write_b128 v6, a[48:51] offset:0
    ds_write_b128 v6, a[52:55] offset:4096
    ds_write_b128 v6, a[56:59] offset:8192
    ds_write_b128 v6, a[60:63] offset:12288
    ds_write_b128 v19, a[64:67] offset:0
    ds_write_b128 v19, a[68:71] offset:4096
    v_mfma_f32_16x16x32_bf16 v[128:131], v[32:35], v[64:67], v[128:131]
    v_mfma_f32_16x16x32_bf16 v[132:135], v[32:35], v[68:71], v[132:135]
    v_mfma_f32_16x16x32_bf16 v[136:139], v[36:39], v[64:67], v[136:139]
    v_mfma_f32_16x16x32_bf16 v[140:143], v[36:39], v[68:71], v[140:143]
    v_mfma_f32_16x16x32_bf16 v[144:147], v[40:43], v[64:67], v[144:147]
    v_mfma_f32_16x16x32_bf16 v[148:151], v[40:43], v[68:71], v[148:151]
    v_mfma_f32_16x16x32_bf16 v[152:155], v[44:47], v[64:67], v[152:155]
    v_mfma_f32_16x16x32_bf16 v[156:159], v[44:47], v[68:71], v[156:159]
    ds_read_b128 v[32:35], v14 offset:49152
    ds_read_b128 v[36:39], v14 offset:51200
    ds_read_b128 v[40:43], v14 offset:53248
    ds_read_b128 v[44:47], v14 offset:55296
    ds_read_b128 v[64:67], v17 offset:49152
    ds_read_b128 v[68:71], v17 offset:51200
    s_waitcnt lgkmcnt(12)
    v_mfma_f32_16x16x32_bf16 v[128:131], v[48:51], v[72:75], v[128:131]
    v_mfma_f32_16x16x32_bf16 v[132:135], v[48:51], v[76:79], v[132:135]
    v_mfma_f32_16x16x32_bf16 v[136:139], v[52:55], v[72:75], v[136:139]
    v_mfma_f32_16x16x32_bf16 v[140:143], v[52:55], v[76:79], v[140:143]
    v_mfma_f32_16x16x32_bf16 v[144:147], v[56:59], v[72:75], v[144:147]
    v_mfma_f32_16x16x32_bf16 v[148:151], v[56:59], v[76:79], v[148:151]
    v_mfma_f32_16x16x32_bf16 v[152:155], v[60:63], v[72:75], v[152:155]
    v_mfma_f32_16x16x32_bf16 v[156:159], v[60:63], v[76:79], v[156:159]
    s_waitcnt lgkmcnt(6)
    s_barrier
    ds_read_b128 v[48:51], v16 offset:49152
    ds_read_b128 v[52:55], v16 offset:51200
    ds_read_b128 v[56:59], v16 offset:53248
    ds_read_b128 v[60:63], v16 offset:55296
    ds_read_b128 v[72:75], v18 offset:49152
    ds_read_b128 v[76:79], v18 offset:51200
    buffer_load_dwordx4 a[24:27], v3, s[20:23], s60 offen
    v_add_u32 v3, 131072, v3
    buffer_load_dwordx4 a[28:31], v3, s[20:23], s60 offen
    v_add_u32 v3, 131072, v3
    buffer_load_dwordx4 a[32:35], v3, s[20:23], s60 offen
    v_add_u32 v3, 131072, v3
    buffer_load_dwordx4 a[36:39], v3, s[20:23], s60 offen
    v_subrev_u32 v3, 393216, v3
    buffer_load_dwordx4 a[40:43], v5, s[24:27], s61 offen
    v_add_u32 v5, 131072, v5
    buffer_load_dwordx4 a[44:47], v5, s[24:27], s61 offen
    v_subrev_u32 v5, 131072, v5
    s_add_u32 s60, s60, 128
    s_add_u32 s61, s61, 128
    s_waitcnt vmcnt(12) lgkmcnt(6)
    ds_write_b128 v6, a[72:75] offset:24576
    ds_write_b128 v6, a[76:79] offset:28672
    ds_write_b128 v6, a[80:83] offset:32768
    ds_write_b128 v6, a[84:87] offset:36864
    ds_write_b128 v19, a[88:91] offset:24576
    ds_write_b128 v19, a[92:95] offset:28672
    v_mfma_f32_16x16x32_bf16 v[128:131], v[32:35], v[64:67], v[128:131]
    v_mfma_f32_16x16x32_bf16 v[132:135], v[32:35], v[68:71], v[132:135]
    v_mfma_f32_16x16x32_bf16 v[136:139], v[36:39], v[64:67], v[136:139]
    v_mfma_f32_16x16x32_bf16 v[140:143], v[36:39], v[68:71], v[140:143]
    v_mfma_f32_16x16x32_bf16 v[144:147], v[40:43], v[64:67], v[144:147]
    v_mfma_f32_16x16x32_bf16 v[148:151], v[40:43], v[68:71], v[148:151]
    v_mfma_f32_16x16x32_bf16 v[152:155], v[44:47], v[64:67], v[152:155]
    v_mfma_f32_16x16x32_bf16 v[156:159], v[44:47], v[68:71], v[156:159]
    ds_read_b128 v[32:35], v14 offset:0
    ds_read_b128 v[36:39], v14 offset:2048
    ds_read_b128 v[40:43], v14 offset:4096
    ds_read_b128 v[44:47], v14 offset:6144
    ds_read_b128 v[64:67], v17 offset:0
    ds_read_b128 v[68:71], v17 offset:2048
    s_waitcnt lgkmcnt(12)
    v_mfma_f32_16x16x32_bf16 v[128:131], v[48:51], v[72:75], v[128:131]
    v_mfma_f32_16x16x32_bf16 v[132:135], v[48:51], v[76:79], v[132:135]
    v_mfma_f32_16x16x32_bf16 v[136:139], v[52:55], v[72:75], v[136:139]
    v_mfma_f32_16x16x32_bf16 v[140:143], v[52:55], v[76:79], v[140:143]
    v_mfma_f32_16x16x32_bf16 v[144:147], v[56:59], v[72:75], v[144:147]
    v_mfma_f32_16x16x32_bf16 v[148:151], v[56:59], v[76:79], v[148:151]
    v_mfma_f32_16x16x32_bf16 v[152:155], v[60:63], v[72:75], v[152:155]
    v_mfma_f32_16x16x32_bf16 v[156:159], v[60:63], v[76:79], v[156:159]
    s_waitcnt lgkmcnt(6)
    s_barrier
    ds_read_b128 v[48:51], v16 offset:0
    ds_read_b128 v[52:55], v16 offset:2048
    ds_read_b128 v[56:59], v16 offset:4096
    ds_read_b128 v[60:63], v16 offset:6144
    ds_read_b128 v[72:75], v18 offset:0
    ds_read_b128 v[76:79], v18 offset:2048
    buffer_load_dwordx4 a[48:51], v3, s[20:23], s60 offen
    v_add_u32 v3, 131072, v3
    buffer_load_dwordx4 a[52:55], v3, s[20:23], s60 offen
    v_add_u32 v3, 131072, v3
    buffer_load_dwordx4 a[56:59], v3, s[20:23], s60 offen
    v_add_u32 v3, 131072, v3
    buffer_load_dwordx4 a[60:63], v3, s[20:23], s60 offen
    v_subrev_u32 v3, 393216, v3
    buffer_load_dwordx4 a[64:67], v5, s[24:27], s61 offen
    v_add_u32 v5, 131072, v5
    buffer_load_dwordx4 a[68:71], v5, s[24:27], s61 offen
    v_subrev_u32 v5, 131072, v5
    s_add_u32 s60, s60, 128
    s_add_u32 s61, s61, 128
    s_waitcnt vmcnt(12) lgkmcnt(6)
    ds_write_b128 v6, a[0:3] offset:49152
    ds_write_b128 v6, a[4:7] offset:53248
    ds_write_b128 v6, a[8:11] offset:57344
    ds_write_b128 v6, a[12:15] offset:61440
    ds_write_b128 v19, a[16:19] offset:49152
    ds_write_b128 v19, a[20:23] offset:53248
    v_mfma_f32_16x16x32_bf16 v[128:131], v[32:35], v[64:67], v[128:131]
    v_mfma_f32_16x16x32_bf16 v[132:135], v[32:35], v[68:71], v[132:135]
    v_mfma_f32_16x16x32_bf16 v[136:139], v[36:39], v[64:67], v[136:139]
    v_mfma_f32_16x16x32_bf16 v[140:143], v[36:39], v[68:71], v[140:143]
    v_mfma_f32_16x16x32_bf16 v[144:147], v[40:43], v[64:67], v[144:147]
    v_mfma_f32_16x16x32_bf16 v[148:151], v[40:43], v[68:71], v[148:151]
    v_mfma_f32_16x16x32_bf16 v[152:155], v[44:47], v[64:67], v[152:155]
    v_mfma_f32_16x16x32_bf16 v[156:159], v[44:47], v[68:71], v[156:159]
    ds_read_b128 v[32:35], v14 offset:24576
    ds_read_b128 v[36:39], v14 offset:26624
    ds_read_b128 v[40:43], v14 offset:28672
    ds_read_b128 v[44:47], v14 offset:30720
    ds_read_b128 v[64:67], v17 offset:24576
    ds_read_b128 v[68:71], v17 offset:26624
    s_waitcnt lgkmcnt(12)
    v_mfma_f32_16x16x32_bf16 v[128:131], v[48:51], v[72:75], v[128:131]
    v_mfma_f32_16x16x32_bf16 v[132:135], v[48:51], v[76:79], v[132:135]
    v_mfma_f32_16x16x32_bf16 v[136:139], v[52:55], v[72:75], v[136:139]
    v_mfma_f32_16x16x32_bf16 v[140:143], v[52:55], v[76:79], v[140:143]
    v_mfma_f32_16x16x32_bf16 v[144:147], v[56:59], v[72:75], v[144:147]
    v_mfma_f32_16x16x32_bf16 v[148:151], v[56:59], v[76:79], v[148:151]
    v_mfma_f32_16x16x32_bf16 v[152:155], v[60:63], v[72:75], v[152:155]
    v_mfma_f32_16x16x32_bf16 v[156:159], v[60:63], v[76:79], v[156:159]
    s_waitcnt lgkmcnt(6)
    s_barrier
    ds_read_b128 v[48:51], v16 offset:24576
    ds_read_b128 v[52:55], v16 offset:26624
    ds_read_b128 v[56:59], v16 offset:28672
    ds_read_b128 v[60:63], v16 offset:30720
    ds_read_b128 v[72:75], v18 offset:24576
    ds_read_b128 v[76:79], v18 offset:26624
    buffer_load_dwordx4 a[72:75], v3, s[20:23], s60 offen
    v_add_u32 v3, 131072, v3
    buffer_load_dwordx4 a[76:79], v3, s[20:23], s60 offen
    v_add_u32 v3, 131072, v3
    buffer_load_dwordx4 a[80:83], v3, s[20:23], s60 offen
    v_add_u32 v3, 131072, v3
    buffer_load_dwordx4 a[84:87], v3, s[20:23], s60 offen
    v_subrev_u32 v3, 393216, v3
    buffer_load_dwordx4 a[88:91], v5, s[24:27], s61 offen
    v_add_u32 v5, 131072, v5
    buffer_load_dwordx4 a[92:95], v5, s[24:27], s61 offen
    v_subrev_u32 v5, 131072, v5
    s_add_u32 s60, s60, 128
    s_add_u32 s61, s61, 128
    s_waitcnt vmcnt(12) lgkmcnt(6)
    ds_write_b128 v6, a[24:27] offset:0
    ds_write_b128 v6, a[28:31] offset:4096
    ds_write_b128 v6, a[32:35] offset:8192
    ds_write_b128 v6, a[36:39] offset:12288
    ds_write_b128 v19, a[40:43] offset:0
    ds_write_b128 v19, a[44:47] offset:4096
    v_mfma_f32_16x16x32_bf16 v[128:131], v[32:35], v[64:67], v[128:131]
    v_mfma_f32_16x16x32_bf16 v[132:135], v[32:35], v[68:71], v[132:135]
    v_mfma_f32_16x16x32_bf16 v[136:139], v[36:39], v[64:67], v[136:139]
    v_mfma_f32_16x16x32_bf16 v[140:143], v[36:39], v[68:71], v[140:143]
    v_mfma_f32_16x16x32_bf16 v[144:147], v[40:43], v[64:67], v[144:147]
    v_mfma_f32_16x16x32_bf16 v[148:151], v[40:43], v[68:71], v[148:151]
    v_mfma_f32_16x16x32_bf16 v[152:155], v[44:47], v[64:67], v[152:155]
    v_mfma_f32_16x16x32_bf16 v[156:159], v[44:47], v[68:71], v[156:159]
    ds_read_b128 v[32:35], v14 offset:49152
    ds_read_b128 v[36:39], v14 offset:51200
    ds_read_b128 v[40:43], v14 offset:53248
    ds_read_b128 v[44:47], v14 offset:55296
    ds_read_b128 v[64:67], v17 offset:49152
    ds_read_b128 v[68:71], v17 offset:51200
    s_waitcnt lgkmcnt(12)
    v_mfma_f32_16x16x32_bf16 v[128:131], v[48:51], v[72:75], v[128:131]
    v_mfma_f32_16x16x32_bf16 v[132:135], v[48:51], v[76:79], v[132:135]
    v_mfma_f32_16x16x32_bf16 v[136:139], v[52:55], v[72:75], v[136:139]
    v_mfma_f32_16x16x32_bf16 v[140:143], v[52:55], v[76:79], v[140:143]
    v_mfma_f32_16x16x32_bf16 v[144:147], v[56:59], v[72:75], v[144:147]
    v_mfma_f32_16x16x32_bf16 v[148:151], v[56:59], v[76:79], v[148:151]
    v_mfma_f32_16x16x32_bf16 v[152:155], v[60:63], v[72:75], v[152:155]
    v_mfma_f32_16x16x32_bf16 v[156:159], v[60:63], v[76:79], v[156:159]
    s_waitcnt lgkmcnt(6)
    s_barrier
    ds_read_b128 v[48:51], v16 offset:49152
    ds_read_b128 v[52:55], v16 offset:51200
    ds_read_b128 v[56:59], v16 offset:53248
    ds_read_b128 v[60:63], v16 offset:55296
    ds_read_b128 v[72:75], v18 offset:49152
    ds_read_b128 v[76:79], v18 offset:51200
    buffer_load_dwordx4 a[0:3], v3, s[20:23], s60 offen
    v_add_u32 v3, 131072, v3
    buffer_load_dwordx4 a[4:7], v3, s[20:23], s60 offen
    v_add_u32 v3, 131072, v3
    buffer_load_dwordx4 a[8:11], v3, s[20:23], s60 offen
    v_add_u32 v3, 131072, v3
    buffer_load_dwordx4 a[12:15], v3, s[20:23], s60 offen
    v_subrev_u32 v3, 393216, v3
    buffer_load_dwordx4 a[16:19], v5, s[24:27], s61 offen
    v_add_u32 v5, 131072, v5
    buffer_load_dwordx4 a[20:23], v5, s[24:27], s61 offen
    v_subrev_u32 v5, 131072, v5
    s_add_u32 s60, s60, 128
    s_add_u32 s61, s61, 128
    s_waitcnt vmcnt(12) lgkmcnt(6)
    ds_write_b128 v6, a[48:51] offset:24576
    ds_write_b128 v6, a[52:55] offset:28672
    ds_write_b128 v6, a[56:59] offset:32768
    ds_write_b128 v6, a[60:63] offset:36864
    ds_write_b128 v19, a[64:67] offset:24576
    ds_write_b128 v19, a[68:71] offset:28672
    v_mfma_f32_16x16x32_bf16 v[128:131], v[32:35], v[64:67], v[128:131]
    v_mfma_f32_16x16x32_bf16 v[132:135], v[32:35], v[68:71], v[132:135]
    v_mfma_f32_16x16x32_bf16 v[136:139], v[36:39], v[64:67], v[136:139]
    v_mfma_f32_16x16x32_bf16 v[140:143], v[36:39], v[68:71], v[140:143]
    v_mfma_f32_16x16x32_bf16 v[144:147], v[40:43], v[64:67], v[144:147]
    v_mfma_f32_16x16x32_bf16 v[148:151], v[40:43], v[68:71], v[148:151]
    v_mfma_f32_16x16x32_bf16 v[152:155], v[44:47], v[64:67], v[152:155]
    v_mfma_f32_16x16x32_bf16 v[156:159], v[44:47], v[68:71], v[156:159]
    ds_read_b128 v[32:35], v14 offset:0
    ds_read_b128 v[36:39], v14 offset:2048
    ds_read_b128 v[40:43], v14 offset:4096
    ds_read_b128 v[44:47], v14 offset:6144
    ds_read_b128 v[64:67], v17 offset:0
    ds_read_b128 v[68:71], v17 offset:2048
    s_waitcnt lgkmcnt(12)
    v_mfma_f32_16x16x32_bf16 v[128:131], v[48:51], v[72:75], v[128:131]
    v_mfma_f32_16x16x32_bf16 v[132:135], v[48:51], v[76:79], v[132:135]
    v_mfma_f32_16x16x32_bf16 v[136:139], v[52:55], v[72:75], v[136:139]
    v_mfma_f32_16x16x32_bf16 v[140:143], v[52:55], v[76:79], v[140:143]
    v_mfma_f32_16x16x32_bf16 v[144:147], v[56:59], v[72:75], v[144:147]
    v_mfma_f32_16x16x32_bf16 v[148:151], v[56:59], v[76:79], v[148:151]
    v_mfma_f32_16x16x32_bf16 v[152:155], v[60:63], v[72:75], v[152:155]
    v_mfma_f32_16x16x32_bf16 v[156:159], v[60:63], v[76:79], v[156:159]
    s_waitcnt lgkmcnt(6)
    s_barrier
    ds_read_b128 v[48:51], v16 offset:0
    ds_read_b128 v[52:55], v16 offset:2048
    ds_read_b128 v[56:59], v16 offset:4096
    ds_read_b128 v[60:63], v16 offset:6144
    ds_read_b128 v[72:75], v18 offset:0
    ds_read_b128 v[76:79], v18 offset:2048
    buffer_load_dwordx4 a[24:27], v3, s[20:23], s60 offen
    v_add_u32 v3, 131072, v3
    buffer_load_dwordx4 a[28:31], v3, s[20:23], s60 offen
    v_add_u32 v3, 131072, v3
    buffer_load_dwordx4 a[32:35], v3, s[20:23], s60 offen
    v_add_u32 v3, 131072, v3
    buffer_load_dwordx4 a[36:39], v3, s[20:23], s60 offen
    v_subrev_u32 v3, 393216, v3
    buffer_load_dwordx4 a[40:43], v5, s[24:27], s61 offen
    v_add_u32 v5, 131072, v5
    buffer_load_dwordx4 a[44:47], v5, s[24:27], s61 offen
    v_subrev_u32 v5, 131072, v5
    s_add_u32 s60, s60, 128
    s_add_u32 s61, s61, 128
    s_waitcnt vmcnt(12) lgkmcnt(6)
    ds_write_b128 v6, a[72:75] offset:49152
    ds_write_b128 v6, a[76:79] offset:53248
    ds_write_b128 v6, a[80:83] offset:57344
    ds_write_b128 v6, a[84:87] offset:61440
    ds_write_b128 v19, a[88:91] offset:49152
    ds_write_b128 v19, a[92:95] offset:53248
    v_mfma_f32_16x16x32_bf16 v[128:131], v[32:35], v[64:67], v[128:131]
    v_mfma_f32_16x16x32_bf16 v[132:135], v[32:35], v[68:71], v[132:135]
    v_mfma_f32_16x16x32_bf16 v[136:139], v[36:39], v[64:67], v[136:139]
    v_mfma_f32_16x16x32_bf16 v[140:143], v[36:39], v[68:71], v[140:143]
    v_mfma_f32_16x16x32_bf16 v[144:147], v[40:43], v[64:67], v[144:147]
    v_mfma_f32_16x16x32_bf16 v[148:151], v[40:43], v[68:71], v[148:151]
    v_mfma_f32_16x16x32_bf16 v[152:155], v[44:47], v[64:67], v[152:155]
    v_mfma_f32_16x16x32_bf16 v[156:159], v[44:47], v[68:71], v[156:159]
    ds_read_b128 v[32:35], v14 offset:24576
    ds_read_b128 v[36:39], v14 offset:26624
    ds_read_b128 v[40:43], v14 offset:28672
    ds_read_b128 v[44:47], v14 offset:30720
    ds_read_b128 v[64:67], v17 offset:24576
    ds_read_b128 v[68:71], v17 offset:26624
    s_waitcnt lgkmcnt(12)
    v_mfma_f32_16x16x32_bf16 v[128:131], v[48:51], v[72:75], v[128:131]
    v_mfma_f32_16x16x32_bf16 v[132:135], v[48:51], v[76:79], v[132:135]
    v_mfma_f32_16x16x32_bf16 v[136:139], v[52:55], v[72:75], v[136:139]
    v_mfma_f32_16x16x32_bf16 v[140:143], v[52:55], v[76:79], v[140:143]
    v_mfma_f32_16x16x32_bf16 v[144:147], v[56:59], v[72:75], v[144:147]
    v_mfma_f32_16x16x32_bf16 v[148:151], v[56:59], v[76:79], v[148:151]
    v_mfma_f32_16x16x32_bf16 v[152:155], v[60:63], v[72:75], v[152:155]
    v_mfma_f32_16x16x32_bf16 v[156:159], v[60:63], v[76:79], v[156:159]
    s_waitcnt lgkmcnt(6)
    s_barrier
    ds_read_b128 v[48:51], v16 offset:24576
    ds_read_b128 v[52:55], v16 offset:26624
    ds_read_b128 v[56:59], v16 offset:28672
    ds_read_b128 v[60:63], v16 offset:30720
    ds_read_b128 v[72:75], v18 offset:24576
    ds_read_b128 v[76:79], v18 offset:26624
    buffer_load_dwordx4 a[48:51], v3, s[20:23], s60 offen
    v_add_u32 v3, 131072, v3
    buffer_load_dwordx4 a[52:55], v3, s[20:23], s60 offen
    v_add_u32 v3, 131072, v3
    buffer_load_dwordx4 a[56:59], v3, s[20:23], s60 offen
    v_add_u32 v3, 131072, v3
    buffer_load_dwordx4 a[60:63], v3, s[20:23], s60 offen
    v_subrev_u32 v3, 393216, v3
    buffer_load_dwordx4 a[64:67], v5, s[24:27], s61 offen
    v_add_u32 v5, 131072, v5
    buffer_load_dwordx4 a[68:71], v5, s[24:27], s61 offen
    v_subrev_u32 v5, 131072, v5
    s_add_u32 s60, s60, 128
    s_add_u32 s61, s61, 128
    s_waitcnt vmcnt(12) lgkmcnt(6)
    ds_write_b128 v6, a[0:3] offset:0
    ds_write_b128 v6, a[4:7] offset:4096
    ds_write_b128 v6, a[8:11] offset:8192
    ds_write_b128 v6, a[12:15] offset:12288
    ds_write_b128 v19, a[16:19] offset:0
    ds_write_b128 v19, a[20:23] offset:4096
    v_mfma_f32_16x16x32_bf16 v[128:131], v[32:35], v[64:67], v[128:131]
    v_mfma_f32_16x16x32_bf16 v[132:135], v[32:35], v[68:71], v[132:135]
    v_mfma_f32_16x16x32_bf16 v[136:139], v[36:39], v[64:67], v[136:139]
    v_mfma_f32_16x16x32_bf16 v[140:143], v[36:39], v[68:71], v[140:143]
    v_mfma_f32_16x16x32_bf16 v[144:147], v[40:43], v[64:67], v[144:147]
    v_mfma_f32_16x16x32_bf16 v[148:151], v[40:43], v[68:71], v[148:151]
    v_mfma_f32_16x16x32_bf16 v[152:155], v[44:47], v[64:67], v[152:155]
    v_mfma_f32_16x16x32_bf16 v[156:159], v[44:47], v[68:71], v[156:159]
    ds_read_b128 v[32:35], v14 offset:49152
    ds_read_b128 v[36:39], v14 offset:51200
    ds_read_b128 v[40:43], v14 offset:53248
    ds_read_b128 v[44:47], v14 offset:55296
    ds_read_b128 v[64:67], v17 offset:49152
    ds_read_b128 v[68:71], v17 offset:51200
    s_waitcnt lgkmcnt(12)
    v_mfma_f32_16x16x32_bf16 v[128:131], v[48:51], v[72:75], v[128:131]
    v_mfma_f32_16x16x32_bf16 v[132:135], v[48:51], v[76:79], v[132:135]
    v_mfma_f32_16x16x32_bf16 v[136:139], v[52:55], v[72:75], v[136:139]
    v_mfma_f32_16x16x32_bf16 v[140:143], v[52:55], v[76:79], v[140:143]
    v_mfma_f32_16x16x32_bf16 v[144:147], v[56:59], v[72:75], v[144:147]
    v_mfma_f32_16x16x32_bf16 v[148:151], v[56:59], v[76:79], v[148:151]
    v_mfma_f32_16x16x32_bf16 v[152:155], v[60:63], v[72:75], v[152:155]
    v_mfma_f32_16x16x32_bf16 v[156:159], v[60:63], v[76:79], v[156:159]
    s_waitcnt lgkmcnt(6)
    s_barrier
    ds_read_b128 v[48:51], v16 offset:49152
    ds_read_b128 v[52:55], v16 offset:51200
    ds_read_b128 v[56:59], v16 offset:53248
    ds_read_b128 v[60:63], v16 offset:55296
    ds_read_b128 v[72:75], v18 offset:49152
    ds_read_b128 v[76:79], v18 offset:51200
    buffer_load_dwordx4 a[72:75], v3, s[20:23], s60 offen
    v_add_u32 v3, 131072, v3
    buffer_load_dwordx4 a[76:79], v3, s[20:23], s60 offen
    v_add_u32 v3, 131072, v3
    buffer_load_dwordx4 a[80:83], v3, s[20:23], s60 offen
    v_add_u32 v3, 131072, v3
    buffer_load_dwordx4 a[84:87], v3, s[20:23], s60 offen
    v_subrev_u32 v3, 393216, v3
    buffer_load_dwordx4 a[88:91], v5, s[24:27], s61 offen
    v_add_u32 v5, 131072, v5
    buffer_load_dwordx4 a[92:95], v5, s[24:27], s61 offen
    v_subrev_u32 v5, 131072, v5
    s_add_u32 s60, s60, 128
    s_add_u32 s61, s61, 128
    s_waitcnt vmcnt(12) lgkmcnt(6)
    ds_write_b128 v6, a[24:27] offset:24576
    ds_write_b128 v6, a[28:31] offset:28672
    ds_write_b128 v6, a[32:35] offset:32768
    ds_write_b128 v6, a[36:39] offset:36864
    ds_write_b128 v19, a[40:43] offset:24576
    ds_write_b128 v19, a[44:47] offset:28672
    v_mfma_f32_16x16x32_bf16 v[128:131], v[32:35], v[64:67], v[128:131]
    v_mfma_f32_16x16x32_bf16 v[132:135], v[32:35], v[68:71], v[132:135]
    v_mfma_f32_16x16x32_bf16 v[136:139], v[36:39], v[64:67], v[136:139]
    v_mfma_f32_16x16x32_bf16 v[140:143], v[36:39], v[68:71], v[140:143]
    v_mfma_f32_16x16x32_bf16 v[144:147], v[40:43], v[64:67], v[144:147]
    v_mfma_f32_16x16x32_bf16 v[148:151], v[40:43], v[68:71], v[148:151]
    v_mfma_f32_16x16x32_bf16 v[152:155], v[44:47], v[64:67], v[152:155]
    v_mfma_f32_16x16x32_bf16 v[156:159], v[44:47], v[68:71], v[156:159]
    ds_read_b128 v[32:35], v14 offset:0
    ds_read_b128 v[36:39], v14 offset:2048
    ds_read_b128 v[40:43], v14 offset:4096
    ds_read_b128 v[44:47], v14 offset:6144
    ds_read_b128 v[64:67], v17 offset:0
    ds_read_b128 v[68:71], v17 offset:2048
    s_waitcnt lgkmcnt(12)
    v_mfma_f32_16x16x32_bf16 v[128:131], v[48:51], v[72:75], v[128:131]
    v_mfma_f32_16x16x32_bf16 v[132:135], v[48:51], v[76:79], v[132:135]
    v_mfma_f32_16x16x32_bf16 v[136:139], v[52:55], v[72:75], v[136:139]
    v_mfma_f32_16x16x32_bf16 v[140:143], v[52:55], v[76:79], v[140:143]
    v_mfma_f32_16x16x32_bf16 v[144:147], v[56:59], v[72:75], v[144:147]
    v_mfma_f32_16x16x32_bf16 v[148:151], v[56:59], v[76:79], v[148:151]
    v_mfma_f32_16x16x32_bf16 v[152:155], v[60:63], v[72:75], v[152:155]
    v_mfma_f32_16x16x32_bf16 v[156:159], v[60:63], v[76:79], v[156:159]
    s_waitcnt lgkmcnt(6)
    s_barrier
    ds_read_b128 v[48:51], v16 offset:0
    ds_read_b128 v[52:55], v16 offset:2048
    ds_read_b128 v[56:59], v16 offset:4096
    ds_read_b128 v[60:63], v16 offset:6144
    ds_read_b128 v[72:75], v18 offset:0
    ds_read_b128 v[76:79], v18 offset:2048
    buffer_load_dwordx4 a[0:3], v3, s[20:23], s60 offen
    v_add_u32 v3, 131072, v3
    buffer_load_dwordx4 a[4:7], v3, s[20:23], s60 offen
    v_add_u32 v3, 131072, v3
    buffer_load_dwordx4 a[8:11], v3, s[20:23], s60 offen
    v_add_u32 v3, 131072, v3
    buffer_load_dwordx4 a[12:15], v3, s[20:23], s60 offen
    v_subrev_u32 v3, 393216, v3
    buffer_load_dwordx4 a[16:19], v5, s[24:27], s61 offen
    v_add_u32 v5, 131072, v5
    buffer_load_dwordx4 a[20:23], v5, s[24:27], s61 offen
    v_subrev_u32 v5, 131072, v5
    s_add_u32 s60, s60, 128
    s_add_u32 s61, s61, 128
    s_waitcnt vmcnt(12) lgkmcnt(6)
    ds_write_b128 v6, a[48:51] offset:49152
    ds_write_b128 v6, a[52:55] offset:53248
    ds_write_b128 v6, a[56:59] offset:57344
    ds_write_b128 v6, a[60:63] offset:61440
    ds_write_b128 v19, a[64:67] offset:49152
    ds_write_b128 v19, a[68:71] offset:53248
    v_mfma_f32_16x16x32_bf16 v[128:131], v[32:35], v[64:67], v[128:131]
    v_mfma_f32_16x16x32_bf16 v[132:135], v[32:35], v[68:71], v[132:135]
    v_mfma_f32_16x16x32_bf16 v[136:139], v[36:39], v[64:67], v[136:139]
    v_mfma_f32_16x16x32_bf16 v[140:143], v[36:39], v[68:71], v[140:143]
    v_mfma_f32_16x16x32_bf16 v[144:147], v[40:43], v[64:67], v[144:147]
    v_mfma_f32_16x16x32_bf16 v[148:151], v[40:43], v[68:71], v[148:151]
    v_mfma_f32_16x16x32_bf16 v[152:155], v[44:47], v[64:67], v[152:155]
    v_mfma_f32_16x16x32_bf16 v[156:159], v[44:47], v[68:71], v[156:159]
    ds_read_b128 v[32:35], v14 offset:24576
    ds_read_b128 v[36:39], v14 offset:26624
    ds_read_b128 v[40:43], v14 offset:28672
    ds_read_b128 v[44:47], v14 offset:30720
    ds_read_b128 v[64:67], v17 offset:24576
    ds_read_b128 v[68:71], v17 offset:26624
    s_waitcnt lgkmcnt(12)
    v_mfma_f32_16x16x32_bf16 v[128:131], v[48:51], v[72:75], v[128:131]
    v_mfma_f32_16x16x32_bf16 v[132:135], v[48:51], v[76:79], v[132:135]
    v_mfma_f32_16x16x32_bf16 v[136:139], v[52:55], v[72:75], v[136:139]
    v_mfma_f32_16x16x32_bf16 v[140:143], v[52:55], v[76:79], v[140:143]
    v_mfma_f32_16x16x32_bf16 v[144:147], v[56:59], v[72:75], v[144:147]
    v_mfma_f32_16x16x32_bf16 v[148:151], v[56:59], v[76:79], v[148:151]
    v_mfma_f32_16x16x32_bf16 v[152:155], v[60:63], v[72:75], v[152:155]
    v_mfma_f32_16x16x32_bf16 v[156:159], v[60:63], v[76:79], v[156:159]
    s_waitcnt lgkmcnt(6)
    s_barrier
    ds_read_b128 v[48:51], v16 offset:24576
    ds_read_b128 v[52:55], v16 offset:26624
    ds_read_b128 v[56:59], v16 offset:28672
    ds_read_b128 v[60:63], v16 offset:30720
    ds_read_b128 v[72:75], v18 offset:24576
    ds_read_b128 v[76:79], v18 offset:26624
    buffer_load_dwordx4 a[24:27], v3, s[20:23], s60 offen
    v_add_u32 v3, 131072, v3
    buffer_load_dwordx4 a[28:31], v3, s[20:23], s60 offen
    v_add_u32 v3, 131072, v3
    buffer_load_dwordx4 a[32:35], v3, s[20:23], s60 offen
    v_add_u32 v3, 131072, v3
    buffer_load_dwordx4 a[36:39], v3, s[20:23], s60 offen
    v_subrev_u32 v3, 393216, v3
    buffer_load_dwordx4 a[40:43], v5, s[24:27], s61 offen
    v_add_u32 v5, 131072, v5
    buffer_load_dwordx4 a[44:47], v5, s[24:27], s61 offen
    v_subrev_u32 v5, 131072, v5
    s_add_u32 s60, s60, 128
    s_add_u32 s61, s61, 128
    s_waitcnt vmcnt(12) lgkmcnt(6)
    ds_write_b128 v6, a[72:75] offset:0
    ds_write_b128 v6, a[76:79] offset:4096
    ds_write_b128 v6, a[80:83] offset:8192
    ds_write_b128 v6, a[84:87] offset:12288
    ds_write_b128 v19, a[88:91] offset:0
    ds_write_b128 v19, a[92:95] offset:4096
    v_mfma_f32_16x16x32_bf16 v[128:131], v[32:35], v[64:67], v[128:131]
    v_mfma_f32_16x16x32_bf16 v[132:135], v[32:35], v[68:71], v[132:135]
    v_mfma_f32_16x16x32_bf16 v[136:139], v[36:39], v[64:67], v[136:139]
    v_mfma_f32_16x16x32_bf16 v[140:143], v[36:39], v[68:71], v[140:143]
    v_mfma_f32_16x16x32_bf16 v[144:147], v[40:43], v[64:67], v[144:147]
    v_mfma_f32_16x16x32_bf16 v[148:151], v[40:43], v[68:71], v[148:151]
    v_mfma_f32_16x16x32_bf16 v[152:155], v[44:47], v[64:67], v[152:155]
    v_mfma_f32_16x16x32_bf16 v[156:159], v[44:47], v[68:71], v[156:159]
    ds_read_b128 v[32:35], v14 offset:49152
    ds_read_b128 v[36:39], v14 offset:51200
    ds_read_b128 v[40:43], v14 offset:53248
    ds_read_b128 v[44:47], v14 offset:55296
    ds_read_b128 v[64:67], v17 offset:49152
    ds_read_b128 v[68:71], v17 offset:51200
    s_waitcnt lgkmcnt(12)
    v_mfma_f32_16x16x32_bf16 v[128:131], v[48:51], v[72:75], v[128:131]
    v_mfma_f32_16x16x32_bf16 v[132:135], v[48:51], v[76:79], v[132:135]
    v_mfma_f32_16x16x32_bf16 v[136:139], v[52:55], v[72:75], v[136:139]
    v_mfma_f32_16x16x32_bf16 v[140:143], v[52:55], v[76:79], v[140:143]
    v_mfma_f32_16x16x32_bf16 v[144:147], v[56:59], v[72:75], v[144:147]
    v_mfma_f32_16x16x32_bf16 v[148:151], v[56:59], v[76:79], v[148:151]
    v_mfma_f32_16x16x32_bf16 v[152:155], v[60:63], v[72:75], v[152:155]
    v_mfma_f32_16x16x32_bf16 v[156:159], v[60:63], v[76:79], v[156:159]
    s_waitcnt lgkmcnt(6)
    s_barrier
    ds_read_b128 v[48:51], v16 offset:49152
    ds_read_b128 v[52:55], v16 offset:51200
    ds_read_b128 v[56:59], v16 offset:53248
    ds_read_b128 v[60:63], v16 offset:55296
    ds_read_b128 v[72:75], v18 offset:49152
    ds_read_b128 v[76:79], v18 offset:51200
    buffer_load_dwordx4 a[48:51], v3, s[20:23], s60 offen
    v_add_u32 v3, 131072, v3
    buffer_load_dwordx4 a[52:55], v3, s[20:23], s60 offen
    v_add_u32 v3, 131072, v3
    buffer_load_dwordx4 a[56:59], v3, s[20:23], s60 offen
    v_add_u32 v3, 131072, v3
    buffer_load_dwordx4 a[60:63], v3, s[20:23], s60 offen
    v_subrev_u32 v3, 393216, v3
    buffer_load_dwordx4 a[64:67], v5, s[24:27], s61 offen
    v_add_u32 v5, 131072, v5
    buffer_load_dwordx4 a[68:71], v5, s[24:27], s61 offen
    v_subrev_u32 v5, 131072, v5
    s_add_u32 s60, s60, 128
    s_add_u32 s61, s61, 128
    s_waitcnt vmcnt(12) lgkmcnt(6)
    ds_write_b128 v6, a[0:3] offset:24576
    ds_write_b128 v6, a[4:7] offset:28672
    ds_write_b128 v6, a[8:11] offset:32768
    ds_write_b128 v6, a[12:15] offset:36864
    ds_write_b128 v19, a[16:19] offset:24576
    ds_write_b128 v19, a[20:23] offset:28672
    v_mfma_f32_16x16x32_bf16 v[128:131], v[32:35], v[64:67], v[128:131]
    v_mfma_f32_16x16x32_bf16 v[132:135], v[32:35], v[68:71], v[132:135]
    v_mfma_f32_16x16x32_bf16 v[136:139], v[36:39], v[64:67], v[136:139]
    v_mfma_f32_16x16x32_bf16 v[140:143], v[36:39], v[68:71], v[140:143]
    v_mfma_f32_16x16x32_bf16 v[144:147], v[40:43], v[64:67], v[144:147]
    v_mfma_f32_16x16x32_bf16 v[148:151], v[40:43], v[68:71], v[148:151]
    v_mfma_f32_16x16x32_bf16 v[152:155], v[44:47], v[64:67], v[152:155]
    v_mfma_f32_16x16x32_bf16 v[156:159], v[44:47], v[68:71], v[156:159]
    ds_read_b128 v[32:35], v14 offset:0
    ds_read_b128 v[36:39], v14 offset:2048
    ds_read_b128 v[40:43], v14 offset:4096
    ds_read_b128 v[44:47], v14 offset:6144
    ds_read_b128 v[64:67], v17 offset:0
    ds_read_b128 v[68:71], v17 offset:2048
    s_waitcnt lgkmcnt(12)
    v_mfma_f32_16x16x32_bf16 v[128:131], v[48:51], v[72:75], v[128:131]
    v_mfma_f32_16x16x32_bf16 v[132:135], v[48:51], v[76:79], v[132:135]
    v_mfma_f32_16x16x32_bf16 v[136:139], v[52:55], v[72:75], v[136:139]
    v_mfma_f32_16x16x32_bf16 v[140:143], v[52:55], v[76:79], v[140:143]
    v_mfma_f32_16x16x32_bf16 v[144:147], v[56:59], v[72:75], v[144:147]
    v_mfma_f32_16x16x32_bf16 v[148:151], v[56:59], v[76:79], v[148:151]
    v_mfma_f32_16x16x32_bf16 v[152:155], v[60:63], v[72:75], v[152:155]
    v_mfma_f32_16x16x32_bf16 v[156:159], v[60:63], v[76:79], v[156:159]
    s_waitcnt lgkmcnt(6)
    s_barrier
    ds_read_b128 v[48:51], v16 offset:0
    ds_read_b128 v[52:55], v16 offset:2048
    ds_read_b128 v[56:59], v16 offset:4096
    ds_read_b128 v[60:63], v16 offset:6144
    ds_read_b128 v[72:75], v18 offset:0
    ds_read_b128 v[76:79], v18 offset:2048
    buffer_load_dwordx4 a[72:75], v3, s[20:23], s60 offen
    v_add_u32 v3, 131072, v3
    buffer_load_dwordx4 a[76:79], v3, s[20:23], s60 offen
    v_add_u32 v3, 131072, v3
    buffer_load_dwordx4 a[80:83], v3, s[20:23], s60 offen
    v_add_u32 v3, 131072, v3
    buffer_load_dwordx4 a[84:87], v3, s[20:23], s60 offen
    v_subrev_u32 v3, 393216, v3
    buffer_load_dwordx4 a[88:91], v5, s[24:27], s61 offen
    v_add_u32 v5, 131072, v5
    buffer_load_dwordx4 a[92:95], v5, s[24:27], s61 offen
    v_subrev_u32 v5, 131072, v5
    s_add_u32 s60, s60, 128
    s_add_u32 s61, s61, 128
    s_waitcnt vmcnt(12) lgkmcnt(6)
    ds_write_b128 v6, a[24:27] offset:49152
    ds_write_b128 v6, a[28:31] offset:53248
    ds_write_b128 v6, a[32:35] offset:57344
    ds_write_b128 v6, a[36:39] offset:61440
    ds_write_b128 v19, a[40:43] offset:49152
    ds_write_b128 v19, a[44:47] offset:53248
    v_mfma_f32_16x16x32_bf16 v[128:131], v[32:35], v[64:67], v[128:131]
    v_mfma_f32_16x16x32_bf16 v[132:135], v[32:35], v[68:71], v[132:135]
    v_mfma_f32_16x16x32_bf16 v[136:139], v[36:39], v[64:67], v[136:139]
    v_mfma_f32_16x16x32_bf16 v[140:143], v[36:39], v[68:71], v[140:143]
    v_mfma_f32_16x16x32_bf16 v[144:147], v[40:43], v[64:67], v[144:147]
    v_mfma_f32_16x16x32_bf16 v[148:151], v[40:43], v[68:71], v[148:151]
    v_mfma_f32_16x16x32_bf16 v[152:155], v[44:47], v[64:67], v[152:155]
    v_mfma_f32_16x16x32_bf16 v[156:159], v[44:47], v[68:71], v[156:159]
    ds_read_b128 v[32:35], v14 offset:24576
    ds_read_b128 v[36:39], v14 offset:26624
    ds_read_b128 v[40:43], v14 offset:28672
    ds_read_b128 v[44:47], v14 offset:30720
    ds_read_b128 v[64:67], v17 offset:24576
    ds_read_b128 v[68:71], v17 offset:26624
    s_waitcnt lgkmcnt(12)
    v_mfma_f32_16x16x32_bf16 v[128:131], v[48:51], v[72:75], v[128:131]
    v_mfma_f32_16x16x32_bf16 v[132:135], v[48:51], v[76:79], v[132:135]
    v_mfma_f32_16x16x32_bf16 v[136:139], v[52:55], v[72:75], v[136:139]
    v_mfma_f32_16x16x32_bf16 v[140:143], v[52:55], v[76:79], v[140:143]
    v_mfma_f32_16x16x32_bf16 v[144:147], v[56:59], v[72:75], v[144:147]
    v_mfma_f32_16x16x32_bf16 v[148:151], v[56:59], v[76:79], v[148:151]
    v_mfma_f32_16x16x32_bf16 v[152:155], v[60:63], v[72:75], v[152:155]
    v_mfma_f32_16x16x32_bf16 v[156:159], v[60:63], v[76:79], v[156:159]
    s_waitcnt lgkmcnt(6)
    s_barrier
    ds_read_b128 v[48:51], v16 offset:24576
    ds_read_b128 v[52:55], v16 offset:26624
    ds_read_b128 v[56:59], v16 offset:28672
    ds_read_b128 v[60:63], v16 offset:30720
    ds_read_b128 v[72:75], v18 offset:24576
    ds_read_b128 v[76:79], v18 offset:26624
    buffer_load_dwordx4 a[0:3], v3, s[20:23], s60 offen
    v_add_u32 v3, 131072, v3
    buffer_load_dwordx4 a[4:7], v3, s[20:23], s60 offen
    v_add_u32 v3, 131072, v3
    buffer_load_dwordx4 a[8:11], v3, s[20:23], s60 offen
    v_add_u32 v3, 131072, v3
    buffer_load_dwordx4 a[12:15], v3, s[20:23], s60 offen
    v_subrev_u32 v3, 393216, v3
    buffer_load_dwordx4 a[16:19], v5, s[24:27], s61 offen
    v_add_u32 v5, 131072, v5
    buffer_load_dwordx4 a[20:23], v5, s[24:27], s61 offen
    v_subrev_u32 v5, 131072, v5
    s_add_u32 s60, s60, 128
    s_add_u32 s61, s61, 128
    s_waitcnt vmcnt(12) lgkmcnt(6)
    ds_write_b128 v6, a[48:51] offset:0
    ds_write_b128 v6, a[52:55] offset:4096
    ds_write_b128 v6, a[56:59] offset:8192
    ds_write_b128 v6, a[60:63] offset:12288
    ds_write_b128 v19, a[64:67] offset:0
    ds_write_b128 v19, a[68:71] offset:4096
    v_mfma_f32_16x16x32_bf16 v[128:131], v[32:35], v[64:67], v[128:131]
    v_mfma_f32_16x16x32_bf16 v[132:135], v[32:35], v[68:71], v[132:135]
    v_mfma_f32_16x16x32_bf16 v[136:139], v[36:39], v[64:67], v[136:139]
    v_mfma_f32_16x16x32_bf16 v[140:143], v[36:39], v[68:71], v[140:143]
    v_mfma_f32_16x16x32_bf16 v[144:147], v[40:43], v[64:67], v[144:147]
    v_mfma_f32_16x16x32_bf16 v[148:151], v[40:43], v[68:71], v[148:151]
    v_mfma_f32_16x16x32_bf16 v[152:155], v[44:47], v[64:67], v[152:155]
    v_mfma_f32_16x16x32_bf16 v[156:159], v[44:47], v[68:71], v[156:159]
    ds_read_b128 v[32:35], v14 offset:49152
    ds_read_b128 v[36:39], v14 offset:51200
    ds_read_b128 v[40:43], v14 offset:53248
    ds_read_b128 v[44:47], v14 offset:55296
    ds_read_b128 v[64:67], v17 offset:49152
    ds_read_b128 v[68:71], v17 offset:51200
    s_waitcnt lgkmcnt(12)
    v_mfma_f32_16x16x32_bf16 v[128:131], v[48:51], v[72:75], v[128:131]
    v_mfma_f32_16x16x32_bf16 v[132:135], v[48:51], v[76:79], v[132:135]
    v_mfma_f32_16x16x32_bf16 v[136:139], v[52:55], v[72:75], v[136:139]
    v_mfma_f32_16x16x32_bf16 v[140:143], v[52:55], v[76:79], v[140:143]
    v_mfma_f32_16x16x32_bf16 v[144:147], v[56:59], v[72:75], v[144:147]
    v_mfma_f32_16x16x32_bf16 v[148:151], v[56:59], v[76:79], v[148:151]
    v_mfma_f32_16x16x32_bf16 v[152:155], v[60:63], v[72:75], v[152:155]
    v_mfma_f32_16x16x32_bf16 v[156:159], v[60:63], v[76:79], v[156:159]
    s_waitcnt lgkmcnt(6)
    s_barrier
    ds_read_b128 v[48:51], v16 offset:49152
    ds_read_b128 v[52:55], v16 offset:51200
    ds_read_b128 v[56:59], v16 offset:53248
    ds_read_b128 v[60:63], v16 offset:55296
    ds_read_b128 v[72:75], v18 offset:49152
    ds_read_b128 v[76:79], v18 offset:51200
    buffer_load_dwordx4 a[24:27], v3, s[20:23], s60 offen
    v_add_u32 v3, 131072, v3
    buffer_load_dwordx4 a[28:31], v3, s[20:23], s60 offen
    v_add_u32 v3, 131072, v3
    buffer_load_dwordx4 a[32:35], v3, s[20:23], s60 offen
    v_add_u32 v3, 131072, v3
    buffer_load_dwordx4 a[36:39], v3, s[20:23], s60 offen
    v_subrev_u32 v3, 393216, v3
    buffer_load_dwordx4 a[40:43], v5, s[24:27], s61 offen
    v_add_u32 v5, 131072, v5
    buffer_load_dwordx4 a[44:47], v5, s[24:27], s61 offen
    v_subrev_u32 v5, 131072, v5
    s_add_u32 s60, s60, 128
    s_add_u32 s61, s61, 128
    s_waitcnt vmcnt(12) lgkmcnt(6)
    ds_write_b128 v6, a[72:75] offset:24576
    ds_write_b128 v6, a[76:79] offset:28672
    ds_write_b128 v6, a[80:83] offset:32768
    ds_write_b128 v6, a[84:87] offset:36864
    ds_write_b128 v19, a[88:91] offset:24576
    ds_write_b128 v19, a[92:95] offset:28672
    v_mfma_f32_16x16x32_bf16 v[128:131], v[32:35], v[64:67], v[128:131]
    v_mfma_f32_16x16x32_bf16 v[132:135], v[32:35], v[68:71], v[132:135]
    v_mfma_f32_16x16x32_bf16 v[136:139], v[36:39], v[64:67], v[136:139]
    v_mfma_f32_16x16x32_bf16 v[140:143], v[36:39], v[68:71], v[140:143]
    v_mfma_f32_16x16x32_bf16 v[144:147], v[40:43], v[64:67], v[144:147]
    v_mfma_f32_16x16x32_bf16 v[148:151], v[40:43], v[68:71], v[148:151]
    v_mfma_f32_16x16x32_bf16 v[152:155], v[44:47], v[64:67], v[152:155]
    v_mfma_f32_16x16x32_bf16 v[156:159], v[44:47], v[68:71], v[156:159]
    ds_read_b128 v[32:35], v14 offset:0
    ds_read_b128 v[36:39], v14 offset:2048
    ds_read_b128 v[40:43], v14 offset:4096
    ds_read_b128 v[44:47], v14 offset:6144
    ds_read_b128 v[64:67], v17 offset:0
    ds_read_b128 v[68:71], v17 offset:2048
    s_waitcnt lgkmcnt(12)
    v_mfma_f32_16x16x32_bf16 v[128:131], v[48:51], v[72:75], v[128:131]
    v_mfma_f32_16x16x32_bf16 v[132:135], v[48:51], v[76:79], v[132:135]
    v_mfma_f32_16x16x32_bf16 v[136:139], v[52:55], v[72:75], v[136:139]
    v_mfma_f32_16x16x32_bf16 v[140:143], v[52:55], v[76:79], v[140:143]
    v_mfma_f32_16x16x32_bf16 v[144:147], v[56:59], v[72:75], v[144:147]
    v_mfma_f32_16x16x32_bf16 v[148:151], v[56:59], v[76:79], v[148:151]
    v_mfma_f32_16x16x32_bf16 v[152:155], v[60:63], v[72:75], v[152:155]
    v_mfma_f32_16x16x32_bf16 v[156:159], v[60:63], v[76:79], v[156:159]
    s_waitcnt lgkmcnt(6)
    s_barrier
    ds_read_b128 v[48:51], v16 offset:0
    ds_read_b128 v[52:55], v16 offset:2048
    ds_read_b128 v[56:59], v16 offset:4096
    ds_read_b128 v[60:63], v16 offset:6144
    ds_read_b128 v[72:75], v18 offset:0
    ds_read_b128 v[76:79], v18 offset:2048
    buffer_load_dwordx4 a[48:51], v3, s[20:23], s60 offen
    v_add_u32 v3, 131072, v3
    buffer_load_dwordx4 a[52:55], v3, s[20:23], s60 offen
    v_add_u32 v3, 131072, v3
    buffer_load_dwordx4 a[56:59], v3, s[20:23], s60 offen
    v_add_u32 v3, 131072, v3
    buffer_load_dwordx4 a[60:63], v3, s[20:23], s60 offen
    v_subrev_u32 v3, 393216, v3
    buffer_load_dwordx4 a[64:67], v5, s[24:27], s61 offen
    v_add_u32 v5, 131072, v5
    buffer_load_dwordx4 a[68:71], v5, s[24:27], s61 offen
    v_subrev_u32 v5, 131072, v5
    s_add_u32 s60, s60, 128
    s_add_u32 s61, s61, 128
    s_waitcnt vmcnt(12) lgkmcnt(6)
    ds_write_b128 v6, a[0:3] offset:49152
    ds_write_b128 v6, a[4:7] offset:53248
    ds_write_b128 v6, a[8:11] offset:57344
    ds_write_b128 v6, a[12:15] offset:61440
    ds_write_b128 v19, a[16:19] offset:49152
    ds_write_b128 v19, a[20:23] offset:53248
    v_mfma_f32_16x16x32_bf16 v[128:131], v[32:35], v[64:67], v[128:131]
    v_mfma_f32_16x16x32_bf16 v[132:135], v[32:35], v[68:71], v[132:135]
    v_mfma_f32_16x16x32_bf16 v[136:139], v[36:39], v[64:67], v[136:139]
    v_mfma_f32_16x16x32_bf16 v[140:143], v[36:39], v[68:71], v[140:143]
    v_mfma_f32_16x16x32_bf16 v[144:147], v[40:43], v[64:67], v[144:147]
    v_mfma_f32_16x16x32_bf16 v[148:151], v[40:43], v[68:71], v[148:151]
    v_mfma_f32_16x16x32_bf16 v[152:155], v[44:47], v[64:67], v[152:155]
    v_mfma_f32_16x16x32_bf16 v[156:159], v[44:47], v[68:71], v[156:159]
    ds_read_b128 v[32:35], v14 offset:24576
    ds_read_b128 v[36:39], v14 offset:26624
    ds_read_b128 v[40:43], v14 offset:28672
    ds_read_b128 v[44:47], v14 offset:30720
    ds_read_b128 v[64:67], v17 offset:24576
    ds_read_b128 v[68:71], v17 offset:26624
    s_waitcnt lgkmcnt(12)
    v_mfma_f32_16x16x32_bf16 v[128:131], v[48:51], v[72:75], v[128:131]
    v_mfma_f32_16x16x32_bf16 v[132:135], v[48:51], v[76:79], v[132:135]
    v_mfma_f32_16x16x32_bf16 v[136:139], v[52:55], v[72:75], v[136:139]
    v_mfma_f32_16x16x32_bf16 v[140:143], v[52:55], v[76:79], v[140:143]
    v_mfma_f32_16x16x32_bf16 v[144:147], v[56:59], v[72:75], v[144:147]
    v_mfma_f32_16x16x32_bf16 v[148:151], v[56:59], v[76:79], v[148:151]
    v_mfma_f32_16x16x32_bf16 v[152:155], v[60:63], v[72:75], v[152:155]
    v_mfma_f32_16x16x32_bf16 v[156:159], v[60:63], v[76:79], v[156:159]
    s_waitcnt lgkmcnt(6)
    s_barrier
    ds_read_b128 v[48:51], v16 offset:24576
    ds_read_b128 v[52:55], v16 offset:26624
    ds_read_b128 v[56:59], v16 offset:28672
    ds_read_b128 v[60:63], v16 offset:30720
    ds_read_b128 v[72:75], v18 offset:24576
    ds_read_b128 v[76:79], v18 offset:26624
    buffer_load_dwordx4 a[72:75], v3, s[20:23], s60 offen
    v_add_u32 v3, 131072, v3
    buffer_load_dwordx4 a[76:79], v3, s[20:23], s60 offen
    v_add_u32 v3, 131072, v3
    buffer_load_dwordx4 a[80:83], v3, s[20:23], s60 offen
    v_add_u32 v3, 131072, v3
    buffer_load_dwordx4 a[84:87], v3, s[20:23], s60 offen
    v_subrev_u32 v3, 393216, v3
    buffer_load_dwordx4 a[88:91], v5, s[24:27], s61 offen
    v_add_u32 v5, 131072, v5
    buffer_load_dwordx4 a[92:95], v5, s[24:27], s61 offen
    v_subrev_u32 v5, 131072, v5
    s_add_u32 s60, s60, 128
    s_add_u32 s61, s61, 128
    s_waitcnt vmcnt(12) lgkmcnt(6)
    ds_write_b128 v6, a[24:27] offset:0
    ds_write_b128 v6, a[28:31] offset:4096
    ds_write_b128 v6, a[32:35] offset:8192
    ds_write_b128 v6, a[36:39] offset:12288
    ds_write_b128 v19, a[40:43] offset:0
    ds_write_b128 v19, a[44:47] offset:4096
    v_mfma_f32_16x16x32_bf16 v[128:131], v[32:35], v[64:67], v[128:131]
    v_mfma_f32_16x16x32_bf16 v[132:135], v[32:35], v[68:71], v[132:135]
    v_mfma_f32_16x16x32_bf16 v[136:139], v[36:39], v[64:67], v[136:139]
    v_mfma_f32_16x16x32_bf16 v[140:143], v[36:39], v[68:71], v[140:143]
    v_mfma_f32_16x16x32_bf16 v[144:147], v[40:43], v[64:67], v[144:147]
    v_mfma_f32_16x16x32_bf16 v[148:151], v[40:43], v[68:71], v[148:151]
    v_mfma_f32_16x16x32_bf16 v[152:155], v[44:47], v[64:67], v[152:155]
    v_mfma_f32_16x16x32_bf16 v[156:159], v[44:47], v[68:71], v[156:159]
    ds_read_b128 v[32:35], v14 offset:49152
    ds_read_b128 v[36:39], v14 offset:51200
    ds_read_b128 v[40:43], v14 offset:53248
    ds_read_b128 v[44:47], v14 offset:55296
    ds_read_b128 v[64:67], v17 offset:49152
    ds_read_b128 v[68:71], v17 offset:51200
    s_waitcnt lgkmcnt(12)
    v_mfma_f32_16x16x32_bf16 v[128:131], v[48:51], v[72:75], v[128:131]
    v_mfma_f32_16x16x32_bf16 v[132:135], v[48:51], v[76:79], v[132:135]
    v_mfma_f32_16x16x32_bf16 v[136:139], v[52:55], v[72:75], v[136:139]
    v_mfma_f32_16x16x32_bf16 v[140:143], v[52:55], v[76:79], v[140:143]
    v_mfma_f32_16x16x32_bf16 v[144:147], v[56:59], v[72:75], v[144:147]
    v_mfma_f32_16x16x32_bf16 v[148:151], v[56:59], v[76:79], v[148:151]
    v_mfma_f32_16x16x32_bf16 v[152:155], v[60:63], v[72:75], v[152:155]
    v_mfma_f32_16x16x32_bf16 v[156:159], v[60:63], v[76:79], v[156:159]
    s_waitcnt lgkmcnt(6)
    s_barrier
    s_waitcnt lgkmcnt(0)
    s_waitcnt vmcnt(0)
    s_nop 7
    s_nop 1
    s_lshl_b32 s12, s10, 6
    v_lshlrev_b32 v20, 5, v12
    v_add_u32 v20, v20, v8
    v_add_u32 v20, s12, v20
    v_lshlrev_b32 v21, 1, v20
    v_mul_u32_u24 v22, 1792, v20
    s_lshl_b32 s13, s11, 8
    v_lshlrev_b32 v23, 7, v11
    v_lshlrev_b32 v24, 3, v9
    v_add_u32 v23, v23, v24
    v_add_u32 v22, v22, v23
    v_add_u32 v22, s13, v22
    buffer_load_ushort v26, v21, s[28:31], 0 offen offset:0
    buffer_load_ushort v27, v21, s[28:31], 0 offen offset:32
    v_add_u32 v25, 0, v22
    buffer_load_dwordx2 v[64:65], v25, s[32:35], 0 offen offset:0
    v_add_u32 v25, 0, v22
    buffer_load_dwordx2 v[66:67], v25, s[32:35], 0 offen offset:32
    v_add_u32 v25, 0, v22
    buffer_load_dwordx2 v[68:69], v25, s[32:35], 0 offen offset:64
    v_add_u32 v25, 0, v22
    buffer_load_dwordx2 v[70:71], v25, s[32:35], 0 offen offset:96
    v_add_u32 v25, 28672, v22
    buffer_load_dwordx2 v[72:73], v25, s[32:35], 0 offen offset:0
    v_add_u32 v25, 28672, v22
    buffer_load_dwordx2 v[74:75], v25, s[32:35], 0 offen offset:32
    v_add_u32 v25, 28672, v22
    buffer_load_dwordx2 v[76:77], v25, s[32:35], 0 offen offset:64
    v_add_u32 v25, 28672, v22
    buffer_load_dwordx2 v[78:79], v25, s[32:35], 0 offen offset:96
    s_waitcnt vmcnt(0)
    v_lshlrev_b32 v26, 16, v26
    v_lshlrev_b32 v27, 16, v27
    v_cvt_pk_bf16_f32 v28, v128, v129
    v_lshlrev_b32 v29, 16, v28
    v_and_b32 v30, 0xffff0000, v28
    v_add_f32 v29, v29, v26
    v_add_f32 v30, v30, v26
    v_cvt_pk_bf16_f32 v28, v29, v30
    v_lshlrev_b32 v29, 16, v28
    v_and_b32 v30, 0xffff0000, v28
    v_lshlrev_b32 v31, 16, v64
    v_and_b32 v28, 0xffff0000, v64
    v_mul_f32 v29, v29, v31
    v_mul_f32 v30, v30, v28
    v_cvt_pk_bf16_f32 v64, v29, v30
    v_cvt_pk_bf16_f32 v28, v130, v131
    v_lshlrev_b32 v29, 16, v28
    v_and_b32 v30, 0xffff0000, v28
    v_add_f32 v29, v29, v26
    v_add_f32 v30, v30, v26
    v_cvt_pk_bf16_f32 v28, v29, v30
    v_lshlrev_b32 v29, 16, v28
    v_and_b32 v30, 0xffff0000, v28
    v_lshlrev_b32 v31, 16, v65
    v_and_b32 v28, 0xffff0000, v65
    v_mul_f32 v29, v29, v31
    v_mul_f32 v30, v30, v28
    v_cvt_pk_bf16_f32 v65, v29, v30
    v_add_u32 v25, 0, v22
    buffer_store_dwordx2 v[64:65], v25, s[36:39], 0 offen offset:0
    v_cvt_pk_bf16_f32 v28, v136, v137
    v_lshlrev_b32 v29, 16, v28
    v_and_b32 v30, 0xffff0000, v28
    v_add_f32 v29, v29, v26
    v_add_f32 v30, v30, v26
    v_cvt_pk_bf16_f32 v28, v29, v30
    v_lshlrev_b32 v29, 16, v28
    v_and_b32 v30, 0xffff0000, v28
    v_lshlrev_b32 v31, 16, v66
    v_and_b32 v28, 0xffff0000, v66
    v_mul_f32 v29, v29, v31
    v_mul_f32 v30, v30, v28
    v_cvt_pk_bf16_f32 v66, v29, v30
    v_cvt_pk_bf16_f32 v28, v138, v139
    v_lshlrev_b32 v29, 16, v28
    v_and_b32 v30, 0xffff0000, v28
    v_add_f32 v29, v29, v26
    v_add_f32 v30, v30, v26
    v_cvt_pk_bf16_f32 v28, v29, v30
    v_lshlrev_b32 v29, 16, v28
    v_and_b32 v30, 0xffff0000, v28
    v_lshlrev_b32 v31, 16, v67
    v_and_b32 v28, 0xffff0000, v67
    v_mul_f32 v29, v29, v31
    v_mul_f32 v30, v30, v28
    v_cvt_pk_bf16_f32 v67, v29, v30
    v_add_u32 v25, 0, v22
    buffer_store_dwordx2 v[66:67], v25, s[36:39], 0 offen offset:32
    v_cvt_pk_bf16_f32 v28, v144, v145
    v_lshlrev_b32 v29, 16, v28
    v_and_b32 v30, 0xffff0000, v28
    v_add_f32 v29, v29, v26
    v_add_f32 v30, v30, v26
    v_cvt_pk_bf16_f32 v28, v29, v30
    v_lshlrev_b32 v29, 16, v28
    v_and_b32 v30, 0xffff0000, v28
    v_lshlrev_b32 v31, 16, v68
    v_and_b32 v28, 0xffff0000, v68
    v_mul_f32 v29, v29, v31
    v_mul_f32 v30, v30, v28
    v_cvt_pk_bf16_f32 v68, v29, v30
    v_cvt_pk_bf16_f32 v28, v146, v147
    v_lshlrev_b32 v29, 16, v28
    v_and_b32 v30, 0xffff0000, v28
    v_add_f32 v29, v29, v26
    v_add_f32 v30, v30, v26
    v_cvt_pk_bf16_f32 v28, v29, v30
    v_lshlrev_b32 v29, 16, v28
    v_and_b32 v30, 0xffff0000, v28
    v_lshlrev_b32 v31, 16, v69
    v_and_b32 v28, 0xffff0000, v69
    v_mul_f32 v29, v29, v31
    v_mul_f32 v30, v30, v28
    v_cvt_pk_bf16_f32 v69, v29, v30
    v_add_u32 v25, 0, v22
    buffer_store_dwordx2 v[68:69], v25, s[36:39], 0 offen offset:64
    v_cvt_pk_bf16_f32 v28, v152, v153
    v_lshlrev_b32 v29, 16, v28
    v_and_b32 v30, 0xffff0000, v28
    v_add_f32 v29, v29, v26
    v_add_f32 v30, v30, v26
    v_cvt_pk_bf16_f32 v28, v29, v30
    v_lshlrev_b32 v29, 16, v28
    v_and_b32 v30, 0xffff0000, v28
    v_lshlrev_b32 v31, 16, v70
    v_and_b32 v28, 0xffff0000, v70
    v_mul_f32 v29, v29, v31
    v_mul_f32 v30, v30, v28
    v_cvt_pk_bf16_f32 v70, v29, v30
    v_cvt_pk_bf16_f32 v28, v154, v155
    v_lshlrev_b32 v29, 16, v28
    v_and_b32 v30, 0xffff0000, v28
    v_add_f32 v29, v29, v26
    v_add_f32 v30, v30, v26
    v_cvt_pk_bf16_f32 v28, v29, v30
    v_lshlrev_b32 v29, 16, v28
    v_and_b32 v30, 0xffff0000, v28
    v_lshlrev_b32 v31, 16, v71
    v_and_b32 v28, 0xffff0000, v71
    v_mul_f32 v29, v29, v31
    v_mul_f32 v30, v30, v28
    v_cvt_pk_bf16_f32 v71, v29, v30
    v_add_u32 v25, 0, v22
    buffer_store_dwordx2 v[70:71], v25, s[36:39], 0 offen offset:96
    v_cvt_pk_bf16_f32 v28, v132, v133
    v_lshlrev_b32 v29, 16, v28
    v_and_b32 v30, 0xffff0000, v28
    v_add_f32 v29, v29, v27
    v_add_f32 v30, v30, v27
    v_cvt_pk_bf16_f32 v28, v29, v30
    v_lshlrev_b32 v29, 16, v28
    v_and_b32 v30, 0xffff0000, v28
    v_lshlrev_b32 v31, 16, v72
    v_and_b32 v28, 0xffff0000, v72
    v_mul_f32 v29, v29, v31
    v_mul_f32 v30, v30, v28
    v_cvt_pk_bf16_f32 v72, v29, v30
    v_cvt_pk_bf16_f32 v28, v134, v135
    v_lshlrev_b32 v29, 16, v28
    v_and_b32 v30, 0xffff0000, v28
    v_add_f32 v29, v29, v27
    v_add_f32 v30, v30, v27
    v_cvt_pk_bf16_f32 v28, v29, v30
    v_lshlrev_b32 v29, 16, v28
    v_and_b32 v30, 0xffff0000, v28
    v_lshlrev_b32 v31, 16, v73
    v_and_b32 v28, 0xffff0000, v73
    v_mul_f32 v29, v29, v31
    v_mul_f32 v30, v30, v28
    v_cvt_pk_bf16_f32 v73, v29, v30
    v_add_u32 v25, 28672, v22
    buffer_store_dwordx2 v[72:73], v25, s[36:39], 0 offen offset:0
    v_cvt_pk_bf16_f32 v28, v140, v141
    v_lshlrev_b32 v29, 16, v28
    v_and_b32 v30, 0xffff0000, v28
    v_add_f32 v29, v29, v27
    v_add_f32 v30, v30, v27
    v_cvt_pk_bf16_f32 v28, v29, v30
    v_lshlrev_b32 v29, 16, v28
    v_and_b32 v30, 0xffff0000, v28
    v_lshlrev_b32 v31, 16, v74
    v_and_b32 v28, 0xffff0000, v74
    v_mul_f32 v29, v29, v31
    v_mul_f32 v30, v30, v28
    v_cvt_pk_bf16_f32 v74, v29, v30
    v_cvt_pk_bf16_f32 v28, v142, v143
    v_lshlrev_b32 v29, 16, v28
    v_and_b32 v30, 0xffff0000, v28
    v_add_f32 v29, v29, v27
    v_add_f32 v30, v30, v27
    v_cvt_pk_bf16_f32 v28, v29, v30
    v_lshlrev_b32 v29, 16, v28
    v_and_b32 v30, 0xffff0000, v28
    v_lshlrev_b32 v31, 16, v75
    v_and_b32 v28, 0xffff0000, v75
    v_mul_f32 v29, v29, v31
    v_mul_f32 v30, v30, v28
    v_cvt_pk_bf16_f32 v75, v29, v30
    v_add_u32 v25, 28672, v22
    buffer_store_dwordx2 v[74:75], v25, s[36:39], 0 offen offset:32
    v_cvt_pk_bf16_f32 v28, v148, v149
    v_lshlrev_b32 v29, 16, v28
    v_and_b32 v30, 0xffff0000, v28
    v_add_f32 v29, v29, v27
    v_add_f32 v30, v30, v27
    v_cvt_pk_bf16_f32 v28, v29, v30
    v_lshlrev_b32 v29, 16, v28
    v_and_b32 v30, 0xffff0000, v28
    v_lshlrev_b32 v31, 16, v76
    v_and_b32 v28, 0xffff0000, v76
    v_mul_f32 v29, v29, v31
    v_mul_f32 v30, v30, v28
    v_cvt_pk_bf16_f32 v76, v29, v30
    v_cvt_pk_bf16_f32 v28, v150, v151
    v_lshlrev_b32 v29, 16, v28
    v_and_b32 v30, 0xffff0000, v28
    v_add_f32 v29, v29, v27
    v_add_f32 v30, v30, v27
    v_cvt_pk_bf16_f32 v28, v29, v30
    v_lshlrev_b32 v29, 16, v28
    v_and_b32 v30, 0xffff0000, v28
    v_lshlrev_b32 v31, 16, v77
    v_and_b32 v28, 0xffff0000, v77
    v_mul_f32 v29, v29, v31
    v_mul_f32 v30, v30, v28
    v_cvt_pk_bf16_f32 v77, v29, v30
    v_add_u32 v25, 28672, v22
    buffer_store_dwordx2 v[76:77], v25, s[36:39], 0 offen offset:64
    v_cvt_pk_bf16_f32 v28, v156, v157
    v_lshlrev_b32 v29, 16, v28
    v_and_b32 v30, 0xffff0000, v28
    v_add_f32 v29, v29, v27
    v_add_f32 v30, v30, v27
    v_cvt_pk_bf16_f32 v28, v29, v30
    v_lshlrev_b32 v29, 16, v28
    v_and_b32 v30, 0xffff0000, v28
    v_lshlrev_b32 v31, 16, v78
    v_and_b32 v28, 0xffff0000, v78
    v_mul_f32 v29, v29, v31
    v_mul_f32 v30, v30, v28
    v_cvt_pk_bf16_f32 v78, v29, v30
    v_cvt_pk_bf16_f32 v28, v158, v159
    v_lshlrev_b32 v29, 16, v28
    v_and_b32 v30, 0xffff0000, v28
    v_add_f32 v29, v29, v27
    v_add_f32 v30, v30, v27
    v_cvt_pk_bf16_f32 v28, v29, v30
    v_lshlrev_b32 v29, 16, v28
    v_and_b32 v30, 0xffff0000, v28
    v_lshlrev_b32 v31, 16, v79
    v_and_b32 v28, 0xffff0000, v79
    v_mul_f32 v29, v29, v31
    v_mul_f32 v30, v30, v28
    v_cvt_pk_bf16_f32 v79, v29, v30
    v_add_u32 v25, 28672, v22
    buffer_store_dwordx2 v[78:79], v25, s[36:39], 0 offen offset:96
K3_end_15:
    s_endpgm
.globl outp_kernel
.p2align 8
.type outp_kernel,@function
outp_kernel:
    s_cmp_ge_u32 s2, 224
    s_cbranch_scc1 K4_end_16
    s_load_dwordx2 s[4:5], s[0:1], 104
    s_load_dwordx2 s[8:9], s[0:1], 120
    s_waitcnt lgkmcnt(0)
    s_add_u32 s20, s8, 8454144
    s_addc_u32 s21, s9, 0
    s_mov_b32 s22, 802816
    s_mov_b32 s23, 0x00020000
    s_add_u32 s24, s8, 18939904
    s_addc_u32 s25, s9, 0
    s_mov_b32 s26, 3670016
    s_mov_b32 s27, 0x00020000
    s_mov_b32 s28, s8
    s_mov_b32 s29, s9
    s_mov_b32 s30, 10752
    s_mov_b32 s31, 0x00020000
    s_add_u32 s32, s8, 4259840
    s_addc_u32 s33, s9, 0
    s_mov_b32 s34, 1835008
    s_mov_b32 s35, 0x00020000
    s_mov_b32 s36, s4
    s_mov_b32 s37, s5
    s_mov_b32 s38, 1835008
    s_mov_b32 s39, 0x00020000
    s_lshr_b32 s14, s2, 3
    s_mul_hi_u32 s10, s14, 0x24924925
    s_mul_i32 s11, s10, 7
    s_sub_u32 s11, s14, s11
    s_and_b32 s14, s2, 7
    s_lshl_b32 s14, s14, 2
    s_add_u32 s10, s10, s14
    s_mul_i32 s60, s11, 114688
    s_mul_i32 s61, s10, 114688
    v_lshrrev_b32 v1, 3, v0
    v_and_b32 v2, 7, v0
    v_mul_u32_u24 v3, 1792, v1
    v_lshlrev_b32 v4, 4, v2
    v_add_u32 v3, v3, v4
    v_mul_u32_u24 v5, 1792, v1
    v_add_u32 v5, v5, v4
    v_xor_b32 v6, v2, v1
    v_and_b32 v6, 7, v6
    v_lshlrev_b32 v6, 4, v6
    v_lshlrev_b32 v7, 7, v1
    v_add_u32 v6, v6, v7
    v_add_u32 v19, 8192, v6
    v_and_b32 v8, 15, v0
    v_lshrrev_b32 v9, 4, v0
    v_and_b32 v9, 3, v9
    v_lshrrev_b32 v10, 6, v0
    v_lshrrev_b32 v11, 1, v10
    v_and_b32 v12, 1, v10
    v_and_b32 v13, 7, v8
    v_xor_b32 v13, v13, v9
    v_lshlrev_b32 v13, 4, v13
    v_mul_u32_u24 v14, 4096, v11
    v_lshlrev_b32 v15, 7, v8
    v_add_u32 v14, v14, v15
    v_add_u32 v14, v14, v13
    v_xor_b32 v16, 64, v14
    v_mul_u32_u24 v17, 4096, v12
    v_add_u32 v17, v17, v15
    v_add_u32 v17, v17, v13
    v_add_u32 v17, 8192, v17
    v_xor_b32 v18, 64, v17
    v_mov_b32 v128, 0
    v_mov_b32 v129, 0
    v_mov_b32 v130, 0
    v_mov_b32 v131, 0
    v_mov_b32 v132, 0
    v_mov_b32 v133, 0
    v_mov_b32 v134, 0
    v_mov_b32 v135, 0
    v_mov_b32 v136, 0
    v_mov_b32 v137, 0
    v_mov_b32 v138, 0
    v_mov_b32 v139, 0
    v_mov_b32 v140, 0
    v_mov_b32 v141, 0
    v_mov_b32 v142, 0
    v_mov_b32 v143, 0
    buffer_load_dwordx4 a[0:3], v3, s[20:23], s60 offen
    v_add_u32 v3, 57344, v3
    buffer_load_dwordx4 a[4:7], v3, s[20:23], s60 offen
    v_subrev_u32 v3, 57344, v3
    buffer_load_dwordx4 a[8:11], v5, s[24:27], s61 offen
    v_add_u32 v5, 57344, v5
    buffer_load_dwordx4 a[12:15], v5, s[24:27], s61 offen
    v_subrev_u32 v5, 57344, v5
    s_add_u32 s60, s60, 128
    s_add_u32 s61, s61, 128
    buffer_load_dwordx4 a[16:19], v3, s[20:23], s60 offen
    v_add_u32 v3, 57344, v3
    buffer_load_dwordx4 a[20:23], v3, s[20:23], s60 offen
    v_subrev_u32 v3, 57344, v3
    buffer_load_dwordx4 a[24:27], v5, s[24:27], s61 offen
    v_add_u32 v5, 57344, v5
    buffer_load_dwordx4 a[28:31], v5, s[24:27], s61 offen
    v_subrev_u32 v5, 57344, v5
    s_add_u32 s60, s60, 128
    s_add_u32 s61, s61, 128
    buffer_load_dwordx4 a[32:35], v3, s[20:23], s60 offen
    v_add_u32 v3, 57344, v3
    buffer_load_dwordx4 a[36:39], v3, s[20:23], s60 offen
    v_subrev_u32 v3, 57344, v3
    buffer_load_dwordx4 a[40:43], v5, s[24:27], s61 offen
    v_add_u32 v5, 57344, v5
    buffer_load_dwordx4 a[44:47], v5, s[24:27], s61 offen
    v_subrev_u32 v5, 57344, v5
    s_add_u32 s60, s60, 128
    s_add_u32 s61, s61, 128
    buffer_load_dwordx4 a[48:51], v3, s[20:23], s60 offen
    v_add_u32 v3, 57344, v3
    buffer_load_dwordx4 a[52:55], v3, s[20:23], s60 offen
    v_subrev_u32 v3, 57344, v3
    buffer_load_dwordx4 a[56:59], v5, s[24:27], s61 offen
    v_add_u32 v5, 57344, v5
    buffer_load_dwordx4 a[60:63], v5, s[24:27], s61 offen
    v_subrev_u32 v5, 57344, v5
    s_add_u32 s60, s60, 128
    s_add_u32 s61, s61, 128
    s_waitcnt vmcnt(8)
    ds_write_b128 v6, a[0:3] offset:0
    ds_write_b128 v6, a[4:7] offset:4096
    ds_write_b128 v19, a[8:11] offset:0
    ds_write_b128 v19, a[12:15] offset:4096
    ds_write_b128 v6, a[16:19] offset:16384
    ds_write_b128 v6, a[20:23] offset:20480
    ds_write_b128 v19, a[24:27] offset:16384
    ds_write_b128 v19, a[28:31] offset:20480
    s_waitcnt lgkmcnt(0)
    s_barrier
    ds_read_b128 v[32:35], v14 offset:0
    ds_read_b128 v[36:39], v14 offset:2048
    ds_read_b128 v[48:51], v17 offset:0
    ds_read_b128 v[52:55], v17 offset:2048
    ds_read_b128 v[40:43], v16 offset:0
    ds_read_b128 v[44:47], v16 offset:2048
    ds_read_b128 v[56:59], v18 offset:0
    ds_read_b128 v[60:63], v18 offset:2048
    buffer_load_dwordx4 a[0:3], v3, s[20:23], s60 offen
    v_add_u32 v3, 57344, v3
    buffer_load_dwordx4 a[4:7], v3, s[20:23], s60 offen
    v_subrev_u32 v3, 57344, v3
    buffer_load_dwordx4 a[8:11], v5, s[24:27], s61 offen
    v_add_u32 v5, 57344, v5
    buffer_load_dwordx4 a[12:15], v5, s[24:27], s61 offen
    v_subrev_u32 v5, 57344, v5
    s_add_u32 s60, s60, 128
    s_add_u32 s61, s61, 128
    s_waitcnt vmcnt(8) lgkmcnt(4)
    ds_write_b128 v6, a[32:35] offset:32768
    ds_write_b128 v6, a[36:39] offset:36864
    ds_write_b128 v19, a[40:43] offset:32768
    ds_write_b128 v19, a[44:47] offset:36864
    v_mfma_f32_16x16x32_bf16 v[128:131], v[32:35], v[48:51], v[128:131]
    v_mfma_f32_16x16x32_bf16 v[132:135], v[32:35], v[52:55], v[132:135]
    v_mfma_f32_16x16x32_bf16 v[136:139], v[36:39], v[48:51], v[136:139]
    v_mfma_f32_16x16x32_bf16 v[140:143], v[36:39], v[52:55], v[140:143]
    ds_read_b128 v[32:35], v14 offset:16384
    ds_read_b128 v[36:39], v14 offset:18432
    ds_read_b128 v[48:51], v17 offset:16384
    ds_read_b128 v[52:55], v17 offset:18432
    s_waitcnt lgkmcnt(8)
    v_mfma_f32_16x16x32_bf16 v[128:131], v[40:43], v[56:59], v[128:131]
    v_mfma_f32_16x16x32_bf16 v[132:135], v[40:43], v[60:63], v[132:135]
    v_mfma_f32_16x16x32_bf16 v[136:139], v[44:47], v[56:59], v[136:139]
    v_mfma_f32_16x16x32_bf16 v[140:143], v[44:47], v[60:63], v[140:143]
    s_waitcnt lgkmcnt(4)
    s_barrier
    ds_read_b128 v[40:43], v16 offset:16384
    ds_read_b128 v[44:47], v16 offset:18432
    ds_read_b128 v[56:59], v18 offset:16384
    ds_read_b128 v[60:63], v18 offset:18432
    buffer_load_dwordx4 a[16:19], v3, s[20:23], s60 offen
    v_add_u32 v3, 57344, v3
    buffer_load_dwordx4 a[20:23], v3, s[20:23], s60 offen
    v_subrev_u32 v3, 57344, v3
    buffer_load_dwordx4 a[24:27], v5, s[24:27], s61 offen
    v_add_u32 v5, 57344, v5
    buffer_load_dwordx4 a[28:31], v5, s[24:27], s61 offen
    v_subrev_u32 v5, 57344, v5
    s_add_u32 s60, s60, 128
    s_add_u32 s61, s61, 128
    s_waitcnt vmcnt(8) lgkmcnt(4)
    ds_write_b128 v6, a[48:51] offset:0
    ds_write_b128 v6, a[52:55] offset:4096
    ds_write_b128 v19, a[56:59] offset:0
    ds_write_b128 v19, a[60:63] offset:4096
    v_mfma_f32_16x16x32_bf16 v[128:131], v[32:35], v[48:51], v[128:131]
    v_mfma_f32_16x16x32_bf16 v[132:135], v[32:35], v[52:55], v[132:135]
    v_mfma_f32_16x16x32_bf16 v[136:139], v[36:39], v[48:51], v[136:139]
    v_mfma_f32_16x16x32_bf16 v[140:143], v[36:39], v[52:55], v[140:143]
    ds_read_b128 v[32:35], v14 offset:32768
    ds_read_b128 v[36:39], v14 offset:34816
    ds_read_b128 v[48:51], v17 offset:32768
    ds_read_b128 v[52:55], v17 offset:34816
    s_waitcnt lgkmcnt(8)
    v_mfma_f32_16x16x32_bf16 v[128:131], v[40:43], v[56:59], v[128:131]
    v_mfma_f32_16x16x32_bf16 v[132:135], v[40:43], v[60:63], v[132:135]
    v_mfma_f32_16x16x32_bf16 v[136:139], v[44:47], v[56:59], v[136:139]
    v_mfma_f32_16x16x32_bf16 v[140:143], v[44:47], v[60:63], v[140:143]
    s_waitcnt lgkmcnt(4)
    s_barrier
    ds_read_b128 v[40:43], v16 offset:32768
    ds_read_b128 v[44:47], v16 offset:34816
    ds_read_b128 v[56:59], v18 offset:32768
    ds_read_b128 v[60:63], v18 offset:34816
    buffer_load_dwordx4 a[32:35], v3, s[20:23], s60 offen
    v_add_u32 v3, 57344, v3
    buffer_load_dwordx4 a[36:39], v3, s[20:23], s60 offen
    v_subrev_u32 v3, 57344, v3
    buffer_load_dwordx4 a[40:43], v5, s[24:27], s61 offen
    v_add_u32 v5, 57344, v5
    buffer_load_dwordx4 a[44:47], v5, s[24:27], s61 offen
    v_subrev_u32 v5, 57344, v5
    s_add_u32 s60, s60, 128
    s_add_u32 s61, s61, 128
    s_waitcnt vmcnt(8) lgkmcnt(4)
    ds_write_b128 v6, a[0:3] offset:16384
    ds_write_b128 v6, a[4:7] offset:20480
    ds_write_b128 v19, a[8:11] offset:16384
    ds_write_b128 v19, a[12:15] offset:20480
    v_mfma_f32_16x16x32_bf16 v[128:131], v[32:35], v[48:51], v[128:131]
    v_mfma_f32_16x16x32_bf16 v[132:135], v[32:35], v[52:55], v[132:135]
    v_mfma_f32_16x16x32_bf16 v[136:139], v[36:39], v[48:51], v[136:139]
    v_mfma_f32_16x16x32_bf16 v[140:143], v[36:39], v[52:55], v[140:143]
    ds_read_b128 v[32:35], v14 offset:0
    ds_read_b128 v[36:39], v14 offset:2048
    ds_read_b128 v[48:51], v17 offset:0
    ds_read_b128 v[52:55], v17 offset:2048
    s_waitcnt lgkmcnt(8)
    v_mfma_f32_16x16x32_bf16 v[128:131], v[40:43], v[56:59], v[128:131]
    v_mfma_f32_16x16x32_bf16 v[132:135], v[40:43], v[60:63], v[132:135]
    v_mfma_f32_16x16x32_bf16 v[136:139], v[44:47], v[56:59], v[136:139]
    v_mfma_f32_16x16x32_bf16 v[140:143], v[44:47], v[60:63], v[140:143]
    s_waitcnt lgkmcnt(4)
    s_barrier
    ds_read_b128 v[40:43], v16 offset:0
    ds_read_b128 v[44:47], v16 offset:2048
    ds_read_b128 v[56:59], v18 offset:0
    ds_read_b128 v[60:63], v18 offset:2048
    buffer_load_dwordx4 a[48:51], v3, s[20:23], s60 offen
    v_add_u32 v3, 57344, v3
    buffer_load_dwordx4 a[52:55], v3, s[20:23], s60 offen
    v_subrev_u32 v3, 57344, v3
    buffer_load_dwordx4 a[56:59], v5, s[24:27], s61 offen
    v_add_u32 v5, 57344, v5
    buffer_load_dwordx4 a[60:63], v5, s[24:27], s61 offen
    v_subrev_u32 v5, 57344, v5
    s_add_u32 s60, s60, 128
    s_add_u32 s61, s61, 128
    s_waitcnt vmcnt(8) lgkmcnt(4)
    ds_write_b128 v6, a[16:19] offset:32768
    ds_write_b128 v6, a[20:23] offset:36864
    ds_write_b128 v19, a[24:27] offset:32768
    ds_write_b128 v19, a[28:31] offset:36864
    v_mfma_f32_16x16x32_bf16 v[128:131], v[32:35], v[48:51], v[128:131]
    v_mfma_f32_16x16x32_bf16 v[132:135], v[32:35], v[52:55], v[132:135]
    v_mfma_f32_16x16x32_bf16 v[136:139], v[36:39], v[48:51], v[136:139]
    v_mfma_f32_16x16x32_bf16 v[140:143], v[36:39], v[52:55], v[140:143]
    ds_read_b128 v[32:35], v14 offset:16384
    ds_read_b128 v[36:39], v14 offset:18432
    ds_read_b128 v[48:51], v17 offset:16384
    ds_read_b128 v[52:55], v17 offset:18432
    s_waitcnt lgkmcnt(8)
    v_mfma_f32_16x16x32_bf16 v[128:131], v[40:43], v[56:59], v[128:131]
    v_mfma_f32_16x16x32_bf16 v[132:135], v[40:43], v[60:63], v[132:135]
    v_mfma_f32_16x16x32_bf16 v[136:139], v[44:47], v[56:59], v[136:139]
    v_mfma_f32_16x16x32_bf16 v[140:143], v[44:47], v[60:63], v[140:143]
    s_waitcnt lgkmcnt(4)
    s_barrier
    ds_read_b128 v[40:43], v16 offset:16384
    ds_read_b128 v[44:47], v16 offset:18432
    ds_read_b128 v[56:59], v18 offset:16384
    ds_read_b128 v[60:63], v18 offset:18432
    buffer_load_dwordx4 a[0:3], v3, s[20:23], s60 offen
    v_add_u32 v3, 57344, v3
    buffer_load_dwordx4 a[4:7], v3, s[20:23], s60 offen
    v_subrev_u32 v3, 57344, v3
    buffer_load_dwordx4 a[8:11], v5, s[24:27], s61 offen
    v_add_u32 v5, 57344, v5
    buffer_load_dwordx4 a[12:15], v5, s[24:27], s61 offen
    v_subrev_u32 v5, 57344, v5
    s_add_u32 s60, s60, 128
    s_add_u32 s61, s61, 128
    s_waitcnt vmcnt(8) lgkmcnt(4)
    ds_write_b128 v6, a[32:35] offset:0
    ds_write_b128 v6, a[36:39] offset:4096
    ds_write_b128 v19, a[40:43] offset:0
    ds_write_b128 v19, a[44:47] offset:4096
    v_mfma_f32_16x16x32_bf16 v[128:131], v[32:35], v[48:51], v[128:131]
    v_mfma_f32_16x16x32_bf16 v[132:135], v[32:35], v[52:55], v[132:135]
    v_mfma_f32_16x16x32_bf16 v[136:139], v[36:39], v[48:51], v[136:139]
    v_mfma_f32_16x16x32_bf16 v[140:143], v[36:39], v[52:55], v[140:143]
    ds_read_b128 v[32:35], v14 offset:32768
    ds_read_b128 v[36:39], v14 offset:34816
    ds_read_b128 v[48:51], v17 offset:32768
    ds_read_b128 v[52:55], v17 offset:34816
    s_waitcnt lgkmcnt(8)
    v_mfma_f32_16x16x32_bf16 v[128:131], v[40:43], v[56:59], v[128:131]
    v_mfma_f32_16x16x32_bf16 v[132:135], v[40:43], v[60:63], v[132:135]
    v_mfma_f32_16x16x32_bf16 v[136:139], v[44:47], v[56:59], v[136:139]
    v_mfma_f32_16x16x32_bf16 v[140:143], v[44:47], v[60:63], v[140:143]
    s_waitcnt lgkmcnt(4)
    s_barrier
    ds_read_b128 v[40:43], v16 offset:32768
    ds_read_b128 v[44:47], v16 offset:34816
    ds_read_b128 v[56:59], v18 offset:32768
    ds_read_b128 v[60:63], v18 offset:34816
    buffer_load_dwordx4 a[16:19], v3, s[20:23], s60 offen
    v_add_u32 v3, 57344, v3
    buffer_load_dwordx4 a[20:23], v3, s[20:23], s60 offen
    v_subrev_u32 v3, 57344, v3
    buffer_load_dwordx4 a[24:27], v5, s[24:27], s61 offen
    v_add_u32 v5, 57344, v5
    buffer_load_dwordx4 a[28:31], v5, s[24:27], s61 offen
    v_subrev_u32 v5, 57344, v5
    s_add_u32 s60, s60, 128
    s_add_u32 s61, s61, 128
    s_waitcnt vmcnt(8) lgkmcnt(4)
    ds_write_b128 v6, a[48:51] offset:16384
    ds_write_b128 v6, a[52:55] offset:20480
    ds_write_b128 v19, a[56:59] offset:16384
    ds_write_b128 v19, a[60:63] offset:20480
    v_mfma_f32_16x16x32_bf16 v[128:131], v[32:35], v[48:51], v[128:131]
    v_mfma_f32_16x16x32_bf16 v[132:135], v[32:35], v[52:55], v[132:135]
    v_mfma_f32_16x16x32_bf16 v[136:139], v[36:39], v[48:51], v[136:139]
    v_mfma_f32_16x16x32_bf16 v[140:143], v[36:39], v[52:55], v[140:143]
    ds_read_b128 v[32:35], v14 offset:0
    ds_read_b128 v[36:39], v14 offset:2048
    ds_read_b128 v[48:51], v17 offset:0
    ds_read_b128 v[52:55], v17 offset:2048
    s_waitcnt lgkmcnt(8)
    v_mfma_f32_16x16x32_bf16 v[128:131], v[40:43], v[56:59], v[128:131]
    v_mfma_f32_16x16x32_bf16 v[132:135], v[40:43], v[60:63], v[132:135]
    v_mfma_f32_16x16x32_bf16 v[136:139], v[44:47], v[56:59], v[136:139]
    v_mfma_f32_16x16x32_bf16 v[140:143], v[44:47], v[60:63], v[140:143]
    s_waitcnt lgkmcnt(4)
    s_barrier
    ds_read_b128 v[40:43], v16 offset:0
    ds_read_b128 v[44:47], v16 offset:2048
    ds_read_b128 v[56:59], v18 offset:0
    ds_read_b128 v[60:63], v18 offset:2048
    buffer_load_dwordx4 a[32:35], v3, s[20:23], s60 offen
    v_add_u32 v3, 57344, v3
    buffer_load_dwordx4 a[36:39], v3, s[20:23], s60 offen
    v_subrev_u32 v3, 57344, v3
    buffer_load_dwordx4 a[40:43], v5, s[24:27], s61 offen
    v_add_u32 v5, 57344, v5
    buffer_load_dwordx4 a[44:47], v5, s[24:27], s61 offen
    v_subrev_u32 v5, 57344, v5
    s_add_u32 s60, s60, 128
    s_add_u32 s61, s61, 128
    s_waitcnt vmcnt(8) lgkmcnt(4)
    ds_write_b128 v6, a[0:3] offset:32768
    ds_write_b128 v6, a[4:7] offset:36864
    ds_write_b128 v19, a[8:11] offset:32768
    ds_write_b128 v19, a[12:15] offset:36864
    v_mfma_f32_16x16x32_bf16 v[128:131], v[32:35], v[48:51], v[128:131]
    v_mfma_f32_16x16x32_bf16 v[132:135], v[32:35], v[52:55], v[132:135]
    v_mfma_f32_16x16x32_bf16 v[136:139], v[36:39], v[48:51], v[136:139]
    v_mfma_f32_16x16x32_bf16 v[140:143], v[36:39], v[52:55], v[140:143]
    ds_read_b128 v[32:35], v14 offset:16384
    ds_read_b128 v[36:39], v14 offset:18432
    ds_read_b128 v[48:51], v17 offset:16384
    ds_read_b128 v[52:55], v17 offset:18432
    s_waitcnt lgkmcnt(8)
    v_mfma_f32_16x16x32_bf16 v[128:131], v[40:43], v[56:59], v[128:131]
    v_mfma_f32_16x16x32_bf16 v[132:135], v[40:43], v[60:63], v[132:135]
    v_mfma_f32_16x16x32_bf16 v[136:139], v[44:47], v[56:59], v[136:139]
    v_mfma_f32_16x16x32_bf16 v[140:143], v[44:47], v[60:63], v[140:143]
    s_waitcnt lgkmcnt(4)
    s_barrier
    ds_read_b128 v[40:43], v16 offset:16384
    ds_read_b128 v[44:47], v16 offset:18432
    ds_read_b128 v[56:59], v18 offset:16384
    ds_read_b128 v[60:63], v18 offset:18432
    buffer_load_dwordx4 a[48:51], v3, s[20:23], s60 offen
    v_add_u32 v3, 57344, v3
    buffer_load_dwordx4 a[52:55], v3, s[20:23], s60 offen
    v_subrev_u32 v3, 57344, v3
    buffer_load_dwordx4 a[56:59], v5, s[24:27], s61 offen
    v_add_u32 v5, 57344, v5
    buffer_load_dwordx4 a[60:63], v5, s[24:27], s61 offen
    v_subrev_u32 v5, 57344, v5
    s_add_u32 s60, s60, 128
    s_add_u32 s61, s61, 128
    s_waitcnt vmcnt(8) lgkmcnt(4)
    ds_write_b128 v6, a[16:19] offset:0
    ds_write_b128 v6, a[20:23] offset:4096
    ds_write_b128 v19, a[24:27] offset:0
    ds_write_b128 v19, a[28:31] offset:4096
    v_mfma_f32_16x16x32_bf16 v[128:131], v[32:35], v[48:51], v[128:131]
    v_mfma_f32_16x16x32_bf16 v[132:135], v[32:35], v[52:55], v[132:135]
    v_mfma_f32_16x16x32_bf16 v[136:139], v[36:39], v[48:51], v[136:139]
    v_mfma_f32_16x16x32_bf16 v[140:143], v[36:39], v[52:55], v[140:143]
    ds_read_b128 v[32:35], v14 offset:32768
    ds_read_b128 v[36:39], v14 offset:34816
    ds_read_b128 v[48:51], v17 offset:32768
    ds_read_b128 v[52:55], v17 offset:34816
    s_waitcnt lgkmcnt(8)
    v_mfma_f32_16x16x32_bf16 v[128:131], v[40:43], v[56:59], v[128:131]
    v_mfma_f32_16x16x32_bf16 v[132:135], v[40:43], v[60:63], v[132:135]
    v_mfma_f32_16x16x32_bf16 v[136:139], v[44:47], v[56:59], v[136:139]
    v_mfma_f32_16x16x32_bf16 v[140:143], v[44:47], v[60:63], v[140:143]
    s_waitcnt lgkmcnt(4)
    s_barrier
    ds_read_b128 v[40:43], v16 offset:32768
    ds_read_b128 v[44:47], v16 offset:34816
    ds_read_b128 v[56:59], v18 offset:32768
    ds_read_b128 v[60:63], v18 offset:34816
    buffer_load_dwordx4 a[0:3], v3, s[20:23], s60 offen
    v_add_u32 v3, 57344, v3
    buffer_load_dwordx4 a[4:7], v3, s[20:23], s60 offen
    v_subrev_u32 v3, 57344, v3
    buffer_load_dwordx4 a[8:11], v5, s[24:27], s61 offen
    v_add_u32 v5, 57344, v5
    buffer_load_dwordx4 a[12:15], v5, s[24:27], s61 offen
    v_subrev_u32 v5, 57344, v5
    s_add_u32 s60, s60, 128
    s_add_u32 s61, s61, 128
    s_waitcnt vmcnt(8) lgkmcnt(4)
    ds_write_b128 v6, a[32:35] offset:16384
    ds_write_b128 v6, a[36:39] offset:20480
    ds_write_b128 v19, a[40:43] offset:16384
    ds_write_b128 v19, a[44:47] offset:20480
    v_mfma_f32_16x16x32_bf16 v[128:131], v[32:35], v[48:51], v[128:131]
    v_mfma_f32_16x16x32_bf16 v[132:135], v[32:35], v[52:55], v[132:135]
    v_mfma_f32_16x16x32_bf16 v[136:139], v[36:39], v[48:51], v[136:139]
    v_mfma_f32_16x16x32_bf16 v[140:143], v[36:39], v[52:55], v[140:143]
    ds_read_b128 v[32:35], v14 offset:0
    ds_read_b128 v[36:39], v14 offset:2048
    ds_read_b128 v[48:51], v17 offset:0
    ds_read_b128 v[52:55], v17 offset:2048
    s_waitcnt lgkmcnt(8)
    v_mfma_f32_16x16x32_bf16 v[128:131], v[40:43], v[56:59], v[128:131]
    v_mfma_f32_16x16x32_bf16 v[132:135], v[40:43], v[60:63], v[132:135]
    v_mfma_f32_16x16x32_bf16 v[136:139], v[44:47], v[56:59], v[136:139]
    v_mfma_f32_16x16x32_bf16 v[140:143], v[44:47], v[60:63], v[140:143]
    s_waitcnt lgkmcnt(4)
    s_barrier
    ds_read_b128 v[40:43], v16 offset:0
    ds_read_b128 v[44:47], v16 offset:2048
    ds_read_b128 v[56:59], v18 offset:0
    ds_read_b128 v[60:63], v18 offset:2048
    buffer_load_dwordx4 a[16:19], v3, s[20:23], s60 offen
    v_add_u32 v3, 57344, v3
    buffer_load_dwordx4 a[20:23], v3, s[20:23], s60 offen
    v_subrev_u32 v3, 57344, v3
    buffer_load_dwordx4 a[24:27], v5, s[24:27], s61 offen
    v_add_u32 v5, 57344, v5
    buffer_load_dwordx4 a[28:31], v5, s[24:27], s61 offen
    v_subrev_u32 v5, 57344, v5
    s_add_u32 s60, s60, 128
    s_add_u32 s61, s61, 128
    s_waitcnt vmcnt(8) lgkmcnt(4)
    ds_write_b128 v6, a[48:51] offset:32768
    ds_write_b128 v6, a[52:55] offset:36864
    ds_write_b128 v19, a[56:59] offset:32768
    ds_write_b128 v19, a[60:63] offset:36864
    v_mfma_f32_16x16x32_bf16 v[128:131], v[32:35], v[48:51], v[128:131]
    v_mfma_f32_16x16x32_bf16 v[132:135], v[32:35], v[52:55], v[132:135]
    v_mfma_f32_16x16x32_bf16 v[136:139], v[36:39], v[48:51], v[136:139]
    v_mfma_f32_16x16x32_bf16 v[140:143], v[36:39], v[52:55], v[140:143]
    ds_read_b128 v[32:35], v14 offset:16384
    ds_read_b128 v[36:39], v14 offset:18432
    ds_read_b128 v[48:51], v17 offset:16384
    ds_read_b128 v[52:55], v17 offset:18432
    s_waitcnt lgkmcnt(8)
    v_mfma_f32_16x16x32_bf16 v[128:131], v[40:43], v[56:59], v[128:131]
    v_mfma_f32_16x16x32_bf16 v[132:135], v[40:43], v[60:63], v[132:135]
    v_mfma_f32_16x16x32_bf16 v[136:139], v[44:47], v[56:59], v[136:139]
    v_mfma_f32_16x16x32_bf16 v[140:143], v[44:47], v[60:63], v[140:143]
    s_waitcnt lgkmcnt(4)
    s_barrier
    ds_read_b128 v[40:43], v16 offset:16384
    ds_read_b128 v[44:47], v16 offset:18432
    ds_read_b128 v[56:59], v18 offset:16384
    ds_read_b128 v[60:63], v18 offset:18432
    buffer_load_dwordx4 a[32:35], v3, s[20:23], s60 offen
    v_add_u32 v3, 57344, v3
    buffer_load_dwordx4 a[36:39], v3, s[20:23], s60 offen
    v_subrev_u32 v3, 57344, v3
    buffer_load_dwordx4 a[40:43], v5, s[24:27], s61 offen
    v_add_u32 v5, 57344, v5
    buffer_load_dwordx4 a[44:47], v5, s[24:27], s61 offen
    v_subrev_u32 v5, 57344, v5
    s_add_u32 s60, s60, 128
    s_add_u32 s61, s61, 128
    s_waitcnt vmcnt(8) lgkmcnt(4)
    ds_write_b128 v6, a[0:3] offset:0
    ds_write_b128 v6, a[4:7] offset:4096
    ds_write_b128 v19, a[8:11] offset:0
    ds_write_b128 v19, a[12:15] offset:4096
    v_mfma_f32_16x16x32_bf16 v[128:131], v[32:35], v[48:51], v[128:131]
    v_mfma_f32_16x16x32_bf16 v[132:135], v[32:35], v[52:55], v[132:135]
    v_mfma_f32_16x16x32_bf16 v[136:139], v[36:39], v[48:51], v[136:139]
    v_mfma_f32_16x16x32_bf16 v[140:143], v[36:39], v[52:55], v[140:143]
    ds_read_b128 v[32:35], v14 offset:32768
    ds_read_b128 v[36:39], v14 offset:34816
    ds_read_b128 v[48:51], v17 offset:32768
    ds_read_b128 v[52:55], v17 offset:34816
    s_waitcnt lgkmcnt(8)
    v_mfma_f32_16x16x32_bf16 v[128:131], v[40:43], v[56:59], v[128:131]
    v_mfma_f32_16x16x32_bf16 v[132:135], v[40:43], v[60:63], v[132:135]
    v_mfma_f32_16x16x32_bf16 v[136:139], v[44:47], v[56:59], v[136:139]
    v_mfma_f32_16x16x32_bf16 v[140:143], v[44:47], v[60:63], v[140:143]
    s_waitcnt lgkmcnt(4)
    s_barrier
    ds_read_b128 v[40:43], v16 offset:32768
    ds_read_b128 v[44:47], v16 offset:34816
    ds_read_b128 v[56:59], v18 offset:32768
    ds_read_b128 v[60:63], v18 offset:34816
    buffer_load_dwordx4 a[48:51], v3, s[20:23], s60 offen
    v_add_u32 v3, 57344, v3
    buffer_load_dwordx4 a[52:55], v3, s[20:23], s60 offen
    v_subrev_u32 v3, 57344, v3
    buffer_load_dwordx4 a[56:59], v5, s[24:27], s61 offen
    v_add_u32 v5, 57344, v5
    buffer_load_dwordx4 a[60:63], v5, s[24:27], s61 offen
    v_subrev_u32 v5, 57344, v5
    s_add_u32 s60, s60, 128
    s_add_u32 s61, s61, 128
    s_waitcnt vmcnt(8) lgkmcnt(4)
    ds_write_b128 v6, a[16:19] offset:16384
    ds_write_b128 v6, a[20:23] offset:20480
    ds_write_b128 v19, a[24:27] offset:16384
    ds_write_b128 v19, a[28:31] offset:20480
    v_mfma_f32_16x16x32_bf16 v[128:131], v[32:35], v[48:51], v[128:131]
    v_mfma_f32_16x16x32_bf16 v[132:135], v[32:35], v[52:55], v[132:135]
    v_mfma_f32_16x16x32_bf16 v[136:139], v[36:39], v[48:51], v[136:139]
    v_mfma_f32_16x16x32_bf16 v[140:143], v[36:39], v[52:55], v[140:143]
    ds_read_b128 v[32:35], v14 offset:0
    ds_read_b128 v[36:39], v14 offset:2048
    ds_read_b128 v[48:51], v17 offset:0
    ds_read_b128 v[52:55], v17 offset:2048
    s_waitcnt lgkmcnt(8)
    v_mfma_f32_16x16x32_bf16 v[128:131], v[40:43], v[56:59], v[128:131]
    v_mfma_f32_16x16x32_bf16 v[132:135], v[40:43], v[60:63], v[132:135]
    v_mfma_f32_16x16x32_bf16 v[136:139], v[44:47], v[56:59], v[136:139]
    v_mfma_f32_16x16x32_bf16 v[140:143], v[44:47], v[60:63], v[140:143]
    s_waitcnt lgkmcnt(4)
    s_barrier
    ds_read_b128 v[40:43], v16 offset:0
    ds_read_b128 v[44:47], v16 offset:2048
    ds_read_b128 v[56:59], v18 offset:0
    ds_read_b128 v[60:63], v18 offset:2048
    buffer_load_dwordx4 a[0:3], v3, s[20:23], s60 offen
    v_add_u32 v3, 57344, v3
    buffer_load_dwordx4 a[4:7], v3, s[20:23], s60 offen
    v_subrev_u32 v3, 57344, v3
    buffer_load_dwordx4 a[8:11], v5, s[24:27], s61 offen
    v_add_u32 v5, 57344, v5
    buffer_load_dwordx4 a[12:15], v5, s[24:27], s61 offen
    v_subrev_u32 v5, 57344, v5
    s_add_u32 s60, s60, 128
    s_add_u32 s61, s61, 128
    s_waitcnt vmcnt(8) lgkmcnt(4)
    ds_write_b128 v6, a[32:35] offset:32768
    ds_write_b128 v6, a[36:39] offset:36864
    ds_write_b128 v19, a[40:43] offset:32768
    ds_write_b128 v19, a[44:47] offset:36864
    v_mfma_f32_16x16x32_bf16 v[128:131], v[32:35], v[48:51], v[128:131]
    v_mfma_f32_16x16x32_bf16 v[132:135], v[32:35], v[52:55], v[132:135]
    v_mfma_f32_16x16x32_bf16 v[136:139], v[36:39], v[48:51], v[136:139]
    v_mfma_f32_16x16x32_bf16 v[140:143], v[36:39], v[52:55], v[140:143]
    ds_read_b128 v[32:35], v14 offset:16384
    ds_read_b128 v[36:39], v14 offset:18432
    ds_read_b128 v[48:51], v17 offset:16384
    ds_read_b128 v[52:55], v17 offset:18432
    s_waitcnt lgkmcnt(8)
    v_mfma_f32_16x16x32_bf16 v[128:131], v[40:43], v[56:59], v[128:131]
    v_mfma_f32_16x16x32_bf16 v[132:135], v[40:43], v[60:63], v[132:135]
    v_mfma_f32_16x16x32_bf16 v[136:139], v[44:47], v[56:59], v[136:139]
    v_mfma_f32_16x16x32_bf16 v[140:143], v[44:47], v[60:63], v[140:143]
    s_waitcnt lgkmcnt(4)
    s_barrier
    ds_read_b128 v[40:43], v16 offset:16384
    ds_read_b128 v[44:47], v16 offset:18432
    ds_read_b128 v[56:59], v18 offset:16384
    ds_read_b128 v[60:63], v18 offset:18432
    buffer_load_dwordx4 a[16:19], v3, s[20:23], s60 offen
    v_add_u32 v3, 57344, v3
    buffer_load_dwordx4 a[20:23], v3, s[20:23], s60 offen
    v_subrev_u32 v3, 57344, v3
    buffer_load_dwordx4 a[24:27], v5, s[24:27], s61 offen
    v_add_u32 v5, 57344, v5
    buffer_load_dwordx4 a[28:31], v5, s[24:27], s61 offen
    v_subrev_u32 v5, 57344, v5
    s_add_u32 s60, s60, 128
    s_add_u32 s61, s61, 128
    s_waitcnt vmcnt(8) lgkmcnt(4)
    ds_write_b128 v6, a[48:51] offset:0
    ds_write_b128 v6, a[52:55] offset:4096
    ds_write_b128 v19, a[56:59] offset:0
    ds_write_b128 v19, a[60:63] offset:4096
    v_mfma_f32_16x16x32_bf16 v[128:131], v[32:35], v[48:51], v[128:131]
    v_mfma_f32_16x16x32_bf16 v[132:135], v[32:35], v[52:55], v[132:135]
    v_mfma_f32_16x16x32_bf16 v[136:139], v[36:39], v[48:51], v[136:139]
    v_mfma_f32_16x16x32_bf16 v[140:143], v[36:39], v[52:55], v[140:143]
    ds_read_b128 v[32:35], v14 offset:32768
    ds_read_b128 v[36:39], v14 offset:34816
    ds_read_b128 v[48:51], v17 offset:32768
    ds_read_b128 v[52:55], v17 offset:34816
    s_waitcnt lgkmcnt(8)
    v_mfma_f32_16x16x32_bf16 v[128:131], v[40:43], v[56:59], v[128:131]
    v_mfma_f32_16x16x32_bf16 v[132:135], v[40:43], v[60:63], v[132:135]
    v_mfma_f32_16x16x32_bf16 v[136:139], v[44:47], v[56:59], v[136:139]
    v_mfma_f32_16x16x32_bf16 v[140:143], v[44:47], v[60:63], v[140:143]
    s_waitcnt lgkmcnt(4)
    s_barrier
    s_waitcnt lgkmcnt(0)
    s_waitcnt vmcnt(0)
    s_nop 7
    s_nop 1
    s_lshl_b32 s12, s10, 6
    v_lshlrev_b32 v20, 5, v12
    v_add_u32 v20, v20, v8
    v_add_u32 v20, s12, v20
    v_mul_u32_u24 v22, 896, v20
    s_lshl_b32 s13, s11, 7
    v_lshlrev_b32 v23, 6, v11
    v_lshlrev_b32 v24, 3, v9
    v_add_u32 v23, v23, v24
    v_add_u32 v23, s13, v23
    v_add_u32 v22, v22, v23
    v_lshlrev_b32 v24, 1, v23
    s_mov_b32 s17, 8960
    buffer_load_dwordx4 v[80:83], v24, s[28:31], s17 offen offset:0
    buffer_load_dwordx4 v[84:87], v24, s[28:31], s17 offen offset:64
    v_add_u32 v25, 0, v22
    buffer_load_dwordx2 v[64:65], v25, s[32:35], 0 offen offset:0
    v_add_u32 v25, 0, v22
    buffer_load_dwordx2 v[66:67], v25, s[32:35], 0 offen offset:32
    v_add_u32 v25, 14336, v22
    buffer_load_dwordx2 v[68:69], v25, s[32:35], 0 offen offset:0
    v_add_u32 v25, 14336, v22
    buffer_load_dwordx2 v[70:71], v25, s[32:35], 0 offen offset:32
    s_waitcnt vmcnt(0)
    v_cvt_pk_bf16_f32 v28, v128, v129
    v_lshlrev_b32 v29, 16, v28
    v_and_b32 v30, 0xffff0000, v28
    v_mul_f32 v29, v29, v80
    v_mul_f32 v30, v30, v81
    v_cvt_pk_bf16_f32 v28, v29, v30
    v_lshlrev_b32 v29, 16, v28
    v_and_b32 v30, 0xffff0000, v28
    v_lshlrev_b32 v31, 16, v64
    v_and_b32 v28, 0xffff0000, v64
    v_add_f32 v29, v29, v31
    v_add_f32 v30, v30, v28
    v_cvt_pk_bf16_f32 v64, v29, v30
    v_cvt_pk_bf16_f32 v28, v130, v131
    v_lshlrev_b32 v29, 16, v28
    v_and_b32 v30, 0xffff0000, v28
    v_mul_f32 v29, v29, v82
    v_mul_f32 v30, v30, v83
    v_cvt_pk_bf16_f32 v28, v29, v30
    v_lshlrev_b32 v29, 16, v28
    v_and_b32 v30, 0xffff0000, v28
    v_lshlrev_b32 v31, 16, v65
    v_and_b32 v28, 0xffff0000, v65
    v_add_f32 v29, v29, v31
    v_add_f32 v30, v30, v28
    v_cvt_pk_bf16_f32 v65, v29, v30
    v_add_u32 v25, 0, v22
    buffer_store_dwordx2 v[64:65], v25, s[36:39], 0 offen offset:0
    v_cvt_pk_bf16_f32 v28, v136, v137
    v_lshlrev_b32 v29, 16, v28
    v_and_b32 v30, 0xffff0000, v28
    v_mul_f32 v29, v29, v84
    v_mul_f32 v30, v30, v85
    v_cvt_pk_bf16_f32 v28, v29, v30
    v_lshlrev_b32 v29, 16, v28
    v_and_b32 v30, 0xffff0000, v28
    v_lshlrev_b32 v31, 16, v66
    v_and_b32 v28, 0xffff0000, v66
    v_add_f32 v29, v29, v31
    v_add_f32 v30, v30, v28
    v_cvt_pk_bf16_f32 v66, v29, v30
    v_cvt_pk_bf16_f32 v28, v138, v139
    v_lshlrev_b32 v29, 16, v28
    v_and_b32 v30, 0xffff0000, v28
    v_mul_f32 v29, v29, v86
    v_mul_f32 v30, v30, v87
    v_cvt_pk_bf16_f32 v28, v29, v30
    v_lshlrev_b32 v29, 16, v28
    v_and_b32 v30, 0xffff0000, v28
    v_lshlrev_b32 v31, 16, v67
    v_and_b32 v28, 0xffff0000, v67
    v_add_f32 v29, v29, v31
    v_add_f32 v30, v30, v28
    v_cvt_pk_bf16_f32 v67, v29, v30
    v_add_u32 v25, 0, v22
    buffer_store_dwordx2 v[66:67], v25, s[36:39], 0 offen offset:32
    v_cvt_pk_bf16_f32 v28, v132, v133
    v_lshlrev_b32 v29, 16, v28
    v_and_b32 v30, 0xffff0000, v28
    v_mul_f32 v29, v29, v80
    v_mul_f32 v30, v30, v81
    v_cvt_pk_bf16_f32 v28, v29, v30
    v_lshlrev_b32 v29, 16, v28
    v_and_b32 v30, 0xffff0000, v28
    v_lshlrev_b32 v31, 16, v68
    v_and_b32 v28, 0xffff0000, v68
    v_add_f32 v29, v29, v31
    v_add_f32 v30, v30, v28
    v_cvt_pk_bf16_f32 v68, v29, v30
    v_cvt_pk_bf16_f32 v28, v134, v135
    v_lshlrev_b32 v29, 16, v28
    v_and_b32 v30, 0xffff0000, v28
    v_mul_f32 v29, v29, v82
    v_mul_f32 v30, v30, v83
    v_cvt_pk_bf16_f32 v28, v29, v30
    v_lshlrev_b32 v29, 16, v28
    v_and_b32 v30, 0xffff0000, v28
    v_lshlrev_b32 v31, 16, v69
    v_and_b32 v28, 0xffff0000, v69
    v_add_f32 v29, v29, v31
    v_add_f32 v30, v30, v28
    v_cvt_pk_bf16_f32 v69, v29, v30
    v_add_u32 v25, 14336, v22
    buffer_store_dwordx2 v[68:69], v25, s[36:39], 0 offen offset:0
    v_cvt_pk_bf16_f32 v28, v140, v141
    v_lshlrev_b32 v29, 16, v28
    v_and_b32 v30, 0xffff0000, v28
    v_mul_f32 v29, v29, v84
    v_mul_f32 v30, v30, v85
    v_cvt_pk_bf16_f32 v28, v29, v30
    v_lshlrev_b32 v29, 16, v28
    v_and_b32 v30, 0xffff0000, v28
    v_lshlrev_b32 v31, 16, v70
    v_and_b32 v28, 0xffff0000, v70
    v_add_f32 v29, v29, v31
    v_add_f32 v30, v30, v28
    v_cvt_pk_bf16_f32 v70, v29, v30
    v_cvt_pk_bf16_f32 v28, v142, v143
    v_lshlrev_b32 v29, 16, v28
    v_and_b32 v30, 0xffff0000, v28
    v_mul_f32 v29, v29, v86
    v_mul_f32 v30, v30, v87
    v_cvt_pk_bf16_f32 v28, v29, v30
    v_lshlrev_b32 v29, 16, v28
    v_and_b32 v30, 0xffff0000, v28
    v_lshlrev_b32 v31, 16, v71
    v_and_b32 v28, 0xffff0000, v71
    v_add_f32 v29, v29, v31
    v_add_f32 v30, v30, v28
    v_cvt_pk_bf16_f32 v71, v29, v30
    v_add_u32 v25, 14336, v22
    buffer_store_dwordx2 v[70:71], v25, s[36:39], 0 offen offset:32
K4_end_16:
    s_endpgm
.section .rodata,"a"
.p2align 6
.amdhsa_kernel prep_kernel
  .amdhsa_next_free_vgpr 128
  .amdhsa_next_free_sgpr 102
  .amdhsa_accum_offset 128
  .amdhsa_group_segment_fixed_size 0
  .amdhsa_kernarg_size 128
  .amdhsa_user_sgpr_count 2
  .amdhsa_user_sgpr_kernarg_segment_ptr 1
  .amdhsa_system_sgpr_workgroup_id_x 1
.end_amdhsa_kernel
.p2align 6
.amdhsa_kernel conv_kernel
  .amdhsa_next_free_vgpr 128
  .amdhsa_next_free_sgpr 102
  .amdhsa_accum_offset 128
  .amdhsa_group_segment_fixed_size 0
  .amdhsa_kernarg_size 128
  .amdhsa_user_sgpr_count 2
  .amdhsa_user_sgpr_kernarg_segment_ptr 1
  .amdhsa_system_sgpr_workgroup_id_x 1
.end_amdhsa_kernel
.p2align 6
.amdhsa_kernel mid_kernel
  .amdhsa_next_free_vgpr 480
  .amdhsa_next_free_sgpr 102
  .amdhsa_accum_offset 256
  .amdhsa_group_segment_fixed_size 0
  .amdhsa_kernarg_size 128
  .amdhsa_user_sgpr_count 2
  .amdhsa_user_sgpr_kernarg_segment_ptr 1
  .amdhsa_system_sgpr_workgroup_id_x 1
.end_amdhsa_kernel
.p2align 6
.amdhsa_kernel spat_kernel
  .amdhsa_next_free_vgpr 264
  .amdhsa_next_free_sgpr 102
  .amdhsa_accum_offset 168
  .amdhsa_group_segment_fixed_size 0
  .amdhsa_kernarg_size 128
  .amdhsa_user_sgpr_count 2
  .amdhsa_user_sgpr_kernarg_segment_ptr 1
  .amdhsa_system_sgpr_workgroup_id_x 1
.end_amdhsa_kernel
.p2align 6
.amdhsa_kernel outp_kernel
  .amdhsa_next_free_vgpr 232
  .amdhsa_next_free_sgpr 102
  .amdhsa_accum_offset 168
  .amdhsa_group_segment_fixed_size 0
  .amdhsa_kernarg_size 128
  .amdhsa_user_sgpr_count 2
  .amdhsa_user_sgpr_kernarg_segment_ptr 1
  .amdhsa_system_sgpr_workgroup_id_x 1
.end_amdhsa_kernel
```
